```python
import torch

def _softmax(x, axis=-1):
    return torch.softmax(x, dim=axis)
def _gelu(x):
    return torch.nn.functional.gelu(x, approximate="tanh")
def _silu(x):
    return torch.nn.functional.silu(x)
def _sigmoid(x):
    return torch.sigmoid(x)
def _layernorm(x, axis=-1, eps=1e-5):
    m = x.mean(dim=axis, keepdim=True)
    v = x.var(dim=axis, keepdim=True, unbiased=False)
    return (x - m) / torch.sqrt(v + eps)
def _scatter_add(tgt, idx, src, axis=0):
    return tgt.clone().index_add_(axis, idx, src)
def _segment_sum(src, seg, n):
    out = torch.zeros((n,) + src.shape[1:], dtype=src.dtype)
    return out.index_add_(0, seg, src)
def _pad(x, pw):
    flat = tuple(v for pair in reversed(pw) for v in pair)
    return torch.nn.functional.pad(x, flat)

kernel_name = 'recurrent_scan__linear_kernel_hedgehog__dense_activation_relu__prompt'

def setup_inputs():

    _w = (lambda a: (lambda t: t.to(torch.bfloat16) if t.is_floating_point() else t)(torch.as_tensor(a)))
    def _A_setup():
        B, S, D, H = 1, 2048, 576, 32
        Dh = D // H
        return {
            "x": _w((lambda *s: torch.randn(*s, dtype=torch.bfloat16) * 0.05)(B, S, D)),
            "wqkv": _w((lambda *s: torch.randn(*s, dtype=torch.bfloat16) * 0.2)(D, 3 * D)),
            "w_phi": _w((lambda *s: torch.randn(*s, dtype=torch.bfloat16) * 0.2)(H, Dh, Dh) * (Dh ** -0.5)),
            "wo": _w((lambda *s: torch.randn(*s, dtype=torch.bfloat16) * 0.05)(D, D)),
        }
    _A_in = _A_setup()

    def _B_setup():
        B, S, D, Dff = 1, 2048, 576, 4608
        return {
            "x": _w((lambda *s: torch.randn(*s, dtype=torch.bfloat16) * 0.05)(B, S, D)),
            "w1": _w((lambda *s: torch.randn(*s, dtype=torch.bfloat16) * 0.05)(D, Dff)),
            "w2": _w((lambda *s: torch.randn(*s, dtype=torch.bfloat16) * 0.05)(Dff, D)),
        }
    _B_in = _B_setup()

    return {
        "A_x": _A_in["x"],
        "A_wqkv": _A_in["wqkv"],
        "A_w_phi": _A_in["w_phi"],
        "A_wo": _A_in["wo"],
        "B_x": _B_in["x"],
        "B_w1": _B_in["w1"],
        "B_w2": _B_in["w2"],
    }

def reference(A_x, A_wqkv, A_w_phi, A_wo, B_x, B_w1, B_w2):
    def _A_ref(x, wqkv, w_phi, wo):
        B, S, D = x.shape
        H = 32; Dh = D // H
        qkv = (lambda x, *d: x.permute(*d))((x @ wqkv).reshape(B, S, 3, H, Dh), 2, 0, 3, 1, 4)
        q, k, v = qkv[0], qkv[1], qkv[2]
        pq = torch.einsum("bhsd,hdf->bhsf", q, w_phi)
        pk = torch.einsum("bhsd,hdf->bhsf", k, w_phi)
        phi_q = torch.concatenate([_softmax(pq, axis=-1), _softmax(-pq, axis=-1)], axis=-1)
        phi_k = torch.concatenate([_softmax(pk, axis=-1), _softmax(-pk, axis=-1)], axis=-1)
        kv = torch.einsum("bhsf,bhsd->bhfd", phi_k, v)
        z  = torch.einsum("bhsf->bhf", phi_k)
        num = torch.einsum("bhqf,bhfd->bhqd", phi_q, kv)
        den = torch.einsum("bhqf,bhf->bhq", phi_q, z)[..., None] + 1e-6
        o = num / den
        return (lambda x, *d: x.permute(*d))(o, 0, 2, 1, 3).reshape(B, S, D) @ wo

    def _B_ref(x, w1, w2):
        h = torch.einsum("bsd,df->bsf", x, w1)
        zero = torch.zeros_like(h)
        h = torch.maximum(h, zero)
        return torch.einsum("bsf,fd->bsd", h, w2)

    x = A_x
    xn = _layernorm(x, axis=-1)
    s = _A_ref(xn, A_wqkv, A_w_phi, A_wo)
    g = _silu(_B_ref(xn, B_w1, B_w2))
    return x + s * g
```

```asm
; @launch grid=(256,1,1) block=(256,1,1) lds=163840
.amdgcn_target "amdgcn-amd-amdhsa--gfx950"
.text
.globl recurrent_scan__linear_kernel_hedgehog__dense_activation_relu__prompt_kernel
.p2align 8
.type recurrent_scan__linear_kernel_hedgehog__dense_activation_relu__prompt_kernel,@function
recurrent_scan__linear_kernel_hedgehog__dense_activation_relu__prompt_kernel:
s_cmp_ge_u32 s2, 256
s_cbranch_scc1 L_end
s_load_dwordx2 s[4:5], s[0:1], 0
s_load_dwordx8 s[76:83], s[0:1], 40
s_load_dwordx8 s[44:51], s[0:1], 8
s_load_dwordx2 s[36:37], s[0:1], 72
s_memrealtime s[94:95]
s_getpc_b64 s[40:41]
PCREF:
s_mov_b32 s42, CODE_END-PCREF
s_mov_b32 s43, 0x20000
s_lshr_b32 s3, s2, 3
v_lshlrev_b32 v25, 5, v0
v_add_u32 v25, s3, v25
v_lshlrev_b32 v25, 7, v25
buffer_load_dword v63, v25, s[40:43], 0 offen
v_lshrrev_b32 v26, 6, v0
v_and_b32 v25, 63, v0
v_lshlrev_b32 v1, 4, v25
v_readfirstlane_b32 s67, v26
s_and_b32 s3, s2, 1
s_lshl_b32 s3, s3, 3
s_lshr_b32 s64, s2, 5
s_add_u32 s68, s64, s3
s_bfe_u32 s70, s2, 0x20001
s_bfe_u32 s71, s2, 0x20003
s_lshl2_add_u32 s69, s70, s71
v_lshrrev_b32 v26, 3, v25
v_mul_u32_u24 v27, 1152, v26
v_and_b32 v28, 0x70, v1
v_and_b32 v29, 0x30, v25
v_xor_b32 v28, v28, v29
v_add_u32 v2, v27, v28
v_xor_b32 v3, 64, v2
v_add_u32 v3, 8192, v3
v_add_u32 v4, 16384, v2
v_add_u32 v5, 16384, v3
s_mul_i32 s72, s67, 9216
s_lshl2_add_u32 s3, s68, s67
s_mul_i32 s85, s3, 36864
s_lshl_b32 s58, s70, 8
s_mov_b32 s6, 2359296
s_mov_b32 s7, 0x20000
s_waitcnt lgkmcnt(0)
s_add_u32 s59, s85, s58
s_add_u32 m0, s72, 0
s_nop 0
buffer_load_dwordx4 v2, s[4:7], s59 offen offset:0 lds
buffer_load_dwordx4 v3, s[4:7], s59 offen offset:1024 lds
buffer_load_dwordx4 v4, s[4:7], s59 offen offset:2048 lds
buffer_load_dwordx4 v5, s[4:7], s59 offen offset:3072 lds
s_add_u32 s58, s58, 128
s_and_b32 s58, s58, 0x3ff
s_add_u32 s59, s85, s58
s_add_u32 m0, s72, 4096
s_nop 0
buffer_load_dwordx4 v2, s[4:7], s59 offen offset:0 lds
buffer_load_dwordx4 v3, s[4:7], s59 offen offset:1024 lds
buffer_load_dwordx4 v4, s[4:7], s59 offen offset:2048 lds
buffer_load_dwordx4 v5, s[4:7], s59 offen offset:3072 lds
s_mov_b64 s[8:9], s[44:45]
s_mov_b32 s10, 1990656
s_mov_b32 s11, 0x20000
s_mov_b64 s[12:13], s[46:47]
s_mov_b32 s14, 20736
s_mov_b32 s15, 0x20000
s_mov_b64 s[16:17], s[48:49]
s_mov_b32 s18, 663552
s_mov_b32 s19, 0x20000
s_mov_b64 s[20:21], s[76:77]
s_mov_b32 s22, 5308416
s_mov_b32 s23, 0x20000
s_mov_b64 s[24:25], s[78:79]
s_mov_b32 s26, 5308416
s_mov_b32 s27, 0x20000
s_mov_b64 s[28:29], s[80:81]
s_mov_b32 s30, 2359296
s_mov_b32 s31, 0x20000
s_mov_b64 s[32:33], s[82:83]
s_mov_b32 s34, 256
s_mov_b32 s35, 0x20000
s_mov_b32 s38, 268435456
s_mov_b32 s39, 0x20000
v_mov_b32 v31, 2147483648
v_cmp_gt_u32 vcc, 18, v25
v_mul_u32_u24 v21, 9216, v25
s_lshl2_add_u32 s64, s64, s67
s_mul_i32 s79, s64, 165888
v_cndmask_b32 v21, v31, v21, vcc
s_mul_i32 s63, s69, 576
s_and_b32 s65, s71, 1
s_lshl_b32 s57, s65, 6
s_add_u32 s57, s57, s63
s_add_u32 s79, s79, s57
v_cmp_gt_u32 vcc, 2, v0
v_lshlrev_b32 v23, 7, v0
s_cmp_eq_u32 s2, 0
s_cselect_b32 s59, 0, 2147483648
v_cndmask_b32 v23, v31, v23, vcc
v_or_b32 v23, s59, v23
buffer_load_dword a182, v21, s[20:23], s79 offen
s_add_u32 s59, s85, 1024
s_add_u32 m0, s72, 8192
s_nop 0
buffer_load_dwordx4 v2, s[4:7], s59 offen offset:0 lds
s_add_u32 m0, s72, 44032
s_nop 0
buffer_load_dwordx4 v3, s[4:7], s59 offen offset:1024 lds
s_add_u32 m0, s72, 79872
s_nop 0
buffer_load_dwordx4 v4, s[4:7], s59 offen offset:2048 lds
s_add_u32 m0, s72, 115712
s_nop 0
buffer_load_dwordx4 v5, s[4:7], s59 offen offset:3072 lds
s_or_b32 s94, s94, 1
s_or_b32 s95, s95, 0x80000000
v_mov_b32 v28, s94
v_mov_b32 v29, s95
buffer_store_dwordx2 v[28:29], v23, s[32:35], 0 offen sc1
v_lshrrev_b32 v26, 2, v25
v_and_b32 v27, 0x30, v1
v_mul_u32_u24 v74, 3456, v26
v_add_u32 v64, v74, v27
v_mul_u32_u24 v75, 9216, v26
v_add_u32 v66, v75, v27
v_mov_b32 v65, 1216
v_mov_b32 v75, 2360
v_cmp_eq_u32 vcc, 16, v27
s_mul_i32 s62, s3, 9
v_add_u32 v67, s62, v26
v_cndmask_b32 v65, v65, v75, vcc
v_cmp_le_u32 vcc, 32, v27
s_mul_i32 s60, s62, 3456
s_mul_i32 s61, s69, 72
v_cndmask_b32 v65, v65, 64, vcc
v_add_u32 v65, v65, v74
s_add_u32 s60, s60, s61
s_lshl_b32 s56, s70, 7
v_subrev_u32 v75, s56, v67
v_cmp_gt_u32 vcc, 0x200, v67
v_and_b32 v75, 0x1ff, v75
s_nop 0
v_cndmask_b32 v67, v67, v75, vcc
v_cmp_gt_u32 vcc, 36, v25
v_lshl_add_u32 v67, v67, 6, v27
s_mul_i32 s61, s62, 9216
s_add_u32 s61, s61, s63
s_lshl_b32 s65, s65, 9
s_sub_u32 s61, s61, s65
s_add_u32 s61, s61, 512
v_cndmask_b32 v64, v31, v64, vcc
v_cndmask_b32 v65, v31, v65, vcc
v_cndmask_b32 v66, v31, v66, vcc
v_cndmask_b32 v67, v31, v67, vcc
s_mul_i32 s62, s69, 184320
s_add_u32 s62, s62, 1048576
s_add_u32 s78, s62, s72
s_lshl_b32 s64, s69, 6
s_add_u32 s64, s64, s3
s_lshl3_add_u32 s63, s64, 49152
s_lshl3_add_u32 s75, s64, 32768
v_bfe_u32 v26, v1, 4, 5
v_lshrrev_b32 v27, 9, v1
v_bfe_u32 v74, v26, 1, 3
v_xor_b32 v74, v74, v27
v_lshlrev_b32 v74, 4, v74
v_lshl_add_u32 v74, v26, 7, v74
v_add_u32 v6, s72, v74
v_xor_b32 v7, 32, v6
v_xor_b32 v8, 64, v6
v_xor_b32 v9, 96, v6
v_lshrrev_b32 v74, 3, v26
v_mul_u32_u24 v74, 35840, v74
v_add_u32 v84, v74, v6
v_add_u32 v85, v74, v7
v_add_u32 v86, v74, v8
v_add_u32 v87, v74, v9
v_mov_b32 v52, 0
v_mov_b32 v53, 0
v_mov_b32 v54, 0
v_mov_b32 v55, 0
v_mov_b32 v56, 0
v_mov_b32 v57, 0
v_mov_b32 v58, 0
v_mov_b32 v59, 0
v_mov_b32 v88, 0x3f803f80
s_mov_b32 s98, 0
s_mov_b32 s99, -1
v_cmp_eq_u32 vcc, 0, v25
v_lshrrev_b32 v75, 3, v25
v_mul_u32_u24 v75, 9216, v75
v_cndmask_b32 v15, v31, v25, vcc
v_bfe_u32 v74, v1, 8, 1
v_lshl_add_u32 v75, v74, 6, v75
v_and_b32 v22, 0x70, v1
v_xor_b32 v11, v75, v22
s_mul_i32 s56, s67, 73728
s_add_u32 s57, s57, s56
s_add_u32 s56, s70, 0
s_and_b32 s56, s56, 3
s_mul_i32 s56, s56, 1179648
s_add_u32 s56, s56, s57
s_add_u32 s40, s56, 0
s_add_u32 s41, s56, 293888
s_add_u32 s42, s56, 587776
s_add_u32 s43, s56, 881664
s_add_u32 s56, s70, 1
s_and_b32 s56, s56, 3
s_mul_i32 s56, s56, 1179648
s_add_u32 s56, s56, s57
s_add_u32 s44, s56, 0
s_add_u32 s45, s56, 293888
s_add_u32 s46, s56, 587776
s_add_u32 s47, s56, 881664
s_add_u32 s56, s70, 2
s_and_b32 s56, s56, 3
s_mul_i32 s56, s56, 1179648
s_add_u32 s56, s56, s57
s_add_u32 s48, s56, 0
s_add_u32 s88, s56, 294912
s_add_u32 s89, s56, 588800
s_add_u32 s90, s56, 882688
s_add_u32 s56, s70, 3
s_and_b32 s56, s56, 3
s_mul_i32 s56, s56, 1179648
s_add_u32 s56, s56, s57
s_add_u32 s91, s56, 0
s_add_u32 s92, s56, 293888
s_add_u32 s93, s56, 587776
s_add_u32 s96, s56, 881664
s_add_u32 s97, s57, 4718592
s_add_u32 s101, s57, 5012480
v_bfe_u32 v75, v1, 4, 2
v_lshlrev_b32 v75, 3, v75
v_lshl_add_u32 v75, v74, 5, v75
v_bfe_u32 v22, v1, 6, 2
v_lshl_add_u32 v74, v27, 3, v22
v_lshl_add_u32 v13, v74, 6, v75
v_lshl_add_u32 v75, v22, 7, v75
v_lshrrev_b32 v22, 1, v22
v_lshl_add_u32 v75, v22, 6, v75
v_mul_u32_u24 v74, 9216, v27
v_add_u32 v12, v74, v75
v_and_b32 v74, 16, v1
v_mov_b32 v60, 0x3f80
v_lshlrev_b32 v60, v74, v60
v_bfe_i32 v74, v1, 5, 1
v_and_b32 v61, v60, v74
v_xor_b32 v60, v60, v61
v_lshlrev_b32 v73, 4, v0
v_add_u32 v73, 147456, v73
v_mov_b32 v76, 0
v_mov_b32 v77, 0
v_mov_b32 v78, 0
v_mov_b32 v79, 0
ds_write_b128 v73, v[76:79] offset:0
ds_write_b128 v73, v[76:79] offset:4096
ds_write_b128 v73, v[76:79] offset:8192
s_lshl2_add_u32 s64, s68, s70
s_lshl2_add_u32 s64, s64, s67
s_lshl4_add_u32 s64, s64, s71
s_lshl_b32 s74, s64, 3
s_lshl4_add_u32 s64, s3, s69
s_lshl3_add_u32 s76, s64, 40960
s_lshl2_add_u32 s64, s68, s71
s_lshl2_add_u32 s64, s64, s67
s_lshl4_add_u32 s64, s64, s70
s_lshl3_add_u32 s77, s64, 65536
s_lshl4_add_u32 s64, s70, s68
s_lshl2_add_u32 s64, s64, s71
s_lshl2_add_u32 s64, s64, s67
s_lshl_b32 s64, s64, 11
s_add_u32 s73, s64, 25165824
v_mul_u32_u24 v92, 729, v0
v_lshrrev_b32 v92, 16, v92
v_mul_u32_u24 v95, 90, v92
v_sub_u32 v95, v0, v95
v_mul_u32_u24 v93, 205, v95
v_lshrrev_b32 v93, 10, v93
v_mul_u32_u24 v96, 5, v93
v_sub_u32 v94, v95, v96
v_mul_u32_u24 v95, 648, v92
v_mul_u32_u24 v96, 36, v93
s_movk_i32 s56, 180
v_add_u32 v95, v95, v96
v_cmp_gt_u32 s[64:65], s56, v0
v_lshl_add_u32 v95, v94, 3, v95
s_mul_i32 s56, s69, 1296
v_add_u32 v95, s56, v95
v_cndmask_b32 v68, v31, v95, s[64:65]
v_mul_u32_u24 v96, 18, v92
v_add_u32 v93, v96, v93
v_and_b32 v95, 0x33, v93
v_and_b32 v96, 4, v93
v_lshl_or_b32 v95, v96, 1, v95
v_bfe_u32 v96, v93, 3, 1
v_lshl_or_b32 v95, v96, 2, v95
v_lshlrev_b32 v97, 6, v95
v_lshl_add_u32 v97, v94, 4, v97
v_lshl_add_u32 v97, v92, 3, v97
v_cmp_gt_u32 s[56:57], 4, v94
v_add_u32 v97, 147456, v97
v_lshlrev_b32 v98, 5, v95
v_lshl_add_u32 v98, v92, 4, v98
v_add_u32 v98, 152576, v98
v_cndmask_b32 v69, v98, v97, s[56:57]
v_add_u32 v98, 2696, v98
v_cndmask_b32 v70, v98, v97, s[56:57]
v_mov_b32 v96, 161792
v_cndmask_b32 v69, v96, v69, s[64:65]
v_cndmask_b32 v70, v96, v70, s[64:65]
v_mul_u32_u24 v92, 7282, v0
v_lshrrev_b32 v92, 16, v92
v_mul_u32_u24 v97, 9, v92
v_sub_u32 v93, v0, v97
s_lshr_b32 s55, s2, 3
s_mul_i32 s54, s55, 18
v_add_u32 v92, s54, v92
v_lshrrev_b32 v94, 5, v92
v_and_b32 v95, 31, v92
v_bfe_u32 v96, v92, 2, 2
v_and_b32 v97, 1, v96
v_mul_u32_u24 v71, 20, v97
v_lshrrev_b32 v97, 1, v96
v_lshl_add_u32 v71, v97, 3, v71
v_lshrrev_b32 v97, 4, v95
v_lshl_add_u32 v71, v97, 2, v71
v_mad_u32_u24 v71, v94, 36, v71
v_lshl_add_u32 v96, v97, 2, v96
v_and_b32 v97, 1, v94
v_lshl_add_u32 v96, v97, 3, v96
v_cmp_le_u32 s[56:57], 16, v94
v_mad_u32_u24 v96, v96, 36, 16
v_and_b32 v97, 3, v95
v_cndmask_b32 v71, v71, v96, s[56:57]
v_add_u32 v71, v71, v97
v_mul_u32_u24 v71, 1152, v71
s_and_b32 s54, s2, 7
s_lshl_b32 s3, s54, 7
v_lshlrev_b32 v96, 4, v93
v_add_u32 v96, s3, v96
s_lshl4_add_u32 s3, s54, 1024
v_cmp_eq_u32 s[56:57], 8, v93
v_mov_b32 v97, s3
s_movk_i32 s3, 162
v_cndmask_b32 v96, v96, v97, s[56:57]
v_cmp_gt_u32 s[64:65], s3, v0
v_add_u32 v71, v71, v96
v_bfe_u32 v97, v95, 2, 1
v_cndmask_b32 v71, v31, v71, s[64:65]
v_xor_b32 v97, v97, v93
v_and_b32 v97, 3, v97
v_lshlrev_b32 v97, 4, v97
v_lshl_add_u32 v97, v95, 6, v97
v_lshrrev_b32 v93, 2, v93
v_lshl_add_u32 v97, v93, 11, v97
v_lshlrev_b32 v95, 4, v95
v_add_u32 v95, 4096, v95
v_cndmask_b32 v97, v97, v95, s[56:57]
v_mul_u32_u24 v94, 4608, v94
v_add_u32 v97, v97, v94
v_cndmask_b32 v72, v31, v97, s[64:65]
s_lshl_b32 s3, s54, 5
s_add_u32 s55, s55, s3
s_lshl3_add_u32 s55, s55, 57344
s_mul_i32 s54, s54, 82944
s_add_u32 s54, s54, 4194304
v_cmp_eq_u32 vcc, 0, v0
v_and_b32 v30, 0x1f0, v1
v_lshrrev_b32 v30, 2, v30
s_lshl_b32 s3, s67, 7
s_add_u32 s3, s3, 159744
v_add_u32 v30, s3, v30
v_cndmask_b32 v73, v31, v0, vcc
v_mov_b32 v24, 0
s_and_b32 s56, s2, 1
s_lshl_b32 s56, s56, 7
buffer_load_dwordx4 a[208:211], v64, s[8:11], s60 offen offset:1152
buffer_load_dwordx4 a[212:215], v65, s[8:11], s60 offen offset:0
buffer_load_dwordx4 a[216:219], v64, s[8:11], s60 offen offset:2304
buffer_load_dwordx4 a[220:223], v64, s[8:11], s60 offen offset:0
buffer_load_dwordx4 a[224:227], v66, s[20:23], s61 offen offset:0
s_waitcnt vmcnt(15)
ds_read_b128 v[112:115], v6 offset:0
ds_read_b128 v[116:119], v7 offset:0
ds_read_b128 v[120:123], v8 offset:0
ds_read_b128 v[124:127], v9 offset:0
s_add_u32 s58, s58, 128
s_and_b32 s58, s58, 0x3ff
s_add_u32 s59, s85, s58
s_add_u32 m0, s72, 36864
s_nop 0
buffer_load_dwordx4 v2, s[4:7], s59 offen offset:0 lds
buffer_load_dwordx4 v3, s[4:7], s59 offen offset:1024 lds
buffer_load_dwordx4 v4, s[4:7], s59 offen offset:2048 lds
buffer_load_dwordx4 v5, s[4:7], s59 offen offset:3072 lds
s_waitcnt vmcnt(15)
ds_read_b128 v[128:131], v6 offset:4096
ds_read_b128 v[132:135], v7 offset:4096
ds_read_b128 v[136:139], v8 offset:4096
ds_read_b128 v[140:143], v9 offset:4096
s_add_u32 s58, s58, 128
s_and_b32 s58, s58, 0x3ff
s_add_u32 s59, s85, s58
s_add_u32 m0, s72, 40960
s_nop 0
buffer_load_dwordx4 v2, s[4:7], s59 offen offset:0 lds
s_waitcnt lgkmcnt(7)
v_dot2c_f32_bf16 v52, v88, v112
v_dot2c_f32_bf16 v56, v112, v112
v_dot2c_f32_bf16 v53, v88, v113
v_dot2c_f32_bf16 v57, v113, v113
v_dot2c_f32_bf16 v54, v88, v114
v_dot2c_f32_bf16 v58, v114, v114
v_dot2c_f32_bf16 v55, v88, v115
v_dot2c_f32_bf16 v59, v115, v115
buffer_load_dwordx4 v3, s[4:7], s59 offen offset:1024 lds
s_waitcnt lgkmcnt(6)
v_dot2c_f32_bf16 v52, v88, v116
v_dot2c_f32_bf16 v56, v116, v116
v_dot2c_f32_bf16 v53, v88, v117
v_dot2c_f32_bf16 v57, v117, v117
v_dot2c_f32_bf16 v54, v88, v118
v_dot2c_f32_bf16 v58, v118, v118
v_dot2c_f32_bf16 v55, v88, v119
v_dot2c_f32_bf16 v59, v119, v119
buffer_load_dwordx4 v4, s[4:7], s59 offen offset:2048 lds
s_waitcnt lgkmcnt(5)
v_dot2c_f32_bf16 v52, v88, v120
v_dot2c_f32_bf16 v56, v120, v120
v_dot2c_f32_bf16 v53, v88, v121
v_dot2c_f32_bf16 v57, v121, v121
v_dot2c_f32_bf16 v54, v88, v122
v_dot2c_f32_bf16 v58, v122, v122
v_dot2c_f32_bf16 v55, v88, v123
v_dot2c_f32_bf16 v59, v123, v123
buffer_load_dwordx4 v5, s[4:7], s59 offen offset:3072 lds
s_waitcnt lgkmcnt(4)
v_dot2c_f32_bf16 v52, v88, v124
v_dot2c_f32_bf16 v56, v124, v124
v_dot2c_f32_bf16 v53, v88, v125
v_dot2c_f32_bf16 v57, v125, v125
v_dot2c_f32_bf16 v54, v88, v126
v_dot2c_f32_bf16 v58, v126, v126
v_dot2c_f32_bf16 v55, v88, v127
v_dot2c_f32_bf16 v59, v127, v127
s_waitcnt vmcnt(14)
ds_read_b128 v[240:243], v84 offset:8192
ds_read_b128 v[244:247], v85 offset:8192
ds_read_b128 v[248:251], v86 offset:8192
ds_read_b128 v[252:255], v87 offset:8192
s_add_u32 s58, s58, 128
s_and_b32 s58, s58, 0x3ff
s_add_u32 s59, s85, s58
s_add_u32 m0, s72, 73728
s_nop 0
buffer_load_dwordx4 v2, s[4:7], s59 offen offset:0 lds
s_waitcnt lgkmcnt(7)
v_dot2c_f32_bf16 v52, v88, v128
v_dot2c_f32_bf16 v56, v128, v128
v_dot2c_f32_bf16 v53, v88, v129
v_dot2c_f32_bf16 v57, v129, v129
v_dot2c_f32_bf16 v54, v88, v130
v_dot2c_f32_bf16 v58, v130, v130
v_dot2c_f32_bf16 v55, v88, v131
v_dot2c_f32_bf16 v59, v131, v131
buffer_load_dwordx4 v3, s[4:7], s59 offen offset:1024 lds
s_waitcnt lgkmcnt(6)
v_dot2c_f32_bf16 v52, v88, v132
v_dot2c_f32_bf16 v56, v132, v132
v_dot2c_f32_bf16 v53, v88, v133
v_dot2c_f32_bf16 v57, v133, v133
v_dot2c_f32_bf16 v54, v88, v134
v_dot2c_f32_bf16 v58, v134, v134
v_dot2c_f32_bf16 v55, v88, v135
v_dot2c_f32_bf16 v59, v135, v135
buffer_load_dwordx4 v4, s[4:7], s59 offen offset:2048 lds
s_waitcnt lgkmcnt(5)
v_dot2c_f32_bf16 v52, v88, v136
v_dot2c_f32_bf16 v56, v136, v136
v_dot2c_f32_bf16 v53, v88, v137
v_dot2c_f32_bf16 v57, v137, v137
v_dot2c_f32_bf16 v54, v88, v138
v_dot2c_f32_bf16 v58, v138, v138
v_dot2c_f32_bf16 v55, v88, v139
v_dot2c_f32_bf16 v59, v139, v139
buffer_load_dwordx4 v5, s[4:7], s59 offen offset:3072 lds
s_waitcnt lgkmcnt(4)
v_dot2c_f32_bf16 v52, v88, v140
v_dot2c_f32_bf16 v56, v140, v140
v_dot2c_f32_bf16 v53, v88, v141
v_dot2c_f32_bf16 v57, v141, v141
v_dot2c_f32_bf16 v54, v88, v142
v_dot2c_f32_bf16 v58, v142, v142
v_dot2c_f32_bf16 v55, v88, v143
v_dot2c_f32_bf16 v59, v143, v143
s_waitcnt vmcnt(8)
ds_read_b128 v[144:147], v6 offset:36864
ds_read_b128 v[148:151], v7 offset:36864
ds_read_b128 v[152:155], v8 offset:36864
ds_read_b128 v[156:159], v9 offset:36864
s_add_u32 s58, s58, 128
s_and_b32 s58, s58, 0x3ff
s_add_u32 s59, s85, s58
s_add_u32 m0, s72, 77824
s_nop 0
buffer_load_dwordx4 v2, s[4:7], s59 offen offset:0 lds
s_waitcnt lgkmcnt(7)
v_dot2c_f32_bf16 v52, v88, v240
v_dot2c_f32_bf16 v56, v240, v240
v_dot2c_f32_bf16 v53, v88, v241
buffer_load_dwordx4 v3, s[4:7], s59 offen offset:1024 lds
v_dot2c_f32_bf16 v57, v241, v241
v_dot2c_f32_bf16 v54, v88, v242
v_dot2c_f32_bf16 v58, v242, v242
v_dot2c_f32_bf16 v55, v88, v243
buffer_load_dwordx4 v4, s[4:7], s59 offen offset:2048 lds
v_dot2c_f32_bf16 v59, v243, v243
s_waitcnt lgkmcnt(6)
v_dot2c_f32_bf16 v52, v88, v244
v_dot2c_f32_bf16 v56, v244, v244
buffer_load_dwordx4 v5, s[4:7], s59 offen offset:3072 lds
v_dot2c_f32_bf16 v53, v88, v245
v_dot2c_f32_bf16 v57, v245, v245
v_dot2c_f32_bf16 v54, v88, v246
v_dot2c_f32_bf16 v58, v246, v246
buffer_store_dwordx4 a[208:211], v67, s[36:39], s62 offen sc1
v_dot2c_f32_bf16 v55, v88, v247
v_dot2c_f32_bf16 v59, v247, v247
s_waitcnt lgkmcnt(5)
v_dot2c_f32_bf16 v52, v88, v248
s_add_u32 s62, s62, 36864
buffer_store_dwordx4 a[212:215], v67, s[36:39], s62 offen sc1
v_dot2c_f32_bf16 v56, v248, v248
v_dot2c_f32_bf16 v53, v88, v249
v_dot2c_f32_bf16 v57, v249, v249
v_dot2c_f32_bf16 v54, v88, v250
s_add_u32 s62, s62, 36864
buffer_store_dwordx4 a[216:219], v67, s[36:39], s62 offen sc1
v_dot2c_f32_bf16 v58, v250, v250
v_dot2c_f32_bf16 v55, v88, v251
v_dot2c_f32_bf16 v59, v251, v251
s_add_u32 s62, s62, 36864
buffer_store_dwordx4 a[220:223], v67, s[36:39], s62 offen sc1
s_waitcnt lgkmcnt(4)
v_dot2c_f32_bf16 v52, v88, v252
v_dot2c_f32_bf16 v56, v252, v252
v_dot2c_f32_bf16 v53, v88, v253
v_dot2c_f32_bf16 v57, v253, v253
s_add_u32 s62, s62, 36864
buffer_store_dwordx4 a[224:227], v67, s[36:39], s62 offen sc1
v_dot2c_f32_bf16 v54, v88, v254
v_dot2c_f32_bf16 v58, v254, v254
v_dot2c_f32_bf16 v55, v88, v255
v_dot2c_f32_bf16 v59, v255, v255
s_waitcnt vmcnt(13)
ds_read_b128 v[160:163], v6 offset:40960
ds_read_b128 v[164:167], v7 offset:40960
ds_read_b128 v[168:171], v8 offset:40960
ds_read_b128 v[172:175], v9 offset:40960
s_add_u32 s58, s58, 128
s_and_b32 s58, s58, 0x3ff
s_add_u32 s59, s85, s58
s_add_u32 m0, s72, 110592
s_nop 0
buffer_load_dwordx4 v2, s[4:7], s59 offen offset:0 lds
s_waitcnt lgkmcnt(7)
v_dot2c_f32_bf16 v52, v88, v144
v_dot2c_f32_bf16 v56, v144, v144
v_dot2c_f32_bf16 v53, v88, v145
v_dot2c_f32_bf16 v57, v145, v145
v_dot2c_f32_bf16 v54, v88, v146
v_dot2c_f32_bf16 v58, v146, v146
buffer_load_dwordx4 v3, s[4:7], s59 offen offset:1024 lds
v_dot2c_f32_bf16 v55, v88, v147
v_dot2c_f32_bf16 v59, v147, v147
s_waitcnt lgkmcnt(6)
v_dot2c_f32_bf16 v52, v88, v148
v_dot2c_f32_bf16 v56, v148, v148
v_dot2c_f32_bf16 v53, v88, v149
v_dot2c_f32_bf16 v57, v149, v149
buffer_load_dwordx4 v4, s[4:7], s59 offen offset:2048 lds
v_dot2c_f32_bf16 v54, v88, v150
v_dot2c_f32_bf16 v58, v150, v150
v_dot2c_f32_bf16 v55, v88, v151
v_dot2c_f32_bf16 v59, v151, v151
s_waitcnt lgkmcnt(5)
v_dot2c_f32_bf16 v52, v88, v152
v_dot2c_f32_bf16 v56, v152, v152
v_dot2c_f32_bf16 v53, v88, v153
buffer_load_dwordx4 v5, s[4:7], s59 offen offset:3072 lds
v_dot2c_f32_bf16 v57, v153, v153
v_dot2c_f32_bf16 v54, v88, v154
v_dot2c_f32_bf16 v58, v154, v154
v_dot2c_f32_bf16 v55, v88, v155
v_dot2c_f32_bf16 v59, v155, v155
s_waitcnt lgkmcnt(4)
v_dot2c_f32_bf16 v52, v88, v156
buffer_load_dwordx2 v[22:23], v24, s[32:35], s56 offen sc1
v_dot2c_f32_bf16 v56, v156, v156
v_dot2c_f32_bf16 v53, v88, v157
v_dot2c_f32_bf16 v57, v157, v157
v_dot2c_f32_bf16 v54, v88, v158
v_dot2c_f32_bf16 v58, v158, v158
v_dot2c_f32_bf16 v55, v88, v159
v_dot2c_f32_bf16 v59, v159, v159
s_waitcnt vmcnt(14)
v_add_u32 v6, 73728, v6
v_add_u32 v7, 73728, v7
v_add_u32 v8, 73728, v8
v_add_u32 v9, 73728, v9
ds_read_b128 v[176:179], v6 offset:0
ds_read_b128 v[180:183], v7 offset:0
ds_read_b128 v[184:187], v8 offset:0
ds_read_b128 v[188:191], v9 offset:0
s_add_u32 s58, s58, 128
s_and_b32 s58, s58, 0x3ff
s_add_u32 s59, s85, s58
s_add_u32 m0, s72, 114688
s_nop 0
buffer_load_dwordx4 v2, s[4:7], s59 offen offset:0 lds
s_waitcnt lgkmcnt(7)
v_dot2c_f32_bf16 v52, v88, v160
v_dot2c_f32_bf16 v56, v160, v160
buffer_load_dwordx4 v3, s[4:7], s59 offen offset:1024 lds
v_dot2c_f32_bf16 v53, v88, v161
v_dot2c_f32_bf16 v57, v161, v161
buffer_load_dwordx4 v4, s[4:7], s59 offen offset:2048 lds
v_dot2c_f32_bf16 v54, v88, v162
v_dot2c_f32_bf16 v58, v162, v162
v_dot2c_f32_bf16 v55, v88, v163
buffer_load_dwordx4 v5, s[4:7], s59 offen offset:3072 lds
v_dot2c_f32_bf16 v59, v163, v163
s_waitcnt lgkmcnt(6)
v_dot2c_f32_bf16 v52, v88, v164
s_add_u32 m0, s72, 0
s_nop 0
buffer_load_dwordx4 v11, s[20:23], s40 offen offset:0 lds
v_dot2c_f32_bf16 v56, v164, v164
v_dot2c_f32_bf16 v53, v88, v165
v_dot2c_f32_bf16 v57, v165, v165
buffer_load_dwordx4 v11, s[20:23], s41 offen offset:1024 lds
v_dot2c_f32_bf16 v54, v88, v166
v_dot2c_f32_bf16 v58, v166, v166
buffer_load_dwordx4 v11, s[20:23], s42 offen offset:2048 lds
v_dot2c_f32_bf16 v55, v88, v167
v_dot2c_f32_bf16 v59, v167, v167
s_waitcnt lgkmcnt(5)
v_dot2c_f32_bf16 v52, v88, v168
buffer_load_dwordx4 v11, s[20:23], s43 offen offset:3072 lds
v_dot2c_f32_bf16 v56, v168, v168
v_dot2c_f32_bf16 v53, v88, v169
s_add_u32 m0, s72, 4096
s_nop 0
buffer_load_dwordx4 v11, s[20:23], s44 offen offset:0 lds
v_dot2c_f32_bf16 v57, v169, v169
v_dot2c_f32_bf16 v54, v88, v170
v_dot2c_f32_bf16 v58, v170, v170
buffer_load_dwordx4 v11, s[20:23], s45 offen offset:1024 lds
v_dot2c_f32_bf16 v55, v88, v171
v_dot2c_f32_bf16 v59, v171, v171
buffer_load_dwordx4 v11, s[20:23], s46 offen offset:2048 lds
s_waitcnt lgkmcnt(4)
v_dot2c_f32_bf16 v52, v88, v172
v_dot2c_f32_bf16 v56, v172, v172
v_dot2c_f32_bf16 v53, v88, v173
buffer_load_dwordx4 v11, s[20:23], s47 offen offset:3072 lds
v_dot2c_f32_bf16 v57, v173, v173
v_dot2c_f32_bf16 v54, v88, v174
s_add_u32 m0, s72, 8192
s_nop 0
buffer_load_dwordx4 v11, s[20:23], s48 offen offset:0 lds
v_dot2c_f32_bf16 v58, v174, v174
v_dot2c_f32_bf16 v55, v88, v175
v_dot2c_f32_bf16 v59, v175, v175
s_waitcnt vmcnt(23)
ds_read_b128 v[192:195], v6 offset:4096
ds_read_b128 v[196:199], v7 offset:4096
ds_read_b128 v[200:203], v8 offset:4096
ds_read_b128 v[204:207], v9 offset:4096
s_waitcnt lgkmcnt(7)
v_dot2c_f32_bf16 v52, v88, v176
v_dot2c_f32_bf16 v56, v176, v176
v_dot2c_f32_bf16 v53, v88, v177
v_dot2c_f32_bf16 v57, v177, v177
v_dot2c_f32_bf16 v54, v88, v178
v_dot2c_f32_bf16 v58, v178, v178
v_dot2c_f32_bf16 v55, v88, v179
v_dot2c_f32_bf16 v59, v179, v179
s_waitcnt lgkmcnt(6)
v_dot2c_f32_bf16 v52, v88, v180
v_dot2c_f32_bf16 v56, v180, v180
v_dot2c_f32_bf16 v53, v88, v181
v_dot2c_f32_bf16 v57, v181, v181
v_dot2c_f32_bf16 v54, v88, v182
v_dot2c_f32_bf16 v58, v182, v182
v_dot2c_f32_bf16 v55, v88, v183
v_dot2c_f32_bf16 v59, v183, v183
s_waitcnt lgkmcnt(5)
v_dot2c_f32_bf16 v52, v88, v184
v_dot2c_f32_bf16 v56, v184, v184
v_dot2c_f32_bf16 v53, v88, v185
v_dot2c_f32_bf16 v57, v185, v185
v_dot2c_f32_bf16 v54, v88, v186
v_dot2c_f32_bf16 v58, v186, v186
v_dot2c_f32_bf16 v55, v88, v187
v_dot2c_f32_bf16 v59, v187, v187
s_waitcnt lgkmcnt(4)
v_dot2c_f32_bf16 v52, v88, v188
v_dot2c_f32_bf16 v56, v188, v188
v_dot2c_f32_bf16 v53, v88, v189
v_dot2c_f32_bf16 v57, v189, v189
v_dot2c_f32_bf16 v54, v88, v190
v_dot2c_f32_bf16 v58, v190, v190
v_dot2c_f32_bf16 v55, v88, v191
v_dot2c_f32_bf16 v59, v191, v191
s_waitcnt vmcnt(14)
ds_read_b128 v[208:211], v6 offset:36864
ds_read_b128 v[212:215], v7 offset:36864
ds_read_b128 v[216:219], v8 offset:36864
ds_read_b128 v[220:223], v9 offset:36864
s_waitcnt lgkmcnt(7)
v_dot2c_f32_bf16 v52, v88, v192
v_dot2c_f32_bf16 v56, v192, v192
v_dot2c_f32_bf16 v53, v88, v193
v_dot2c_f32_bf16 v57, v193, v193
v_dot2c_f32_bf16 v54, v88, v194
v_dot2c_f32_bf16 v58, v194, v194
v_dot2c_f32_bf16 v55, v88, v195
v_dot2c_f32_bf16 v59, v195, v195
s_waitcnt lgkmcnt(6)
v_dot2c_f32_bf16 v52, v88, v196
v_dot2c_f32_bf16 v56, v196, v196
v_dot2c_f32_bf16 v53, v88, v197
v_dot2c_f32_bf16 v57, v197, v197
v_dot2c_f32_bf16 v54, v88, v198
v_dot2c_f32_bf16 v58, v198, v198
v_dot2c_f32_bf16 v55, v88, v199
v_dot2c_f32_bf16 v59, v199, v199
s_waitcnt lgkmcnt(5)
v_dot2c_f32_bf16 v52, v88, v200
v_dot2c_f32_bf16 v56, v200, v200
v_dot2c_f32_bf16 v53, v88, v201
v_dot2c_f32_bf16 v57, v201, v201
v_dot2c_f32_bf16 v54, v88, v202
v_dot2c_f32_bf16 v58, v202, v202
v_dot2c_f32_bf16 v55, v88, v203
v_dot2c_f32_bf16 v59, v203, v203
s_waitcnt lgkmcnt(4)
v_dot2c_f32_bf16 v52, v88, v204
v_dot2c_f32_bf16 v56, v204, v204
v_dot2c_f32_bf16 v53, v88, v205
v_dot2c_f32_bf16 v57, v205, v205
v_dot2c_f32_bf16 v54, v88, v206
v_dot2c_f32_bf16 v58, v206, v206
v_dot2c_f32_bf16 v55, v88, v207
v_dot2c_f32_bf16 v59, v207, v207
s_waitcnt vmcnt(9)
ds_read_b128 v[224:227], v6 offset:40960
ds_read_b128 v[228:231], v7 offset:40960
ds_read_b128 v[232:235], v8 offset:40960
ds_read_b128 v[236:239], v9 offset:40960
s_add_u32 m0, s72, 36864
s_nop 0
buffer_load_dwordx4 v11, s[20:23], s88 offen offset:0 lds
s_waitcnt lgkmcnt(7)
v_dot2c_f32_bf16 v52, v88, v208
v_dot2c_f32_bf16 v56, v208, v208
v_dot2c_f32_bf16 v53, v88, v209
buffer_load_dwordx4 v11, s[20:23], s89 offen offset:1024 lds
v_dot2c_f32_bf16 v57, v209, v209
v_dot2c_f32_bf16 v54, v88, v210
v_dot2c_f32_bf16 v58, v210, v210
buffer_load_dwordx4 v11, s[20:23], s90 offen offset:2048 lds
v_dot2c_f32_bf16 v55, v88, v211
v_dot2c_f32_bf16 v59, v211, v211
s_waitcnt lgkmcnt(6)
v_dot2c_f32_bf16 v52, v88, v212
s_add_u32 m0, s72, 39936
s_nop 0
buffer_load_dwordx4 v11, s[20:23], s91 offen offset:0 lds
v_dot2c_f32_bf16 v56, v212, v212
v_dot2c_f32_bf16 v53, v88, v213
v_dot2c_f32_bf16 v57, v213, v213
buffer_load_dwordx4 v11, s[20:23], s92 offen offset:1024 lds
v_dot2c_f32_bf16 v54, v88, v214
v_dot2c_f32_bf16 v58, v214, v214
v_dot2c_f32_bf16 v55, v88, v215
v_dot2c_f32_bf16 v59, v215, v215
buffer_load_dwordx4 v11, s[20:23], s93 offen offset:2048 lds
s_waitcnt lgkmcnt(5)
v_dot2c_f32_bf16 v52, v88, v216
v_dot2c_f32_bf16 v56, v216, v216
v_dot2c_f32_bf16 v53, v88, v217
buffer_load_dwordx4 v11, s[20:23], s96 offen offset:3072 lds
v_dot2c_f32_bf16 v57, v217, v217
v_dot2c_f32_bf16 v54, v88, v218
v_dot2c_f32_bf16 v58, v218, v218
s_add_u32 m0, s72, 44032
s_nop 0
buffer_load_dwordx4 v11, s[20:23], s97 offen offset:0 lds
v_dot2c_f32_bf16 v55, v88, v219
v_dot2c_f32_bf16 v59, v219, v219
s_waitcnt lgkmcnt(4)
v_dot2c_f32_bf16 v52, v88, v220
buffer_load_dwordx4 v11, s[20:23], s101 offen offset:1024 lds
v_dot2c_f32_bf16 v56, v220, v220
v_dot2c_f32_bf16 v53, v88, v221
v_dot2c_f32_bf16 v57, v221, v221
buffer_load_dword a183, v21, s[20:23], s79 offen offset:128
v_dot2c_f32_bf16 v54, v88, v222
v_dot2c_f32_bf16 v58, v222, v222
v_dot2c_f32_bf16 v55, v88, v223
v_dot2c_f32_bf16 v59, v223, v223
v_min_u32 v24, v22, v23
v_cmp_eq_u32 vcc, 0, v24
s_nop 0
s_cbranch_vccnz SLOW_tag
BACK_tag:
v_readfirstlane_b32 s94, v22
v_readfirstlane_b32 s95, v23
v_accvgpr_write_b32 a180, v22
v_accvgpr_write_b32 a181, v23
s_waitcnt lgkmcnt(3)
v_dot2c_f32_bf16 v52, v88, v224
v_dot2c_f32_bf16 v56, v224, v224
v_dot2c_f32_bf16 v53, v88, v225
v_dot2c_f32_bf16 v57, v225, v225
buffer_store_dwordx2 a[180:181], v15, s[36:39], s63 offen sc1
v_dot2c_f32_bf16 v54, v88, v226
v_dot2c_f32_bf16 v58, v226, v226
v_dot2c_f32_bf16 v55, v88, v227
v_dot2c_f32_bf16 v59, v227, v227
s_waitcnt lgkmcnt(2)
v_dot2c_f32_bf16 v52, v88, v228
v_dot2c_f32_bf16 v56, v228, v228
v_dot2c_f32_bf16 v53, v88, v229
v_dot2c_f32_bf16 v57, v229, v229
v_dot2c_f32_bf16 v54, v88, v230
v_dot2c_f32_bf16 v58, v230, v230
v_dot2c_f32_bf16 v55, v88, v231
v_dot2c_f32_bf16 v59, v231, v231
s_waitcnt lgkmcnt(1)
v_dot2c_f32_bf16 v52, v88, v232
v_dot2c_f32_bf16 v56, v232, v232
v_dot2c_f32_bf16 v53, v88, v233
v_dot2c_f32_bf16 v57, v233, v233
v_dot2c_f32_bf16 v54, v88, v234
v_dot2c_f32_bf16 v58, v234, v234
v_dot2c_f32_bf16 v55, v88, v235
v_dot2c_f32_bf16 v59, v235, v235
s_waitcnt lgkmcnt(0)
v_dot2c_f32_bf16 v52, v88, v236
v_dot2c_f32_bf16 v56, v236, v236
v_dot2c_f32_bf16 v53, v88, v237
v_dot2c_f32_bf16 v57, v237, v237
v_dot2c_f32_bf16 v54, v88, v238
v_dot2c_f32_bf16 v58, v238, v238
v_dot2c_f32_bf16 v55, v88, v239
v_dot2c_f32_bf16 v59, v239, v239
v_add_f32 v52, v52, v53
s_nop 0
v_add_f32 v54, v54, v55
v_add_f32 v56, v56, v57
v_add_f32 v58, v58, v59
v_add_f32 v52, v52, v54
v_mov_b32 v53, v52
v_add_f32 v56, v56, v58
v_mov_b32 v57, v56
v_permlane32_swap_b32 v52, v53
v_add_f32 v52, v52, v53
v_mul_f32 v52, 987991609, v52
v_permlane32_swap_b32 v56, v57
v_cvt_pk_bf16_f32 v53, v52, v52
v_and_b32 v53, 0xffff0000, v53
v_xor_b32 v48, 0x80000000, v53
v_mov_b32 v49, v48
v_mov_b32 v50, v48
v_mov_b32 v51, v48
s_nop 1
v_mfma_f32_4x4x4_16b_bf16 v[32:35], v[60:61], v[112:113], v[48:51]
v_mfma_f32_4x4x4_16b_bf16 v[36:39], v[60:61], v[114:115], v[48:51]
v_add_f32 v56, v56, v57
v_mul_f32 v56, 987991609, v56
v_fma_f32 v56, -v52, v52, v56
v_max_f32 v56, 0, v56
v_cvt_pk_bf16_f32 v56, v56, v56
v_and_b32 v56, 0xffff0000, v56
v_mfma_f32_4x4x4_16b_bf16 v[40:43], v[60:61], v[116:117], v[48:51]
v_mfma_f32_4x4x4_16b_bf16 v[44:47], v[60:61], v[118:119], v[48:51]
v_add_f32 v56, 0x3727c5ac, v56
v_cvt_pk_bf16_f32 v56, v56, v56
v_and_b32 v56, 0xffff0000, v56
v_sqrt_f32 v56, v56
s_nop 0
v_cvt_pk_bf16_f32 v56, v56, v56
v_lshrrev_b32 v19, 16, v56
v_cvt_pk_bf16_f32 v112, v32, v33
v_cvt_pk_bf16_f32 v113, v34, v35
v_cvt_pk_bf16_f32 v114, v36, v37
v_cvt_pk_bf16_f32 v115, v38, v39
v_mfma_f32_4x4x4_16b_bf16 v[32:35], v[60:61], v[120:121], v[48:51]
v_mfma_f32_4x4x4_16b_bf16 v[36:39], v[60:61], v[122:123], v[48:51]
v_and_b32 v56, 0xffff0000, v56
v_rcp_f32 v17, v56
v_add_u32 v14, 0, v12
v_xor_b32 v20, 64, v14
v_mul_f32 v18, 1069066811, v17
v_cvt_pk_bf16_f32 v116, v40, v41
v_cvt_pk_bf16_f32 v117, v42, v43
v_cvt_pk_bf16_f32 v118, v44, v45
v_cvt_pk_bf16_f32 v119, v46, v47
v_mfma_f32_4x4x4_16b_bf16 v[40:43], v[60:61], v[124:125], v[48:51]
v_mfma_f32_4x4x4_16b_bf16 v[44:47], v[60:61], v[126:127], v[48:51]
v_cvt_pk_bf16_f32 v120, v32, v33
v_cvt_pk_bf16_f32 v121, v34, v35
v_cvt_pk_bf16_f32 v122, v36, v37
v_cvt_pk_bf16_f32 v123, v38, v39
v_mfma_f32_4x4x4_16b_bf16 v[32:35], v[60:61], v[128:129], v[48:51]
v_mfma_f32_4x4x4_16b_bf16 v[36:39], v[60:61], v[130:131], v[48:51]
v_cvt_pk_bf16_f32 v124, v40, v41
v_cvt_pk_bf16_f32 v125, v42, v43
v_cvt_pk_bf16_f32 v126, v44, v45
v_cvt_pk_bf16_f32 v127, v46, v47
v_mfma_f32_4x4x4_16b_bf16 v[40:43], v[60:61], v[132:133], v[48:51]
v_mfma_f32_4x4x4_16b_bf16 v[44:47], v[60:61], v[134:135], v[48:51]
v_cvt_pk_bf16_f32 v128, v32, v33
v_cvt_pk_bf16_f32 v129, v34, v35
v_cvt_pk_bf16_f32 v130, v36, v37
v_cvt_pk_bf16_f32 v131, v38, v39
v_mfma_f32_4x4x4_16b_bf16 v[32:35], v[60:61], v[136:137], v[48:51]
v_mfma_f32_4x4x4_16b_bf16 v[36:39], v[60:61], v[138:139], v[48:51]
v_cvt_pk_bf16_f32 v132, v40, v41
v_cvt_pk_bf16_f32 v133, v42, v43
v_cvt_pk_bf16_f32 v134, v44, v45
v_cvt_pk_bf16_f32 v135, v46, v47
s_waitcnt vmcnt(11)
s_barrier
ds_read_b64_tr_b16 a[144:145], v14 offset:0
ds_read_b64_tr_b16 a[146:147], v14 offset:512
ds_read_b64_tr_b16 a[148:149], v20 offset:0
ds_read_b64_tr_b16 a[150:151], v20 offset:512
ds_read_b64_tr_b16 a[152:153], v14 offset:18432
ds_read_b64_tr_b16 a[154:155], v14 offset:18944
ds_read_b64_tr_b16 a[156:157], v20 offset:18432
ds_read_b64_tr_b16 a[158:159], v20 offset:18944
ds_read_b64_tr_b16 a[160:161], v14 offset:1024
ds_read_b64_tr_b16 a[162:163], v14 offset:1536
s_waitcnt lgkmcnt(6)
v_mfma_f32_32x32x16_bf16 v[80:95], a[144:147], v[112:115], 0
ds_read_b64_tr_b16 a[164:165], v20 offset:1024
ds_read_b64_tr_b16 a[166:167], v20 offset:1536
v_cvt_pk_bf16_f32 v136, v32, v33
v_cvt_pk_bf16_f32 v137, v34, v35
v_cvt_pk_bf16_f32 v138, v36, v37
v_cvt_pk_bf16_f32 v139, v38, v39
v_mfma_f32_32x32x16_bf16 v[96:111], a[148:151], v[112:115], 0
ds_read_b64_tr_b16 a[168:169], v14 offset:19456
ds_read_b64_tr_b16 a[170:171], v14 offset:19968
v_add_u32 v11, 128, v11
s_add_u32 m0, s72, 73728
s_nop 0
buffer_load_dwordx4 v11, s[20:23], s40 offen offset:0 lds
buffer_load_dword a228, v68, s[12:15], 0 offen offset:0
v_mfma_f32_4x4x4_16b_bf16 v[40:43], v[60:61], v[140:141], v[48:51]
v_mfma_f32_4x4x4_16b_bf16 v[44:47], v[60:61], v[142:143], v[48:51]
s_waitcnt lgkmcnt(6)
v_mfma_f32_32x32x16_bf16 v[80:95], a[152:155], v[116:119], v[80:95]
ds_read_b64_tr_b16 a[144:145], v20 offset:19456
ds_read_b64_tr_b16 a[146:147], v20 offset:19968
v_cvt_pk_bf16_f32 v140, v40, v41
v_cvt_pk_bf16_f32 v141, v42, v43
v_cvt_pk_bf16_f32 v142, v44, v45
v_cvt_pk_bf16_f32 v143, v46, v47
v_mfma_f32_32x32x16_bf16 v[96:111], a[156:159], v[116:119], v[96:111]
ds_read_b64_tr_b16 a[148:149], v14 offset:2048
ds_read_b64_tr_b16 a[150:151], v14 offset:2560
buffer_load_dwordx4 v11, s[20:23], s41 offen offset:1024 lds
buffer_load_dword a229, v68, s[12:15], 0 offen offset:4
buffer_load_dwordx4 a[232:235], v71, s[16:19], 0 offen
ds_write_b32 v30, v17
v_mfma_f32_4x4x4_16b_bf16 v[32:35], v[60:61], v[144:145], v[48:51]
v_mfma_f32_4x4x4_16b_bf16 v[36:39], v[60:61], v[146:147], v[48:51]
s_waitcnt lgkmcnt(7)
v_mfma_f32_32x32x16_bf16 v[80:95], a[160:163], v[120:123], v[80:95]
ds_read_b64_tr_b16 a[152:153], v20 offset:2048
ds_read_b64_tr_b16 a[154:155], v20 offset:2560
v_cvt_pk_bf16_f32 v144, v32, v33
v_cvt_pk_bf16_f32 v145, v34, v35
v_cvt_pk_bf16_f32 v146, v36, v37
v_cvt_pk_bf16_f32 v147, v38, v39
v_mfma_f32_32x32x16_bf16 v[96:111], a[164:167], v[120:123], v[96:111]
ds_read_b64_tr_b16 a[156:157], v14 offset:20480
ds_read_b64_tr_b16 a[158:159], v14 offset:20992
v_mfma_f32_4x4x4_16b_bf16 v[40:43], v[60:61], v[148:149], v[48:51]
v_mfma_f32_4x4x4_16b_bf16 v[44:47], v[60:61], v[150:151], v[48:51]
s_waitcnt lgkmcnt(7)
v_mfma_f32_32x32x16_bf16 v[80:95], a[168:171], v[124:127], v[80:95]
ds_read_b64_tr_b16 a[160:161], v20 offset:20480
ds_read_b64_tr_b16 a[162:163], v20 offset:20992
v_cvt_pk_bf16_f32 v148, v40, v41
v_cvt_pk_bf16_f32 v149, v42, v43
v_cvt_pk_bf16_f32 v150, v44, v45
v_cvt_pk_bf16_f32 v151, v46, v47
v_mfma_f32_32x32x16_bf16 v[96:111], a[144:147], v[124:127], v[96:111]
ds_read_b64_tr_b16 a[164:165], v14 offset:3072
ds_read_b64_tr_b16 a[166:167], v14 offset:3584
buffer_load_dwordx4 v11, s[20:23], s42 offen offset:2048 lds
v_mfma_f32_4x4x4_16b_bf16 v[32:35], v[60:61], v[152:153], v[48:51]
v_mfma_f32_4x4x4_16b_bf16 v[36:39], v[60:61], v[154:155], v[48:51]
s_waitcnt lgkmcnt(6)
v_mfma_f32_32x32x16_bf16 v[80:95], a[148:151], v[128:131], v[80:95]
ds_read_b64_tr_b16 a[168:169], v20 offset:3072
ds_read_b64_tr_b16 a[170:171], v20 offset:3584
v_cvt_pk_bf16_f32 v152, v32, v33
v_cvt_pk_bf16_f32 v153, v34, v35
v_cvt_pk_bf16_f32 v154, v36, v37
v_cvt_pk_bf16_f32 v155, v38, v39
v_mfma_f32_32x32x16_bf16 v[96:111], a[152:155], v[128:131], v[96:111]
ds_read_b64_tr_b16 a[144:145], v14 offset:21504
ds_read_b64_tr_b16 a[146:147], v14 offset:22016
buffer_load_dwordx4 v11, s[20:23], s43 offen offset:3072 lds
v_mfma_f32_4x4x4_16b_bf16 v[40:43], v[60:61], v[156:157], v[48:51]
v_mfma_f32_4x4x4_16b_bf16 v[44:47], v[60:61], v[158:159], v[48:51]
s_waitcnt lgkmcnt(6)
v_mfma_f32_32x32x16_bf16 v[80:95], a[156:159], v[132:135], v[80:95]
ds_read_b64_tr_b16 a[148:149], v20 offset:21504
ds_read_b64_tr_b16 a[150:151], v20 offset:22016
v_cvt_pk_bf16_f32 v156, v40, v41
v_cvt_pk_bf16_f32 v157, v42, v43
v_cvt_pk_bf16_f32 v158, v44, v45
v_cvt_pk_bf16_f32 v159, v46, v47
v_mfma_f32_32x32x16_bf16 v[96:111], a[160:163], v[132:135], v[96:111]
ds_read_b64_tr_b16 a[152:153], v14 offset:4096
ds_read_b64_tr_b16 a[154:155], v14 offset:4608
s_add_u32 m0, s72, 77824
v_mfma_f32_4x4x4_16b_bf16 v[32:35], v[60:61], v[160:161], v[48:51]
v_mfma_f32_4x4x4_16b_bf16 v[36:39], v[60:61], v[162:163], v[48:51]
s_waitcnt lgkmcnt(6)
v_mfma_f32_32x32x16_bf16 v[80:95], a[164:167], v[136:139], v[80:95]
ds_read_b64_tr_b16 a[156:157], v20 offset:4096
ds_read_b64_tr_b16 a[158:159], v20 offset:4608
v_cvt_pk_bf16_f32 v160, v32, v33
v_cvt_pk_bf16_f32 v161, v34, v35
v_cvt_pk_bf16_f32 v162, v36, v37
v_cvt_pk_bf16_f32 v163, v38, v39
v_mfma_f32_32x32x16_bf16 v[96:111], a[168:171], v[136:139], v[96:111]
ds_read_b64_tr_b16 a[160:161], v14 offset:22528
ds_read_b64_tr_b16 a[162:163], v14 offset:23040
buffer_load_dwordx4 v11, s[20:23], s44 offen offset:0 lds
v_mfma_f32_4x4x4_16b_bf16 v[40:43], v[60:61], v[164:165], v[48:51]
v_mfma_f32_4x4x4_16b_bf16 v[44:47], v[60:61], v[166:167], v[48:51]
s_waitcnt lgkmcnt(6)
v_mfma_f32_32x32x16_bf16 v[80:95], a[144:147], v[140:143], v[80:95]
ds_read_b64_tr_b16 a[164:165], v20 offset:22528
ds_read_b64_tr_b16 a[166:167], v20 offset:23040
v_cvt_pk_bf16_f32 v164, v40, v41
v_cvt_pk_bf16_f32 v165, v42, v43
v_cvt_pk_bf16_f32 v166, v44, v45
v_cvt_pk_bf16_f32 v167, v46, v47
v_mfma_f32_32x32x16_bf16 v[96:111], a[148:151], v[140:143], v[96:111]
ds_read_b64_tr_b16 a[168:169], v14 offset:5120
ds_read_b64_tr_b16 a[170:171], v14 offset:5632
v_mfma_f32_4x4x4_16b_bf16 v[32:35], v[60:61], v[168:169], v[48:51]
v_mfma_f32_4x4x4_16b_bf16 v[36:39], v[60:61], v[170:171], v[48:51]
s_waitcnt lgkmcnt(6)
v_mfma_f32_32x32x16_bf16 v[80:95], a[152:155], v[144:147], v[80:95]
ds_read_b64_tr_b16 a[144:145], v20 offset:5120
ds_read_b64_tr_b16 a[146:147], v20 offset:5632
v_cvt_pk_bf16_f32 v168, v32, v33
v_cvt_pk_bf16_f32 v169, v34, v35
v_cvt_pk_bf16_f32 v170, v36, v37
v_cvt_pk_bf16_f32 v171, v38, v39
v_mfma_f32_32x32x16_bf16 v[96:111], a[156:159], v[144:147], v[96:111]
ds_read_b64_tr_b16 a[148:149], v14 offset:23552
ds_read_b64_tr_b16 a[150:151], v14 offset:24064
buffer_load_dwordx4 v11, s[20:23], s45 offen offset:1024 lds
v_mfma_f32_4x4x4_16b_bf16 v[40:43], v[60:61], v[172:173], v[48:51]
v_mfma_f32_4x4x4_16b_bf16 v[44:47], v[60:61], v[174:175], v[48:51]
s_waitcnt lgkmcnt(6)
v_mfma_f32_32x32x16_bf16 v[80:95], a[160:163], v[148:151], v[80:95]
ds_read_b64_tr_b16 a[152:153], v20 offset:23552
ds_read_b64_tr_b16 a[154:155], v20 offset:24064
v_cvt_pk_bf16_f32 v172, v40, v41
v_cvt_pk_bf16_f32 v173, v42, v43
v_cvt_pk_bf16_f32 v174, v44, v45
v_cvt_pk_bf16_f32 v175, v46, v47
v_mfma_f32_32x32x16_bf16 v[96:111], a[164:167], v[148:151], v[96:111]
ds_read_b64_tr_b16 a[156:157], v14 offset:6144
ds_read_b64_tr_b16 a[158:159], v14 offset:6656
buffer_load_dwordx4 v11, s[20:23], s46 offen offset:2048 lds
v_mfma_f32_4x4x4_16b_bf16 v[32:35], v[60:61], v[176:177], v[48:51]
v_mfma_f32_4x4x4_16b_bf16 v[36:39], v[60:61], v[178:179], v[48:51]
s_waitcnt lgkmcnt(6)
v_mfma_f32_32x32x16_bf16 v[80:95], a[168:171], v[152:155], v[80:95]
ds_read_b64_tr_b16 a[160:161], v20 offset:6144
ds_read_b64_tr_b16 a[162:163], v20 offset:6656
v_cvt_pk_bf16_f32 v176, v32, v33
v_cvt_pk_bf16_f32 v177, v34, v35
v_cvt_pk_bf16_f32 v178, v36, v37
v_cvt_pk_bf16_f32 v179, v38, v39
v_mfma_f32_32x32x16_bf16 v[96:111], a[144:147], v[152:155], v[96:111]
ds_read_b64_tr_b16 a[164:165], v14 offset:24576
ds_read_b64_tr_b16 a[166:167], v14 offset:25088
v_mfma_f32_4x4x4_16b_bf16 v[40:43], v[60:61], v[180:181], v[48:51]
v_mfma_f32_4x4x4_16b_bf16 v[44:47], v[60:61], v[182:183], v[48:51]
s_waitcnt lgkmcnt(6)
v_mfma_f32_32x32x16_bf16 v[80:95], a[148:151], v[156:159], v[80:95]
ds_read_b64_tr_b16 a[168:169], v20 offset:24576
ds_read_b64_tr_b16 a[170:171], v20 offset:25088
v_cvt_pk_bf16_f32 v180, v40, v41
v_cvt_pk_bf16_f32 v181, v42, v43
v_cvt_pk_bf16_f32 v182, v44, v45
v_cvt_pk_bf16_f32 v183, v46, v47
v_mfma_f32_32x32x16_bf16 v[96:111], a[152:155], v[156:159], v[96:111]
ds_read_b64_tr_b16 a[144:145], v14 offset:7168
ds_read_b64_tr_b16 a[146:147], v14 offset:7680
buffer_load_dwordx4 v11, s[20:23], s47 offen offset:3072 lds
v_mfma_f32_4x4x4_16b_bf16 v[32:35], v[60:61], v[184:185], v[48:51]
v_mfma_f32_4x4x4_16b_bf16 v[36:39], v[60:61], v[186:187], v[48:51]
s_waitcnt lgkmcnt(6)
v_mfma_f32_32x32x16_bf16 v[80:95], a[156:159], v[160:163], v[80:95]
ds_read_b64_tr_b16 a[148:149], v20 offset:7168
ds_read_b64_tr_b16 a[150:151], v20 offset:7680
v_cvt_pk_bf16_f32 v184, v32, v33
v_cvt_pk_bf16_f32 v185, v34, v35
v_cvt_pk_bf16_f32 v186, v36, v37
v_cvt_pk_bf16_f32 v187, v38, v39
v_mfma_f32_32x32x16_bf16 v[96:111], a[160:163], v[160:163], v[96:111]
ds_read_b64_tr_b16 a[152:153], v14 offset:25600
ds_read_b64_tr_b16 a[154:155], v14 offset:26112
s_add_u32 m0, s72, 81920
s_nop 0
buffer_load_dwordx4 v11, s[20:23], s48 offen offset:0 lds
v_mfma_f32_4x4x4_16b_bf16 v[40:43], v[60:61], v[188:189], v[48:51]
v_mfma_f32_4x4x4_16b_bf16 v[44:47], v[60:61], v[190:191], v[48:51]
s_waitcnt lgkmcnt(6)
v_mfma_f32_32x32x16_bf16 v[80:95], a[164:167], v[164:167], v[80:95]
ds_read_b64_tr_b16 a[156:157], v20 offset:25600
ds_read_b64_tr_b16 a[158:159], v20 offset:26112
v_cvt_pk_bf16_f32 v188, v40, v41
v_cvt_pk_bf16_f32 v189, v42, v43
v_cvt_pk_bf16_f32 v190, v44, v45
v_cvt_pk_bf16_f32 v191, v46, v47
v_mfma_f32_32x32x16_bf16 v[96:111], a[168:171], v[164:167], v[96:111]
ds_read_b64_tr_b16 a[160:161], v14 offset:8192
ds_read_b64_tr_b16 a[162:163], v14 offset:8704
v_mfma_f32_4x4x4_16b_bf16 v[32:35], v[60:61], v[192:193], v[48:51]
v_mfma_f32_4x4x4_16b_bf16 v[36:39], v[60:61], v[194:195], v[48:51]
s_waitcnt lgkmcnt(6)
v_mfma_f32_32x32x16_bf16 v[80:95], a[144:147], v[168:171], v[80:95]
ds_read_b64_tr_b16 a[164:165], v20 offset:8192
ds_read_b64_tr_b16 a[166:167], v20 offset:8704
v_cvt_pk_bf16_f32 v192, v32, v33
v_cvt_pk_bf16_f32 v193, v34, v35
v_cvt_pk_bf16_f32 v194, v36, v37
v_cvt_pk_bf16_f32 v195, v38, v39
v_mfma_f32_32x32x16_bf16 v[96:111], a[148:151], v[168:171], v[96:111]
ds_read_b64_tr_b16 a[168:169], v14 offset:26624
ds_read_b64_tr_b16 a[170:171], v14 offset:27136
v_mfma_f32_4x4x4_16b_bf16 v[40:43], v[60:61], v[196:197], v[48:51]
v_mfma_f32_4x4x4_16b_bf16 v[44:47], v[60:61], v[198:199], v[48:51]
s_waitcnt lgkmcnt(6)
v_mfma_f32_32x32x16_bf16 v[80:95], a[152:155], v[172:175], v[80:95]
ds_read_b64_tr_b16 a[144:145], v20 offset:26624
ds_read_b64_tr_b16 a[146:147], v20 offset:27136
s_waitcnt vmcnt(14)
s_barrier
v_cvt_pk_bf16_f32 v196, v40, v41
v_cvt_pk_bf16_f32 v197, v42, v43
v_cvt_pk_bf16_f32 v198, v44, v45
v_cvt_pk_bf16_f32 v199, v46, v47
v_mfma_f32_32x32x16_bf16 v[96:111], a[156:159], v[172:175], v[96:111]
v_add_u32 v14, 36864, v12
v_xor_b32 v20, 64, v14
ds_read_b64_tr_b16 a[148:149], v14 offset:0
ds_read_b64_tr_b16 a[150:151], v14 offset:512
v_mfma_f32_4x4x4_16b_bf16 v[32:35], v[60:61], v[200:201], v[48:51]
v_mfma_f32_4x4x4_16b_bf16 v[36:39], v[60:61], v[202:203], v[48:51]
s_waitcnt lgkmcnt(6)
v_mfma_f32_32x32x16_bf16 v[80:95], a[160:163], v[176:179], v[80:95]
ds_read_b64_tr_b16 a[152:153], v20 offset:0
ds_read_b64_tr_b16 a[154:155], v20 offset:512
v_cvt_pk_bf16_f32 v200, v32, v33
v_cvt_pk_bf16_f32 v201, v34, v35
v_cvt_pk_bf16_f32 v202, v36, v37
v_cvt_pk_bf16_f32 v203, v38, v39
v_mfma_f32_32x32x16_bf16 v[96:111], a[164:167], v[176:179], v[96:111]
ds_read_b64_tr_b16 a[156:157], v14 offset:18432
ds_read_b64_tr_b16 a[158:159], v14 offset:18944
s_add_u32 m0, s72, 110592
v_mfma_f32_4x4x4_16b_bf16 v[40:43], v[60:61], v[204:205], v[48:51]
v_mfma_f32_4x4x4_16b_bf16 v[44:47], v[60:61], v[206:207], v[48:51]
s_waitcnt lgkmcnt(6)
v_mfma_f32_32x32x16_bf16 v[80:95], a[168:171], v[180:183], v[80:95]
ds_read_b64_tr_b16 a[160:161], v20 offset:18432
ds_read_b64_tr_b16 a[162:163], v20 offset:18944
v_cvt_pk_bf16_f32 v204, v40, v41
v_cvt_pk_bf16_f32 v205, v42, v43
v_cvt_pk_bf16_f32 v206, v44, v45
v_cvt_pk_bf16_f32 v207, v46, v47
v_mfma_f32_32x32x16_bf16 v[96:111], a[144:147], v[180:183], v[96:111]
ds_read_b64_tr_b16 a[164:165], v14 offset:1024
ds_read_b64_tr_b16 a[166:167], v14 offset:1536
v_mfma_f32_4x4x4_16b_bf16 v[32:35], v[60:61], v[208:209], v[48:51]
v_mfma_f32_4x4x4_16b_bf16 v[36:39], v[60:61], v[210:211], v[48:51]
s_waitcnt lgkmcnt(6)
v_mfma_f32_32x32x16_bf16 v[80:95], a[148:151], v[184:187], v[80:95]
ds_read_b64_tr_b16 a[168:169], v20 offset:1024
ds_read_b64_tr_b16 a[170:171], v20 offset:1536
v_cvt_pk_bf16_f32 v208, v32, v33
v_cvt_pk_bf16_f32 v209, v34, v35
v_cvt_pk_bf16_f32 v210, v36, v37
v_cvt_pk_bf16_f32 v211, v38, v39
v_mfma_f32_32x32x16_bf16 v[96:111], a[152:155], v[184:187], v[96:111]
ds_read_b64_tr_b16 a[144:145], v14 offset:19456
ds_read_b64_tr_b16 a[146:147], v14 offset:19968
buffer_load_dwordx4 v11, s[20:23], s88 offen offset:0 lds
v_accvgpr_write_b32 a0, v112
v_accvgpr_write_b32 a1, v113
v_accvgpr_write_b32 a2, v114
v_mfma_f32_4x4x4_16b_bf16 v[40:43], v[60:61], v[212:213], v[48:51]
v_mfma_f32_4x4x4_16b_bf16 v[44:47], v[60:61], v[214:215], v[48:51]
s_waitcnt lgkmcnt(6)
v_mfma_f32_32x32x16_bf16 v[80:95], a[156:159], v[188:191], v[80:95]
ds_read_b64_tr_b16 a[148:149], v20 offset:19456
ds_read_b64_tr_b16 a[150:151], v20 offset:19968
v_cvt_pk_bf16_f32 v212, v40, v41
v_cvt_pk_bf16_f32 v213, v42, v43
v_cvt_pk_bf16_f32 v214, v44, v45
v_cvt_pk_bf16_f32 v215, v46, v47
v_mfma_f32_32x32x16_bf16 v[96:111], a[160:163], v[188:191], v[96:111]
ds_read_b64_tr_b16 a[152:153], v14 offset:2048
ds_read_b64_tr_b16 a[154:155], v14 offset:2560
buffer_load_dwordx4 v11, s[20:23], s89 offen offset:1024 lds
v_accvgpr_write_b32 a3, v115
v_accvgpr_write_b32 a4, v116
v_accvgpr_write_b32 a5, v117
v_mfma_f32_4x4x4_16b_bf16 v[32:35], v[60:61], v[216:217], v[48:51]
v_mfma_f32_4x4x4_16b_bf16 v[36:39], v[60:61], v[218:219], v[48:51]
s_waitcnt lgkmcnt(6)
v_mfma_f32_32x32x16_bf16 v[80:95], a[164:167], v[192:195], v[80:95]
ds_read_b64_tr_b16 a[156:157], v20 offset:2048
ds_read_b64_tr_b16 a[158:159], v20 offset:2560
v_cvt_pk_bf16_f32 v216, v32, v33
v_cvt_pk_bf16_f32 v217, v34, v35
v_cvt_pk_bf16_f32 v218, v36, v37
v_cvt_pk_bf16_f32 v219, v38, v39
v_mfma_f32_32x32x16_bf16 v[96:111], a[168:171], v[192:195], v[96:111]
ds_read_b64_tr_b16 a[160:161], v14 offset:20480
ds_read_b64_tr_b16 a[162:163], v14 offset:20992
v_accvgpr_write_b32 a6, v118
v_accvgpr_write_b32 a7, v119
v_accvgpr_write_b32 a8, v120
v_accvgpr_write_b32 a9, v121
v_mfma_f32_4x4x4_16b_bf16 v[40:43], v[60:61], v[220:221], v[48:51]
v_mfma_f32_4x4x4_16b_bf16 v[44:47], v[60:61], v[222:223], v[48:51]
s_waitcnt lgkmcnt(6)
v_mfma_f32_32x32x16_bf16 v[80:95], a[144:147], v[196:199], v[80:95]
ds_read_b64_tr_b16 a[164:165], v20 offset:20480
ds_read_b64_tr_b16 a[166:167], v20 offset:20992
v_cvt_pk_bf16_f32 v220, v40, v41
v_cvt_pk_bf16_f32 v221, v42, v43
v_cvt_pk_bf16_f32 v222, v44, v45
v_cvt_pk_bf16_f32 v223, v46, v47
v_mfma_f32_32x32x16_bf16 v[96:111], a[148:151], v[196:199], v[96:111]
ds_read_b64_tr_b16 a[168:169], v14 offset:3072
ds_read_b64_tr_b16 a[170:171], v14 offset:3584
buffer_load_dwordx4 v11, s[20:23], s90 offen offset:2048 lds
v_accvgpr_write_b32 a10, v122
v_accvgpr_write_b32 a11, v123
v_accvgpr_write_b32 a12, v124
v_mfma_f32_4x4x4_16b_bf16 v[32:35], v[60:61], v[224:225], v[48:51]
v_mfma_f32_4x4x4_16b_bf16 v[36:39], v[60:61], v[226:227], v[48:51]
s_waitcnt lgkmcnt(6)
v_mfma_f32_32x32x16_bf16 v[80:95], a[152:155], v[200:203], v[80:95]
ds_read_b64_tr_b16 a[144:145], v20 offset:3072
ds_read_b64_tr_b16 a[146:147], v20 offset:3584
v_cvt_pk_bf16_f32 v224, v32, v33
v_cvt_pk_bf16_f32 v225, v34, v35
v_cvt_pk_bf16_f32 v226, v36, v37
v_cvt_pk_bf16_f32 v227, v38, v39
v_mfma_f32_32x32x16_bf16 v[96:111], a[156:159], v[200:203], v[96:111]
ds_read_b64_tr_b16 a[148:149], v14 offset:21504
ds_read_b64_tr_b16 a[150:151], v14 offset:22016
s_add_u32 m0, s72, 113664
s_nop 0
buffer_load_dwordx4 v11, s[20:23], s91 offen offset:0 lds
s_waitcnt vmcnt(12)
ds_write_b64 v69, a[228:229]
ds_write_b64 v70, a[228:229]
v_mfma_f32_4x4x4_16b_bf16 v[40:43], v[60:61], v[228:229], v[48:51]
v_mfma_f32_4x4x4_16b_bf16 v[44:47], v[60:61], v[230:231], v[48:51]
s_waitcnt lgkmcnt(8)
v_mfma_f32_32x32x16_bf16 v[80:95], a[160:163], v[204:207], v[80:95]
ds_read_b64_tr_b16 a[152:153], v20 offset:21504
ds_read_b64_tr_b16 a[154:155], v20 offset:22016
v_cvt_pk_bf16_f32 v228, v40, v41
v_cvt_pk_bf16_f32 v229, v42, v43
v_cvt_pk_bf16_f32 v230, v44, v45
v_cvt_pk_bf16_f32 v231, v46, v47
v_mfma_f32_32x32x16_bf16 v[96:111], a[164:167], v[204:207], v[96:111]
ds_read_b64_tr_b16 a[156:157], v14 offset:4096
ds_read_b64_tr_b16 a[158:159], v14 offset:4608
s_waitcnt vmcnt(11)
buffer_store_dwordx4 a[232:235], v72, s[36:39], s54 offen sc1
v_mov_b32 v25, v73
v_accvgpr_write_b32 a13, v125
v_accvgpr_write_b32 a14, v126
v_mfma_f32_4x4x4_16b_bf16 v[32:35], v[60:61], v[232:233], v[48:51]
v_mfma_f32_4x4x4_16b_bf16 v[36:39], v[60:61], v[234:235], v[48:51]
s_waitcnt lgkmcnt(8)
v_mfma_f32_32x32x16_bf16 v[80:95], a[168:171], v[208:211], v[80:95]
ds_read_b64_tr_b16 a[160:161], v20 offset:4096
ds_read_b64_tr_b16 a[162:163], v20 offset:4608
v_cvt_pk_bf16_f32 v232, v32, v33
v_cvt_pk_bf16_f32 v233, v34, v35
v_cvt_pk_bf16_f32 v234, v36, v37
v_cvt_pk_bf16_f32 v235, v38, v39
v_mfma_f32_32x32x16_bf16 v[96:111], a[144:147], v[208:211], v[96:111]
ds_read_b64_tr_b16 a[164:165], v14 offset:22528
ds_read_b64_tr_b16 a[166:167], v14 offset:23040
buffer_load_dwordx4 v11, s[20:23], s92 offen offset:1024 lds
v_accvgpr_write_b32 a15, v127
v_accvgpr_write_b32 a16, v128
v_accvgpr_write_b32 a17, v129
v_mfma_f32_4x4x4_16b_bf16 v[40:43], v[60:61], v[236:237], v[48:51]
v_mfma_f32_4x4x4_16b_bf16 v[44:47], v[60:61], v[238:239], v[48:51]
s_waitcnt lgkmcnt(6)
v_mfma_f32_32x32x16_bf16 v[80:95], a[148:151], v[212:215], v[80:95]
ds_read_b64_tr_b16 a[168:169], v20 offset:22528
ds_read_b64_tr_b16 a[170:171], v20 offset:23040
v_cvt_pk_bf16_f32 v236, v40, v41
v_cvt_pk_bf16_f32 v237, v42, v43
v_cvt_pk_bf16_f32 v238, v44, v45
v_cvt_pk_bf16_f32 v239, v46, v47
v_mfma_f32_32x32x16_bf16 v[96:111], a[152:155], v[212:215], v[96:111]
ds_read_b64_tr_b16 a[144:145], v14 offset:5120
ds_read_b64_tr_b16 a[146:147], v14 offset:5632
v_lshrrev_b32 v24, 1, v1
s_lshl_b32 s49, s69, 9
s_add_u32 s53, s49, 49152
buffer_load_dwordx2 v[22:23], v24, s[36:39], s53 offen sc1
v_mfma_f32_4x4x4_16b_bf16 v[32:35], v[60:61], v[240:241], v[48:51]
v_mfma_f32_4x4x4_16b_bf16 v[36:39], v[60:61], v[242:243], v[48:51]
s_waitcnt lgkmcnt(6)
v_mfma_f32_32x32x16_bf16 v[80:95], a[156:159], v[216:219], v[80:95]
ds_read_b64_tr_b16 a[148:149], v20 offset:5120
ds_read_b64_tr_b16 a[150:151], v20 offset:5632
v_cvt_pk_bf16_f32 v240, v32, v33
v_cvt_pk_bf16_f32 v241, v34, v35
v_cvt_pk_bf16_f32 v242, v36, v37
v_cvt_pk_bf16_f32 v243, v38, v39
v_mfma_f32_32x32x16_bf16 v[96:111], a[160:163], v[216:219], v[96:111]
ds_read_b64_tr_b16 a[152:153], v14 offset:23552
ds_read_b64_tr_b16 a[154:155], v14 offset:24064
buffer_load_dwordx4 v11, s[20:23], s93 offen offset:2048 lds
v_accvgpr_write_b32 a18, v130
v_accvgpr_write_b32 a19, v131
v_accvgpr_write_b32 a20, v132
v_mfma_f32_4x4x4_16b_bf16 v[40:43], v[60:61], v[244:245], v[48:51]
v_mfma_f32_4x4x4_16b_bf16 v[44:47], v[60:61], v[246:247], v[48:51]
s_waitcnt lgkmcnt(6)
v_mfma_f32_32x32x16_bf16 v[80:95], a[164:167], v[220:223], v[80:95]
ds_read_b64_tr_b16 a[156:157], v20 offset:23552
ds_read_b64_tr_b16 a[158:159], v20 offset:24064
v_cvt_pk_bf16_f32 v244, v40, v41
v_cvt_pk_bf16_f32 v245, v42, v43
v_cvt_pk_bf16_f32 v246, v44, v45
v_cvt_pk_bf16_f32 v247, v46, v47
v_mfma_f32_32x32x16_bf16 v[96:111], a[168:171], v[220:223], v[96:111]
ds_read_b64_tr_b16 a[160:161], v14 offset:6144
ds_read_b64_tr_b16 a[162:163], v14 offset:6656
buffer_load_dwordx4 v11, s[20:23], s96 offen offset:3072 lds
v_accvgpr_write_b32 a21, v133
v_accvgpr_write_b32 a22, v134
v_accvgpr_write_b32 a23, v135
v_mfma_f32_4x4x4_16b_bf16 v[32:35], v[60:61], v[248:249], v[48:51]
v_mfma_f32_4x4x4_16b_bf16 v[36:39], v[60:61], v[250:251], v[48:51]
s_waitcnt lgkmcnt(6)
v_mfma_f32_32x32x16_bf16 v[80:95], a[144:147], v[224:227], v[80:95]
ds_read_b64_tr_b16 a[164:165], v20 offset:6144
ds_read_b64_tr_b16 a[166:167], v20 offset:6656
v_cvt_pk_bf16_f32 v248, v32, v33
v_cvt_pk_bf16_f32 v249, v34, v35
v_cvt_pk_bf16_f32 v250, v36, v37
v_cvt_pk_bf16_f32 v251, v38, v39
v_mfma_f32_32x32x16_bf16 v[96:111], a[148:151], v[224:227], v[96:111]
ds_read_b64_tr_b16 a[168:169], v14 offset:24576
ds_read_b64_tr_b16 a[170:171], v14 offset:25088
s_add_u32 m0, s72, 117760
v_accvgpr_write_b32 a24, v136
v_accvgpr_write_b32 a25, v137
v_accvgpr_write_b32 a26, v138
v_mfma_f32_4x4x4_16b_bf16 v[40:43], v[60:61], v[252:253], v[48:51]
v_mfma_f32_4x4x4_16b_bf16 v[44:47], v[60:61], v[254:255], v[48:51]
s_waitcnt lgkmcnt(6)
v_mfma_f32_32x32x16_bf16 v[80:95], a[152:155], v[228:231], v[80:95]
ds_read_b64_tr_b16 a[144:145], v20 offset:24576
ds_read_b64_tr_b16 a[146:147], v20 offset:25088
v_cvt_pk_bf16_f32 v252, v40, v41
v_cvt_pk_bf16_f32 v253, v42, v43
v_cvt_pk_bf16_f32 v254, v44, v45
v_cvt_pk_bf16_f32 v255, v46, v47
v_mfma_f32_32x32x16_bf16 v[96:111], a[156:159], v[228:231], v[96:111]
ds_read_b64_tr_b16 a[148:149], v14 offset:7168
ds_read_b64_tr_b16 a[150:151], v14 offset:7680
buffer_load_dwordx4 v11, s[20:23], s97 offen offset:0 lds
v_accvgpr_write_b32 a27, v139
v_accvgpr_write_b32 a28, v140
v_accvgpr_write_b32 a29, v141
s_waitcnt lgkmcnt(6)
v_mfma_f32_32x32x16_bf16 v[80:95], a[160:163], v[232:235], v[80:95]
ds_read_b64_tr_b16 a[152:153], v20 offset:7168
ds_read_b64_tr_b16 a[154:155], v20 offset:7680
v_accvgpr_write_b32 a30, v142
v_accvgpr_write_b32 a31, v143
v_accvgpr_write_b32 a32, v144
v_mfma_f32_32x32x16_bf16 v[96:111], a[164:167], v[232:235], v[96:111]
ds_read_b64_tr_b16 a[156:157], v14 offset:25600
ds_read_b64_tr_b16 a[158:159], v14 offset:26112
buffer_load_dwordx4 v11, s[20:23], s101 offen offset:1024 lds
v_accvgpr_write_b32 a33, v145
v_accvgpr_write_b32 a34, v146
v_accvgpr_write_b32 a35, v147
s_waitcnt lgkmcnt(6)
v_mfma_f32_32x32x16_bf16 v[80:95], a[168:171], v[236:239], v[80:95]
ds_read_b64_tr_b16 a[160:161], v20 offset:25600
ds_read_b64_tr_b16 a[162:163], v20 offset:26112
v_accvgpr_write_b32 a36, v148
v_accvgpr_write_b32 a37, v149
v_accvgpr_write_b32 a38, v150
v_mfma_f32_32x32x16_bf16 v[96:111], a[144:147], v[236:239], v[96:111]
ds_read_b64_tr_b16 a[164:165], v14 offset:8192
ds_read_b64_tr_b16 a[166:167], v14 offset:8704
v_accvgpr_write_b32 a39, v151
v_accvgpr_write_b32 a40, v152
v_accvgpr_write_b32 a41, v153
v_accvgpr_write_b32 a42, v154
s_waitcnt lgkmcnt(6)
v_mfma_f32_32x32x16_bf16 v[80:95], a[148:151], v[240:243], v[80:95]
ds_read_b64_tr_b16 a[168:169], v20 offset:8192
ds_read_b64_tr_b16 a[170:171], v20 offset:8704
v_accvgpr_write_b32 a43, v155
v_accvgpr_write_b32 a44, v156
v_accvgpr_write_b32 a45, v157
v_mfma_f32_32x32x16_bf16 v[96:111], a[152:155], v[240:243], v[96:111]
ds_read_b64_tr_b16 a[144:145], v14 offset:26624
ds_read_b64_tr_b16 a[146:147], v14 offset:27136
v_accvgpr_write_b32 a46, v158
v_accvgpr_write_b32 a47, v159
v_accvgpr_write_b32 a48, v160
v_accvgpr_write_b32 a49, v161
s_waitcnt lgkmcnt(6)
v_mfma_f32_32x32x16_bf16 v[80:95], a[156:159], v[244:247], v[80:95]
ds_read_b64_tr_b16 a[148:149], v20 offset:26624
ds_read_b64_tr_b16 a[150:151], v20 offset:27136
s_waitcnt vmcnt(11)
s_barrier
v_accvgpr_write_b32 a50, v162
v_mfma_f32_32x32x16_bf16 v[96:111], a[160:163], v[244:247], v[96:111]
v_add_u32 v14, 73728, v12
ds_read_b64_tr_b16 a[152:153], v14 offset:0
ds_read_b64_tr_b16 a[154:155], v14 offset:512
v_accvgpr_write_b32 a51, v163
v_accvgpr_write_b32 a52, v164
v_accvgpr_write_b32 a53, v165
s_waitcnt lgkmcnt(6)
v_mfma_f32_32x32x16_bf16 v[80:95], a[164:167], v[248:251], v[80:95]
ds_read_b64_tr_b16 a[156:157], v14 offset:18432
ds_read_b64_tr_b16 a[158:159], v14 offset:18944
v_accvgpr_write_b32 a54, v166
v_accvgpr_write_b32 a55, v167
v_accvgpr_write_b32 a56, v168
v_mfma_f32_32x32x16_bf16 v[96:111], a[168:171], v[248:251], v[96:111]
ds_read_b64_tr_b16 a[160:161], v14 offset:1024
ds_read_b64_tr_b16 a[162:163], v14 offset:1536
v_accvgpr_write_b32 a57, v169
v_accvgpr_write_b32 a58, v170
v_accvgpr_write_b32 a59, v171
v_accvgpr_write_b32 a60, v172
s_waitcnt lgkmcnt(6)
v_mfma_f32_32x32x16_bf16 v[80:95], a[144:147], v[252:255], v[80:95]
ds_read_b64_tr_b16 a[164:165], v14 offset:19456
ds_read_b64_tr_b16 a[166:167], v14 offset:19968
v_accvgpr_write_b32 a61, v173
v_accvgpr_write_b32 a62, v174
v_accvgpr_write_b32 a63, v175
v_mfma_f32_32x32x16_bf16 v[96:111], a[148:151], v[252:255], v[96:111]
ds_read_b64_tr_b16 a[168:169], v14 offset:2048
ds_read_b64_tr_b16 a[170:171], v14 offset:2560
s_waitcnt vmcnt(4)
v_cmp_ne_u64 vcc, s[94:95], v[22:23]
s_nop 0
s_cbranch_vccnz SLOW_rp
BACK_rp:
s_add_u32 s49, s78, 0
s_add_u32 m0, s72, 0
s_waitcnt lgkmcnt(6)
v_mfma_f32_32x32x16_bf16 v[32:47], a[152:155], v[112:115], 0
ds_read_b64_tr_b16 a[144:145], v14 offset:20480
ds_read_b64_tr_b16 a[146:147], v14 offset:20992
buffer_load_dwordx4 v1, s[36:39], s49 offen offset:0 sc1 lds
v_accvgpr_write_b32 a64, v176
v_accvgpr_write_b32 a65, v177
v_mfma_f32_32x32x16_bf16 v[32:47], a[156:159], v[116:119], v[32:47]
ds_read_b64_tr_b16 a[148:149], v14 offset:3072
ds_read_b64_tr_b16 a[150:151], v14 offset:3584
v_cvt_pk_bf16_f32 v64, v80, v81
v_cvt_pk_bf16_f32 v65, v82, v83
v_cvt_pk_bf16_f32 v66, v84, v85
v_cvt_pk_bf16_f32 v67, v86, v87
s_waitcnt lgkmcnt(6)
v_mfma_f32_32x32x16_bf16 v[32:47], a[160:163], v[120:123], v[32:47]
ds_read_b64_tr_b16 a[152:153], v14 offset:21504
ds_read_b64_tr_b16 a[154:155], v14 offset:22016
v_cvt_pk_bf16_f32 v68, v88, v89
v_cvt_pk_bf16_f32 v69, v90, v91
v_cvt_pk_bf16_f32 v70, v92, v93
v_mfma_f32_32x32x16_bf16 v[32:47], a[164:167], v[124:127], v[32:47]
ds_read_b64_tr_b16 a[156:157], v14 offset:4096
ds_read_b64_tr_b16 a[158:159], v14 offset:4608
buffer_load_dwordx4 v1, s[36:39], s49 offen offset:1024 sc1 lds
v_cvt_pk_bf16_f32 v71, v94, v95
v_pk_max_i16 v64, v64, 0
v_pk_max_i16 v65, v65, 0
s_waitcnt lgkmcnt(6)
v_mfma_f32_32x32x16_bf16 v[32:47], a[168:171], v[128:131], v[32:47]
ds_read_b64_tr_b16 a[160:161], v14 offset:22528
ds_read_b64_tr_b16 a[162:163], v14 offset:23040
v_pk_max_i16 v66, v66, 0
v_pk_max_i16 v67, v67, 0
v_pk_max_i16 v68, v68, 0
v_mfma_f32_32x32x16_bf16 v[32:47], a[144:147], v[132:135], v[32:47]
ds_read_b64_tr_b16 a[164:165], v14 offset:5120
ds_read_b64_tr_b16 a[166:167], v14 offset:5632
v_pk_max_i16 v69, v69, 0
v_pk_max_i16 v70, v70, 0
v_pk_max_i16 v71, v71, 0
buffer_store_dwordx4 v[64:67], v1, s[36:39], s73 offen offset:0 sc1
s_waitcnt lgkmcnt(6)
v_mfma_f32_32x32x16_bf16 v[32:47], a[148:151], v[136:139], v[32:47]
ds_read_b64_tr_b16 a[168:169], v14 offset:23552
ds_read_b64_tr_b16 a[170:171], v14 offset:24064
buffer_load_dwordx4 v1, s[36:39], s49 offen offset:2048 sc1 lds
buffer_store_dwordx4 v[68:71], v1, s[36:39], s73 offen offset:1024 sc1
v_cvt_pk_bf16_f32 v72, v96, v97
v_mfma_f32_32x32x16_bf16 v[32:47], a[152:155], v[140:143], v[32:47]
ds_read_b64_tr_b16 a[144:145], v14 offset:6144
ds_read_b64_tr_b16 a[146:147], v14 offset:6656
v_cvt_pk_bf16_f32 v73, v98, v99
v_cvt_pk_bf16_f32 v74, v100, v101
v_cvt_pk_bf16_f32 v75, v102, v103
v_cvt_pk_bf16_f32 v76, v104, v105
s_waitcnt lgkmcnt(6)
v_mfma_f32_32x32x16_bf16 v[32:47], a[156:159], v[144:147], v[32:47]
ds_read_b64_tr_b16 a[148:149], v14 offset:24576
ds_read_b64_tr_b16 a[150:151], v14 offset:25088
v_cvt_pk_bf16_f32 v77, v106, v107
v_cvt_pk_bf16_f32 v78, v108, v109
v_cvt_pk_bf16_f32 v79, v110, v111
v_mfma_f32_32x32x16_bf16 v[32:47], a[160:163], v[148:151], v[32:47]
ds_read_b64_tr_b16 a[152:153], v14 offset:7168
ds_read_b64_tr_b16 a[154:155], v14 offset:7680
buffer_load_dwordx4 v1, s[36:39], s49 offen offset:3072 sc1 lds
v_pk_max_i16 v72, v72, 0
v_pk_max_i16 v73, v73, 0
v_pk_max_i16 v74, v74, 0
s_waitcnt lgkmcnt(6)
v_mfma_f32_32x32x16_bf16 v[32:47], a[164:167], v[152:155], v[32:47]
ds_read_b64_tr_b16 a[156:157], v14 offset:25600
ds_read_b64_tr_b16 a[158:159], v14 offset:26112
v_pk_max_i16 v75, v75, 0
v_pk_max_i16 v76, v76, 0
v_pk_max_i16 v77, v77, 0
v_mfma_f32_32x32x16_bf16 v[32:47], a[168:171], v[156:159], v[32:47]
ds_read_b64_tr_b16 a[160:161], v14 offset:8192
ds_read_b64_tr_b16 a[162:163], v14 offset:8704
s_add_u32 s49, s78, 4096
s_add_u32 m0, s72, 4096
v_pk_max_i16 v78, v78, 0
v_pk_max_i16 v79, v79, 0
s_waitcnt lgkmcnt(6)
v_mfma_f32_32x32x16_bf16 v[32:47], a[144:147], v[160:163], v[32:47]
ds_read_b64_tr_b16 a[164:165], v14 offset:26624
ds_read_b64_tr_b16 a[166:167], v14 offset:27136
buffer_load_dwordx4 v1, s[36:39], s49 offen offset:0 sc1 lds
s_add_u32 s73, s73, 2097152
buffer_store_dwordx4 v[72:75], v1, s[36:39], s73 offen offset:0 sc1
v_mfma_f32_32x32x16_bf16 v[32:47], a[148:151], v[164:167], v[32:47]
v_xor_b32 v14, 64, v14
ds_read_b64_tr_b16 a[168:169], v14 offset:0
ds_read_b64_tr_b16 a[170:171], v14 offset:512
buffer_store_dwordx4 v[76:79], v1, s[36:39], s73 offen offset:1024 sc1
v_accvgpr_write_b32 a66, v178
v_accvgpr_write_b32 a67, v179
s_waitcnt lgkmcnt(6)
v_mfma_f32_32x32x16_bf16 v[32:47], a[152:155], v[168:171], v[32:47]
ds_read_b64_tr_b16 a[144:145], v14 offset:18432
ds_read_b64_tr_b16 a[146:147], v14 offset:18944
v_accvgpr_write_b32 a68, v180
v_accvgpr_write_b32 a69, v181
v_accvgpr_write_b32 a70, v182
v_mfma_f32_32x32x16_bf16 v[32:47], a[156:159], v[172:175], v[32:47]
ds_read_b64_tr_b16 a[148:149], v14 offset:1024
ds_read_b64_tr_b16 a[150:151], v14 offset:1536
v_accvgpr_write_b32 a71, v183
v_accvgpr_write_b32 a72, v184
v_accvgpr_write_b32 a73, v185
v_accvgpr_write_b32 a74, v186
s_waitcnt lgkmcnt(6)
v_mfma_f32_32x32x16_bf16 v[32:47], a[160:163], v[176:179], v[32:47]
ds_read_b64_tr_b16 a[152:153], v14 offset:19456
ds_read_b64_tr_b16 a[154:155], v14 offset:19968
buffer_load_dwordx4 v1, s[36:39], s49 offen offset:1024 sc1 lds
v_accvgpr_write_b32 a75, v187
v_accvgpr_write_b32 a76, v188
v_mfma_f32_32x32x16_bf16 v[32:47], a[164:167], v[180:183], v[32:47]
ds_read_b64_tr_b16 a[156:157], v14 offset:2048
ds_read_b64_tr_b16 a[158:159], v14 offset:2560
v_accvgpr_write_b32 a77, v189
v_accvgpr_write_b32 a78, v190
v_accvgpr_write_b32 a79, v191
v_accvgpr_write_b32 a80, v192
s_waitcnt lgkmcnt(6)
v_mfma_f32_32x32x16_bf16 v[48:63], a[168:171], v[112:115], 0
ds_read_b64_tr_b16 a[160:161], v14 offset:20480
ds_read_b64_tr_b16 a[162:163], v14 offset:20992
v_accvgpr_write_b32 a81, v193
v_accvgpr_write_b32 a82, v194
v_accvgpr_write_b32 a83, v195
v_mfma_f32_32x32x16_bf16 v[48:63], a[144:147], v[116:119], v[48:63]
ds_read_b64_tr_b16 a[164:165], v14 offset:3072
ds_read_b64_tr_b16 a[166:167], v14 offset:3584
buffer_load_dwordx4 v1, s[36:39], s49 offen offset:2048 sc1 lds
v_accvgpr_write_b32 a84, v196
v_accvgpr_write_b32 a85, v197
v_accvgpr_write_b32 a86, v198
s_waitcnt lgkmcnt(6)
v_mfma_f32_32x32x16_bf16 v[48:63], a[148:151], v[120:123], v[48:63]
ds_read_b64_tr_b16 a[168:169], v14 offset:21504
ds_read_b64_tr_b16 a[170:171], v14 offset:22016
v_accvgpr_write_b32 a87, v199
v_accvgpr_write_b32 a88, v200
v_accvgpr_write_b32 a89, v201
v_mfma_f32_32x32x16_bf16 v[48:63], a[152:155], v[124:127], v[48:63]
ds_read_b64_tr_b16 a[144:145], v14 offset:4096
ds_read_b64_tr_b16 a[146:147], v14 offset:4608
v_accvgpr_write_b32 a90, v202
v_accvgpr_write_b32 a91, v203
v_accvgpr_write_b32 a92, v204
v_accvgpr_write_b32 a93, v205
s_waitcnt lgkmcnt(6)
v_mfma_f32_32x32x16_bf16 v[48:63], a[156:159], v[128:131], v[48:63]
ds_read_b64_tr_b16 a[148:149], v14 offset:22528
ds_read_b64_tr_b16 a[150:151], v14 offset:23040
buffer_load_dwordx4 v1, s[36:39], s49 offen offset:3072 sc1 lds
v_accvgpr_write_b32 a94, v206
v_accvgpr_write_b32 a95, v207
v_mfma_f32_32x32x16_bf16 v[48:63], a[160:163], v[132:135], v[48:63]
ds_read_b64_tr_b16 a[152:153], v14 offset:5120
ds_read_b64_tr_b16 a[154:155], v14 offset:5632
v_accvgpr_write_b32 a96, v208
v_accvgpr_write_b32 a97, v209
v_accvgpr_write_b32 a98, v210
v_accvgpr_write_b32 a99, v211
s_waitcnt lgkmcnt(6)
v_mfma_f32_32x32x16_bf16 v[48:63], a[164:167], v[136:139], v[48:63]
ds_read_b64_tr_b16 a[156:157], v14 offset:23552
ds_read_b64_tr_b16 a[158:159], v14 offset:24064
s_add_u32 s49, s78, 8192
s_add_u32 m0, s72, 8192
v_accvgpr_write_b32 a100, v212
v_mfma_f32_32x32x16_bf16 v[48:63], a[168:171], v[140:143], v[48:63]
ds_read_b64_tr_b16 a[160:161], v14 offset:6144
ds_read_b64_tr_b16 a[162:163], v14 offset:6656
buffer_load_dwordx4 v1, s[36:39], s49 offen offset:0 sc1 lds
v_accvgpr_write_b32 a101, v213
v_accvgpr_write_b32 a102, v214
v_accvgpr_write_b32 a103, v215
s_waitcnt lgkmcnt(6)
v_mfma_f32_32x32x16_bf16 v[48:63], a[144:147], v[144:147], v[48:63]
ds_read_b64_tr_b16 a[164:165], v14 offset:24576
ds_read_b64_tr_b16 a[166:167], v14 offset:25088
v_accvgpr_write_b32 a104, v216
v_accvgpr_write_b32 a105, v217
v_accvgpr_write_b32 a106, v218
v_mfma_f32_32x32x16_bf16 v[48:63], a[148:151], v[148:151], v[48:63]
ds_read_b64_tr_b16 a[168:169], v14 offset:7168
ds_read_b64_tr_b16 a[170:171], v14 offset:7680
v_accvgpr_write_b32 a107, v219
v_accvgpr_write_b32 a108, v220
v_accvgpr_write_b32 a109, v221
v_accvgpr_write_b32 a110, v222
s_waitcnt lgkmcnt(6)
v_mfma_f32_32x32x16_bf16 v[48:63], a[152:155], v[152:155], v[48:63]
ds_read_b64_tr_b16 a[144:145], v14 offset:25600
ds_read_b64_tr_b16 a[146:147], v14 offset:26112
v_accvgpr_write_b32 a111, v223
v_accvgpr_write_b32 a112, v224
v_accvgpr_write_b32 a113, v225
v_mfma_f32_32x32x16_bf16 v[48:63], a[156:159], v[156:159], v[48:63]
ds_read_b64_tr_b16 a[148:149], v14 offset:8192
ds_read_b64_tr_b16 a[150:151], v14 offset:8704
v_accvgpr_write_b32 a114, v226
v_accvgpr_write_b32 a115, v227
v_accvgpr_write_b32 a116, v228
v_accvgpr_write_b32 a117, v229
s_waitcnt lgkmcnt(6)
v_mfma_f32_32x32x16_bf16 v[48:63], a[160:163], v[160:163], v[48:63]
ds_read_b64_tr_b16 a[152:153], v14 offset:26624
ds_read_b64_tr_b16 a[154:155], v14 offset:27136
s_waitcnt vmcnt(13)
s_barrier
v_accvgpr_write_b32 a118, v230
v_mfma_f32_32x32x16_bf16 v[48:63], a[164:167], v[164:167], v[48:63]
v_add_u32 v14, 110592, v12
ds_read_b64_tr_b16 a[156:157], v14 offset:0
ds_read_b64_tr_b16 a[158:159], v14 offset:512
v_accvgpr_write_b32 a119, v231
v_accvgpr_write_b32 a120, v232
v_accvgpr_write_b32 a121, v233
s_waitcnt lgkmcnt(6)
v_mfma_f32_32x32x16_bf16 v[48:63], a[168:171], v[168:171], v[48:63]
ds_read_b64_tr_b16 a[160:161], v14 offset:18432
ds_read_b64_tr_b16 a[162:163], v14 offset:18944
s_add_u32 s49, s78, 36864
s_add_u32 m0, s72, 36864
v_bfe_u32 v97, v1, 8, 1
v_mfma_f32_32x32x16_bf16 v[48:63], a[144:147], v[172:175], v[48:63]
ds_read_b64_tr_b16 a[164:165], v14 offset:1024
ds_read_b64_tr_b16 a[166:167], v14 offset:1536
v_mul_u32_u24 v96, 2688, v97
v_lshrrev_b32 v97, 9, v1
v_lshl_add_u32 v96, v97, 8, v96
v_bfe_u32 v97, v1, 6, 2
s_waitcnt lgkmcnt(6)
v_mfma_f32_32x32x16_bf16 v[48:63], a[148:151], v[176:179], v[48:63]
ds_read_b64_tr_b16 a[168:169], v14 offset:19456
ds_read_b64_tr_b16 a[170:171], v14 offset:19968
v_lshl_add_u32 v96, v97, 5, v96
v_bfe_u32 v97, v1, 4, 2
v_lshl_add_u32 v96, v97, 3, v96
v_mfma_f32_32x32x16_bf16 v[48:63], a[152:155], v[180:183], v[48:63]
ds_read_b64_tr_b16 a[144:145], v14 offset:2048
ds_read_b64_tr_b16 a[146:147], v14 offset:2560
v_add_u32 v96, 152576, v96
v_add_u32 v97, 147456, v13
ds_read_b64_tr_b16 a[184:185], v97 offset:0
ds_read_b64_tr_b16 a[196:197], v96 offset:0
s_waitcnt lgkmcnt(8)
v_mfma_f32_32x32x16_bf16 v[32:47], a[156:159], v[184:187], v[32:47]
ds_read_b64_tr_b16 a[148:149], v14 offset:20480
ds_read_b64_tr_b16 a[150:151], v14 offset:20992
buffer_load_dwordx4 v1, s[36:39], s49 offen offset:0 sc1 lds
ds_read_b64_tr_b16 a[186:187], v97 offset:256
ds_read_b64_tr_b16 a[198:199], v96 offset:128
v_mfma_f32_32x32x16_bf16 v[32:47], a[160:163], v[188:191], v[32:47]
ds_read_b64_tr_b16 a[152:153], v14 offset:3072
ds_read_b64_tr_b16 a[154:155], v14 offset:3584
ds_read_b64_tr_b16 a[188:189], v97 offset:1024
ds_read_b64_tr_b16 a[200:201], v96 offset:512
ds_read_b64_tr_b16 a[190:191], v97 offset:1280
ds_read_b64_tr_b16 a[202:203], v96 offset:640
s_waitcnt lgkmcnt(14)
v_mfma_f32_32x32x16_bf16 v[32:47], a[164:167], v[192:195], v[32:47]
ds_read_b64_tr_b16 a[156:157], v14 offset:21504
ds_read_b64_tr_b16 a[158:159], v14 offset:22016
buffer_load_dwordx4 v1, s[36:39], s49 offen offset:1024 sc1 lds
ds_read_b64_tr_b16 a[192:193], v97 offset:2048
ds_read_b64_tr_b16 a[204:205], v96 offset:1024
v_mfma_f32_32x32x16_bf16 v[32:47], a[168:171], v[196:199], v[32:47]
ds_read_b64_tr_b16 a[160:161], v14 offset:4096
ds_read_b64_tr_b16 a[162:163], v14 offset:4608
ds_read_b64_tr_b16 a[194:195], v97 offset:2304
ds_read_b64_tr_b16 a[206:207], v96 offset:1152
v_accvgpr_write_b32 a122, v234
v_accvgpr_write_b32 a123, v235
s_waitcnt lgkmcnt(15)
v_mfma_f32_32x32x16_bf16 v[32:47], a[144:147], v[200:203], v[32:47]
ds_read_b64_tr_b16 a[164:165], v14 offset:22528
ds_read_b64_tr_b16 a[166:167], v14 offset:23040
v_accvgpr_write_b32 a124, v236
v_accvgpr_write_b32 a125, v237
v_accvgpr_write_b32 a126, v238
v_mfma_f32_32x32x16_bf16 v[32:47], a[148:151], v[204:207], v[32:47]
ds_read_b64_tr_b16 a[168:169], v14 offset:5120
ds_read_b64_tr_b16 a[170:171], v14 offset:5632
buffer_load_dwordx4 v1, s[36:39], s49 offen offset:2048 sc1 lds
v_accvgpr_write_b32 a127, v239
v_accvgpr_write_b32 a128, v240
v_accvgpr_write_b32 a129, v241
s_waitcnt lgkmcnt(10)
v_mfma_f32_32x32x16_bf16 v[32:47], a[152:155], v[208:211], v[32:47]
ds_read_b64_tr_b16 a[144:145], v14 offset:23552
ds_read_b64_tr_b16 a[146:147], v14 offset:24064
v_accvgpr_write_b32 a130, v242
v_accvgpr_write_b32 a131, v243
v_accvgpr_write_b32 a132, v244
v_mfma_f32_32x32x16_bf16 v[32:47], a[156:159], v[212:215], v[32:47]
ds_read_b64_tr_b16 a[148:149], v14 offset:6144
ds_read_b64_tr_b16 a[150:151], v14 offset:6656
v_accvgpr_write_b32 a133, v245
v_accvgpr_write_b32 a134, v246
v_accvgpr_write_b32 a135, v247
v_accvgpr_write_b32 a136, v248
s_waitcnt lgkmcnt(6)
v_mfma_f32_32x32x16_bf16 v[32:47], a[160:163], v[216:219], v[32:47]
ds_read_b64_tr_b16 a[152:153], v14 offset:24576
ds_read_b64_tr_b16 a[154:155], v14 offset:25088
buffer_load_dwordx4 v1, s[36:39], s49 offen offset:3072 sc1 lds
v_accvgpr_write_b32 a137, v249
v_accvgpr_write_b32 a138, v250
v_mfma_f32_32x32x16_bf16 v[32:47], a[164:167], v[220:223], v[32:47]
ds_read_b64_tr_b16 a[156:157], v14 offset:7168
ds_read_b64_tr_b16 a[158:159], v14 offset:7680
v_accvgpr_write_b32 a139, v251
v_accvgpr_write_b32 a140, v252
v_accvgpr_write_b32 a141, v253
v_accvgpr_write_b32 a142, v254
s_waitcnt lgkmcnt(6)
v_mfma_f32_32x32x16_bf16 v[32:47], a[168:171], v[224:227], v[32:47]
ds_read_b64_tr_b16 a[160:161], v14 offset:25600
ds_read_b64_tr_b16 a[162:163], v14 offset:26112
s_add_u32 s49, s78, 40960
s_add_u32 m0, s72, 40960
v_accvgpr_write_b32 a143, v255
v_mfma_f32_32x32x16_bf16 v[32:47], a[144:147], v[228:231], v[32:47]
ds_read_b64_tr_b16 a[164:165], v14 offset:8192
ds_read_b64_tr_b16 a[166:167], v14 offset:8704
buffer_load_dwordx4 v1, s[36:39], s49 offen offset:0 sc1 lds
v_and_b32 v28, 16, v1
v_mov_b32 v29, 0x3f80
v_lshlrev_b32 v29, v28, v29
s_waitcnt lgkmcnt(6)
v_mfma_f32_32x32x16_bf16 v[32:47], a[148:151], v[232:235], v[32:47]
ds_read_b64_tr_b16 a[168:169], v14 offset:26624
ds_read_b64_tr_b16 a[170:171], v14 offset:27136
v_bfe_u32 v28, v1, 5, 3
v_cmp_eq_u32 s[64:65], 0, v28
s_nop 1
v_cndmask_b32 v30, 0, v29, s[64:65]
v_mfma_f32_32x32x16_bf16 v[32:47], a[152:155], v[236:239], v[32:47]
v_xor_b32 v14, 64, v14
ds_read_b64_tr_b16 a[144:145], v14 offset:0
ds_read_b64_tr_b16 a[146:147], v14 offset:512
v_accvgpr_write_b32 a176, v30
v_cmp_eq_u32 s[64:65], 1, v28
s_nop 1
v_cndmask_b32 v30, 0, v29, s[64:65]
s_waitcnt lgkmcnt(6)
v_mfma_f32_32x32x16_bf16 v[32:47], a[156:159], v[240:243], v[32:47]
ds_read_b64_tr_b16 a[148:149], v14 offset:18432
ds_read_b64_tr_b16 a[150:151], v14 offset:18944
buffer_load_dwordx4 v1, s[36:39], s49 offen offset:1024 sc1 lds
v_accvgpr_write_b32 a177, v30
v_cmp_eq_u32 s[64:65], 2, v28
v_mfma_f32_32x32x16_bf16 v[32:47], a[160:163], v[244:247], v[32:47]
ds_read_b64_tr_b16 a[152:153], v14 offset:1024
ds_read_b64_tr_b16 a[154:155], v14 offset:1536
v_cndmask_b32 v30, 0, v29, s[64:65]
v_accvgpr_write_b32 a178, v30
v_cmp_eq_u32 s[64:65], 3, v28
s_nop 1
v_cndmask_b32 v30, 0, v29, s[64:65]
s_waitcnt lgkmcnt(6)
v_mfma_f32_32x32x16_bf16 v[32:47], a[164:167], v[248:251], v[32:47]
ds_read_b64_tr_b16 a[156:157], v14 offset:19456
ds_read_b64_tr_b16 a[158:159], v14 offset:19968
v_accvgpr_write_b32 a179, v30
v_bfe_u32 v26, v1, 4, 4
s_mul_i32 s60, s67, 48
v_mfma_f32_32x32x16_bf16 v[32:47], a[168:171], v[252:255], v[32:47]
ds_read_b64_tr_b16 a[160:161], v14 offset:2048
ds_read_b64_tr_b16 a[162:163], v14 offset:2560
buffer_load_dwordx4 v1, s[36:39], s49 offen offset:2048 sc1 lds
s_add_u32 s60, s60, 0
v_add_u32 v26, s60, v26
s_movk_i32 s60, 90
s_waitcnt lgkmcnt(6)
v_mfma_f32_32x32x16_bf16 v[48:63], a[144:147], v[184:187], v[48:63]
ds_read_b64_tr_b16 a[164:165], v14 offset:20480
ds_read_b64_tr_b16 a[166:167], v14 offset:20992
v_cmp_le_u32 s[64:65], s60, v26
v_lshrrev_b32 v29, 8, v1
v_lshrrev_b32 v31, 1, v29
v_mfma_f32_32x32x16_bf16 v[48:63], a[148:151], v[188:191], v[48:63]
ds_read_b64_tr_b16 a[168:169], v14 offset:3072
ds_read_b64_tr_b16 a[170:171], v14 offset:3584
v_lshl_add_u32 v31, v31, 8, v26
s_movk_i32 s60, 180
v_cndmask_b32 v27, 0, 1, s[64:65]
v_cmp_gt_u32 s[62:63], s60, v31
s_waitcnt lgkmcnt(6)
v_mfma_f32_32x32x16_bf16 v[48:63], a[152:155], v[192:195], v[48:63]
ds_read_b64_tr_b16 a[144:145], v14 offset:21504
ds_read_b64_tr_b16 a[146:147], v14 offset:22016
buffer_load_dwordx4 v1, s[36:39], s49 offen offset:3072 sc1 lds
v_cvt_pk_bf16_f32 v80, v32, v33
v_cvt_pk_bf16_f32 v81, v34, v35
v_mfma_f32_32x32x16_bf16 v[48:63], a[156:159], v[196:199], v[48:63]
ds_read_b64_tr_b16 a[148:149], v14 offset:4096
ds_read_b64_tr_b16 a[150:151], v14 offset:4608
v_cvt_pk_bf16_f32 v82, v36, v37
v_cvt_pk_bf16_f32 v83, v38, v39
v_cvt_pk_bf16_f32 v84, v40, v41
v_cvt_pk_bf16_f32 v85, v42, v43
s_waitcnt lgkmcnt(6)
v_mfma_f32_32x32x16_bf16 v[48:63], a[160:163], v[200:203], v[48:63]
ds_read_b64_tr_b16 a[152:153], v14 offset:22528
ds_read_b64_tr_b16 a[154:155], v14 offset:23040
s_add_u32 s49, s78, 45056
s_add_u32 m0, s72, 45056
v_cvt_pk_bf16_f32 v86, v44, v45
v_mfma_f32_32x32x16_bf16 v[48:63], a[164:167], v[204:207], v[48:63]
ds_read_b64_tr_b16 a[156:157], v14 offset:5120
ds_read_b64_tr_b16 a[158:159], v14 offset:5632
buffer_load_dwordx4 v1, s[36:39], s49 offen offset:0 sc1 lds
v_cvt_pk_bf16_f32 v87, v46, v47
v_pk_max_i16 v80, v80, 0
v_pk_max_i16 v81, v81, 0
s_waitcnt lgkmcnt(6)
v_mfma_f32_32x32x16_bf16 v[48:63], a[168:171], v[208:211], v[48:63]
ds_read_b64_tr_b16 a[160:161], v14 offset:23552
ds_read_b64_tr_b16 a[162:163], v14 offset:24064
v_pk_max_i16 v82, v82, 0
v_pk_max_i16 v83, v83, 0
v_pk_max_i16 v84, v84, 0
v_mfma_f32_32x32x16_bf16 v[48:63], a[144:147], v[212:215], v[48:63]
ds_read_b64_tr_b16 a[164:165], v14 offset:6144
ds_read_b64_tr_b16 a[166:167], v14 offset:6656
v_pk_max_i16 v85, v85, 0
v_pk_max_i16 v86, v86, 0
v_pk_max_i16 v87, v87, 0
s_add_u32 s73, s73, 2097152
s_waitcnt lgkmcnt(6)
v_mfma_f32_32x32x16_bf16 v[48:63], a[148:151], v[216:219], v[48:63]
ds_read_b64_tr_b16 a[168:169], v14 offset:24576
ds_read_b64_tr_b16 a[170:171], v14 offset:25088
buffer_load_dword a182, v21, s[20:23], s79 offen offset:256
buffer_store_dwordx4 v[80:83], v1, s[36:39], s73 offen offset:0 sc1
buffer_store_dwordx4 v[84:87], v1, s[36:39], s73 offen offset:1024 sc1
v_mfma_f32_32x32x16_bf16 v[48:63], a[152:155], v[220:223], v[48:63]
ds_read_b64_tr_b16 a[144:145], v14 offset:7168
ds_read_b64_tr_b16 a[146:147], v14 offset:7680
v_mul_u32_u24 v30, 90, v27
v_sub_u32 v26, v26, v30
v_mul_u32_u24 v28, 3641, v26
v_lshrrev_b32 v28, 16, v28
s_waitcnt lgkmcnt(6)
v_mfma_f32_32x32x16_bf16 v[48:63], a[156:159], v[224:227], v[48:63]
ds_read_b64_tr_b16 a[148:149], v14 offset:25600
ds_read_b64_tr_b16 a[150:151], v14 offset:26112
v_mul_u32_u24 v30, 18, v28
v_sub_u32 v26, v26, v30
v_lshl_add_u32 v26, v26, 1, v29
v_mfma_f32_32x32x16_bf16 v[48:63], a[160:163], v[228:231], v[48:63]
ds_read_b64_tr_b16 a[152:153], v14 offset:8192
ds_read_b64_tr_b16 a[154:155], v14 offset:8704
v_lshrrev_b32 v30, 3, v26
v_and_b32 v26, 7, v26
v_lshl_add_u32 v26, v30, 4, v26
v_lshl_add_u32 v26, v27, 3, v26
s_waitcnt lgkmcnt(6)
v_mfma_f32_32x32x16_bf16 v[48:63], a[164:167], v[232:235], v[48:63]
ds_read_b64_tr_b16 a[156:157], v14 offset:26624
ds_read_b64_tr_b16 a[158:159], v14 offset:27136
s_waitcnt vmcnt(12)
s_barrier
v_lshlrev_b32 v29, 6, v26
v_mfma_f32_32x32x16_bf16 v[48:63], a[168:171], v[236:239], v[48:63]
v_add_u32 v14, 0, v13
ds_read_b64_tr_b16 a[160:161], v14 offset:0
ds_read_b64_tr_b16 a[162:163], v14 offset:256
buffer_store_dwordx2 a[180:181], v25, s[36:39], s55 offen sc1
v_lshlrev_b32 v100, 4, v0
v_add_u32 v100, 147456, v100
s_waitcnt lgkmcnt(6)
v_mfma_f32_32x32x16_bf16 v[48:63], a[144:147], v[240:243], v[48:63]
ds_read_b64_tr_b16 a[164:165], v14 offset:1024
ds_read_b64_tr_b16 a[166:167], v14 offset:1280
v_mov_b32 v96, 0
v_mov_b32 v97, 0
v_mov_b32 v98, 0
v_mfma_f32_32x32x16_bf16 v[48:63], a[148:151], v[244:247], v[48:63]
ds_read_b64_tr_b16 a[168:169], v14 offset:2048
ds_read_b64_tr_b16 a[170:171], v14 offset:2304
v_mov_b32 v99, 0
ds_write_b128 v100, v[96:99] offset:0
ds_write_b128 v100, v[96:99] offset:4096
ds_write_b128 v100, v[96:99] offset:8192
s_waitcnt lgkmcnt(9)
v_mfma_f32_32x32x16_bf16 v[48:63], a[152:155], v[248:251], v[48:63]
ds_read_b64_tr_b16 a[144:145], v14 offset:3072
ds_read_b64_tr_b16 a[146:147], v14 offset:3328
v_lshrrev_b32 v100, 8, v1
v_mul_u32_u24 v2, 1152, v100
v_lshlrev_b32 v100, 6, v100
v_mfma_f32_32x32x16_bf16 v[48:63], a[156:159], v[252:255], v[48:63]
ds_read_b64_tr_b16 a[148:149], v14 offset:4096
ds_read_b64_tr_b16 a[150:151], v14 offset:4352
v_and_b32 v101, 0xf0, v1
v_xor_b32 v100, v100, v101
v_add_u32 v2, v2, v100
v_add_u32 v3, 17408, v2
s_waitcnt lgkmcnt(9)
v_mfma_f32_32x32x16_bf16 v[32:47], a[160:163], v[112:115], 0
ds_read_b64_tr_b16 a[152:153], v14 offset:5120
ds_read_b64_tr_b16 a[154:155], v14 offset:5376
s_add_u32 s49, s78, 73728
s_add_u32 m0, s72, 73728
v_add_u32 v4, 34816, v2
v_mfma_f32_32x32x16_bf16 v[32:47], a[164:167], v[116:119], v[32:47]
ds_read_b64_tr_b16 a[156:157], v14 offset:6144
ds_read_b64_tr_b16 a[158:159], v14 offset:6400
v_add_u32 v5, 52224, v2
v_add_u32 v6, 73728, v2
v_add_u32 v7, 91136, v2
v_add_u32 v8, 108544, v2
s_waitcnt lgkmcnt(6)
v_mfma_f32_32x32x16_bf16 v[32:47], a[168:171], v[120:123], v[32:47]
ds_read_b64_tr_b16 a[160:161], v14 offset:7168
ds_read_b64_tr_b16 a[162:163], v14 offset:7424
v_cvt_pk_bf16_f32 v88, v48, v49
v_cvt_pk_bf16_f32 v89, v50, v51
v_cvt_pk_bf16_f32 v90, v52, v53
v_mfma_f32_32x32x16_bf16 v[32:47], a[144:147], v[124:127], v[32:47]
ds_read_b64_tr_b16 a[164:165], v14 offset:8192
ds_read_b64_tr_b16 a[166:167], v14 offset:8448
v_cvt_pk_bf16_f32 v91, v54, v55
v_cvt_pk_bf16_f32 v92, v56, v57
v_cvt_pk_bf16_f32 v93, v58, v59
v_cvt_pk_bf16_f32 v94, v60, v61
s_waitcnt lgkmcnt(6)
v_mfma_f32_32x32x16_bf16 v[32:47], a[148:151], v[128:131], v[32:47]
ds_read_b64_tr_b16 a[168:169], v14 offset:9216
ds_read_b64_tr_b16 a[170:171], v14 offset:9472
v_cvt_pk_bf16_f32 v95, v62, v63
v_pk_max_i16 v88, v88, 0
v_pk_max_i16 v89, v89, 0
v_mfma_f32_32x32x16_bf16 v[32:47], a[152:155], v[132:135], v[32:47]
ds_read_b64_tr_b16 a[144:145], v14 offset:10240
ds_read_b64_tr_b16 a[146:147], v14 offset:10496
v_pk_max_i16 v90, v90, 0
v_pk_max_i16 v91, v91, 0
v_pk_max_i16 v92, v92, 0
v_pk_max_i16 v93, v93, 0
s_waitcnt lgkmcnt(6)
v_mfma_f32_32x32x16_bf16 v[32:47], a[156:159], v[136:139], v[32:47]
ds_read_b64_tr_b16 a[148:149], v14 offset:11264
ds_read_b64_tr_b16 a[150:151], v14 offset:11520
buffer_load_dwordx4 v1, s[36:39], s49 offen offset:0 sc1 lds
v_pk_max_i16 v94, v94, 0
v_pk_max_i16 v95, v95, 0
v_mfma_f32_32x32x16_bf16 v[32:47], a[160:163], v[140:143], v[32:47]
ds_read_b64_tr_b16 a[152:153], v14 offset:12288
ds_read_b64_tr_b16 a[154:155], v14 offset:12544
s_add_u32 s73, s73, 2097152
buffer_store_dwordx4 v[88:91], v1, s[36:39], s73 offen offset:0 sc1
buffer_store_dwordx4 v[92:95], v1, s[36:39], s73 offen offset:1024 sc1
v_add_u32 v9, 125952, v2
s_waitcnt lgkmcnt(6)
v_mfma_f32_32x32x16_bf16 v[32:47], a[164:167], v[144:147], v[32:47]
ds_read_b64_tr_b16 a[156:157], v14 offset:13312
ds_read_b64_tr_b16 a[158:159], v14 offset:13568
buffer_load_dwordx4 v1, s[36:39], s49 offen offset:1024 sc1 lds
v_add_u32 v10, 147456, v2
v_and_b32 v100, 0x3f, v12
v_mfma_f32_32x32x16_bf16 v[32:47], a[168:171], v[148:151], v[32:47]
ds_read_b64_tr_b16 a[160:161], v14 offset:14336
ds_read_b64_tr_b16 a[162:163], v14 offset:14592
v_bfe_u32 v101, v1, 6, 2
v_mul_u32_u24 v101, 320, v101
v_add_u32 v100, v100, v101
v_lshrrev_b32 v101, 9, v1
s_waitcnt lgkmcnt(6)
v_mfma_f32_32x32x16_bf16 v[32:47], a[144:147], v[152:155], v[32:47]
ds_read_b64_tr_b16 a[164:165], v14 offset:15360
ds_read_b64_tr_b16 a[166:167], v14 offset:15616
v_mul_u32_u24 v101, 9216, v101
v_add_u32 v100, v100, v101
s_and_b32 s54, s70, 1
v_mfma_f32_32x32x16_bf16 v[32:47], a[148:151], v[156:159], v[32:47]
ds_read_b64_tr_b16 a[168:169], v14 offset:16384
ds_read_b64_tr_b16 a[170:171], v14 offset:16640
buffer_load_dwordx4 v1, s[36:39], s49 offen offset:2048 sc1 lds
s_lshl_b32 s54, s54, 7
s_xor_b32 s54, s54, 128
v_xor_b32 v25, s54, v100
s_waitcnt lgkmcnt(6)
v_mfma_f32_32x32x16_bf16 v[32:47], a[152:155], v[160:163], v[32:47]
ds_read_b64_tr_b16 a[144:145], v14 offset:17408
ds_read_b64_tr_b16 a[146:147], v14 offset:17664
v_lshl_add_u32 v29, v28, 4, v29
v_lshl_add_u32 v29, v27, 3, v29
v_cmp_gt_u32 s[64:65], 4, v28
v_mfma_f32_32x32x16_bf16 v[32:47], a[156:159], v[164:167], v[32:47]
ds_read_b64_tr_b16 a[148:149], v14 offset:18432
ds_read_b64_tr_b16 a[150:151], v14 offset:18688
buffer_load_dwordx4 v1, s[36:39], s49 offen offset:3072 sc1 lds
v_add_u32 v29, 147456, v29
v_lshlrev_b32 v30, 5, v26
v_lshl_add_u32 v30, v27, 4, v30
s_waitcnt lgkmcnt(6)
v_mfma_f32_32x32x16_bf16 v[32:47], a[160:163], v[168:171], v[32:47]
ds_read_b64_tr_b16 a[152:153], v14 offset:19456
ds_read_b64_tr_b16 a[154:155], v14 offset:19712
v_add_u32 v30, 152576, v30
v_cndmask_b32 v31, v30, v29, s[64:65]
v_add_u32 v30, 2696, v30
v_mfma_f32_32x32x16_bf16 v[32:47], a[164:167], v[172:175], v[32:47]
ds_read_b64_tr_b16 a[156:157], v14 offset:20480
ds_read_b64_tr_b16 a[158:159], v14 offset:20736
s_add_u32 s49, s78, 77824
s_add_u32 m0, s72, 77824
v_cndmask_b32 v26, v30, v29, s[64:65]
v_mov_b32 v30, 161792
s_waitcnt lgkmcnt(6)
v_mfma_f32_32x32x16_bf16 v[32:47], a[168:171], v[176:179], v[32:47]
ds_read_b64_tr_b16 a[160:161], v14 offset:21504
ds_read_b64_tr_b16 a[162:163], v14 offset:21760
buffer_load_dwordx4 v1, s[36:39], s49 offen offset:0 sc1 lds
v_cndmask_b32 v31, v30, v31, s[62:63]
v_cndmask_b32 v26, v30, v26, s[62:63]
v_mfma_f32_32x32x16_bf16 v[32:47], a[144:147], v[180:183], v[32:47]
ds_read_b64_tr_b16 a[164:165], v14 offset:22528
ds_read_b64_tr_b16 a[166:167], v14 offset:22784
v_accvgpr_write_b32 a236, v31
v_accvgpr_write_b32 a237, v26
v_bfe_u32 v26, v1, 4, 4
s_mul_i32 s60, s67, 48
s_waitcnt lgkmcnt(6)
v_mfma_f32_32x32x16_bf16 v[32:47], a[148:151], v[184:187], v[32:47]
ds_read_b64_tr_b16 a[168:169], v14 offset:23552
ds_read_b64_tr_b16 a[170:171], v14 offset:23808
buffer_load_dwordx4 v1, s[36:39], s49 offen offset:1024 sc1 lds
s_add_u32 s60, s60, 16
v_add_u32 v26, s60, v26
v_mfma_f32_32x32x16_bf16 v[32:47], a[152:155], v[188:191], v[32:47]
ds_read_b64_tr_b16 a[144:145], v14 offset:24576
ds_read_b64_tr_b16 a[146:147], v14 offset:24832
s_movk_i32 s60, 90
v_cmp_le_u32 s[64:65], s60, v26
v_lshrrev_b32 v29, 8, v1
v_lshrrev_b32 v31, 1, v29
s_waitcnt lgkmcnt(6)
v_mfma_f32_32x32x16_bf16 v[32:47], a[156:159], v[192:195], v[32:47]
ds_read_b64_tr_b16 a[148:149], v14 offset:25600
ds_read_b64_tr_b16 a[150:151], v14 offset:25856
v_lshl_add_u32 v31, v31, 8, v26
s_movk_i32 s60, 180
v_cndmask_b32 v27, 0, 1, s[64:65]
v_mfma_f32_32x32x16_bf16 v[32:47], a[160:163], v[196:199], v[32:47]
ds_read_b64_tr_b16 a[152:153], v14 offset:26624
ds_read_b64_tr_b16 a[154:155], v14 offset:26880
buffer_load_dwordx4 v1, s[36:39], s49 offen offset:2048 sc1 lds
v_cmp_gt_u32 s[62:63], s60, v31
v_mul_u32_u24 v30, 90, v27
v_sub_u32 v26, v26, v30
s_waitcnt lgkmcnt(6)
v_mfma_f32_32x32x16_bf16 v[32:47], a[164:167], v[200:203], v[32:47]
ds_read_b64_tr_b16 a[156:157], v14 offset:27648
ds_read_b64_tr_b16 a[158:159], v14 offset:27904
v_mul_u32_u24 v28, 3641, v26
v_lshrrev_b32 v28, 16, v28
v_mul_u32_u24 v30, 18, v28
v_mfma_f32_32x32x16_bf16 v[32:47], a[168:171], v[204:207], v[32:47]
ds_read_b64_tr_b16 a[160:161], v14 offset:28672
ds_read_b64_tr_b16 a[162:163], v14 offset:28928
buffer_load_dwordx4 v1, s[36:39], s49 offen offset:3072 sc1 lds
v_sub_u32 v26, v26, v30
v_lshl_add_u32 v26, v26, 1, v29
v_lshrrev_b32 v30, 3, v26
s_waitcnt lgkmcnt(6)
v_mfma_f32_32x32x16_bf16 v[32:47], a[144:147], v[208:211], v[32:47]
ds_read_b64_tr_b16 a[164:165], v14 offset:29696
ds_read_b64_tr_b16 a[166:167], v14 offset:29952
v_and_b32 v26, 7, v26
v_lshl_add_u32 v26, v30, 4, v26
v_lshl_add_u32 v26, v27, 3, v26
v_mfma_f32_32x32x16_bf16 v[32:47], a[148:151], v[212:215], v[32:47]
ds_read_b64_tr_b16 a[168:169], v14 offset:30720
ds_read_b64_tr_b16 a[170:171], v14 offset:30976
s_add_u32 s49, s78, 81920
s_add_u32 m0, s72, 81920
v_lshlrev_b32 v29, 6, v26
v_lshl_add_u32 v29, v28, 4, v29
s_waitcnt lgkmcnt(6)
v_mfma_f32_32x32x16_bf16 v[32:47], a[152:155], v[216:219], v[32:47]
ds_read_b64_tr_b16 a[144:145], v14 offset:31744
ds_read_b64_tr_b16 a[146:147], v14 offset:32000
buffer_load_dwordx4 v1, s[36:39], s49 offen offset:0 sc1 lds
v_lshl_add_u32 v29, v27, 3, v29
v_cmp_gt_u32 s[64:65], 4, v28
v_mfma_f32_32x32x16_bf16 v[32:47], a[156:159], v[220:223], v[32:47]
ds_read_b64_tr_b16 a[148:149], v14 offset:32768
ds_read_b64_tr_b16 a[150:151], v14 offset:33024
v_add_u32 v29, 147456, v29
v_lshlrev_b32 v30, 5, v26
v_lshl_add_u32 v30, v27, 4, v30
v_add_u32 v30, 152576, v30
s_waitcnt lgkmcnt(6)
v_mfma_f32_32x32x16_bf16 v[32:47], a[160:163], v[224:227], v[32:47]
ds_read_b64_tr_b16 a[152:153], v14 offset:33792
ds_read_b64_tr_b16 a[154:155], v14 offset:34048
v_cndmask_b32 v31, v30, v29, s[64:65]
v_add_u32 v30, 2696, v30
v_cndmask_b32 v26, v30, v29, s[64:65]
v_mfma_f32_32x32x16_bf16 v[32:47], a[164:167], v[228:231], v[32:47]
ds_read_b64_tr_b16 a[156:157], v14 offset:34816
ds_read_b64_tr_b16 a[158:159], v14 offset:35072
v_mov_b32 v30, 161792
v_cndmask_b32 v31, v30, v31, s[62:63]
v_cndmask_b32 v26, v30, v26, s[62:63]
v_accvgpr_write_b32 a238, v31
s_waitcnt lgkmcnt(6)
v_mfma_f32_32x32x16_bf16 v[32:47], a[168:171], v[232:235], v[32:47]
ds_read_b64_tr_b16 a[160:161], v14 offset:35840
ds_read_b64_tr_b16 a[162:163], v14 offset:36096
s_waitcnt vmcnt(15)
s_barrier
v_accvgpr_write_b32 a239, v26
v_mfma_f32_32x32x16_bf16 v[32:47], a[144:147], v[236:239], v[32:47]
v_add_u32 v14, 36864, v13
ds_read_b64_tr_b16 a[164:165], v14 offset:0
ds_read_b64_tr_b16 a[166:167], v14 offset:256
v_bfe_u32 v26, v1, 4, 4
s_mul_i32 s60, s67, 48
s_add_u32 s60, s60, 32
s_waitcnt lgkmcnt(6)
v_mfma_f32_32x32x16_bf16 v[32:47], a[148:151], v[240:243], v[32:47]
ds_read_b64_tr_b16 a[168:169], v14 offset:1024
ds_read_b64_tr_b16 a[170:171], v14 offset:1280
s_add_u32 s49, s78, 110592
s_add_u32 m0, s72, 110592
v_add_u32 v26, s60, v26
v_mfma_f32_32x32x16_bf16 v[32:47], a[152:155], v[244:247], v[32:47]
ds_read_b64_tr_b16 a[144:145], v14 offset:2048
ds_read_b64_tr_b16 a[146:147], v14 offset:2304
s_movk_i32 s60, 90
v_cmp_le_u32 s[64:65], s60, v26
v_lshrrev_b32 v29, 8, v1
v_lshrrev_b32 v31, 1, v29
s_waitcnt lgkmcnt(6)
v_mfma_f32_32x32x16_bf16 v[32:47], a[156:159], v[248:251], v[32:47]
ds_read_b64_tr_b16 a[148:149], v14 offset:3072
ds_read_b64_tr_b16 a[150:151], v14 offset:3328
v_lshl_add_u32 v31, v31, 8, v26
s_movk_i32 s60, 180
v_cndmask_b32 v27, 0, 1, s[64:65]
v_mfma_f32_32x32x16_bf16 v[32:47], a[160:163], v[252:255], v[32:47]
ds_read_b64_tr_b16 a[152:153], v14 offset:4096
ds_read_b64_tr_b16 a[154:155], v14 offset:4352
v_cmp_gt_u32 s[62:63], s60, v31
v_mul_u32_u24 v30, 90, v27
v_sub_u32 v26, v26, v30
v_mul_u32_u24 v28, 3641, v26
s_waitcnt lgkmcnt(6)
v_mfma_f32_32x32x16_bf16 v[48:63], a[164:167], a[0:3], 0
ds_read_b64_tr_b16 a[156:157], v14 offset:5120
ds_read_b64_tr_b16 a[158:159], v14 offset:5376
buffer_load_dwordx4 v1, s[36:39], s49 offen offset:0 sc1 lds
v_add_u32 v253, 147456, v13
v_lshrrev_b32 v28, 16, v28
v_mfma_f32_32x32x16_bf16 v[48:63], a[168:171], a[4:7], v[48:63]
ds_read_b64_tr_b16 a[160:161], v14 offset:6144
ds_read_b64_tr_b16 a[162:163], v14 offset:6400
v_mul_u32_u24 v30, 18, v28
v_sub_u32 v26, v26, v30
v_lshl_add_u32 v26, v26, 1, v29
v_lshrrev_b32 v30, 3, v26
s_waitcnt lgkmcnt(6)
v_mfma_f32_32x32x16_bf16 v[48:63], a[144:147], a[8:11], v[48:63]
ds_read_b64_tr_b16 a[164:165], v14 offset:7168
ds_read_b64_tr_b16 a[166:167], v14 offset:7424
buffer_load_dwordx4 v1, s[36:39], s49 offen offset:1024 sc1 lds
v_cvt_pk_bf16_f32 v136, v32, v33
v_cvt_pk_bf16_f32 v137, v34, v35
v_mfma_f32_32x32x16_bf16 v[48:63], a[148:151], a[12:15], v[48:63]
ds_read_b64_tr_b16 a[168:169], v14 offset:8192
ds_read_b64_tr_b16 a[170:171], v14 offset:8448
v_cvt_pk_bf16_f32 v138, v36, v37
v_cvt_pk_bf16_f32 v139, v38, v39
v_cvt_pk_bf16_f32 v140, v40, v41
v_cvt_pk_bf16_f32 v141, v42, v43
s_waitcnt lgkmcnt(6)
v_mfma_f32_32x32x16_bf16 v[48:63], a[152:155], a[16:19], v[48:63]
ds_read_b64_tr_b16 a[144:145], v14 offset:9216
ds_read_b64_tr_b16 a[146:147], v14 offset:9472
v_cvt_pk_bf16_f32 v142, v44, v45
v_cvt_pk_bf16_f32 v143, v46, v47
v_and_b32 v26, 7, v26
v_mfma_f32_32x32x16_bf16 v[48:63], a[156:159], a[20:23], v[48:63]
ds_read_b64_tr_b16 a[148:149], v14 offset:10240
ds_read_b64_tr_b16 a[150:151], v14 offset:10496
buffer_load_dwordx4 v1, s[36:39], s49 offen offset:2048 sc1 lds
v_lshl_add_u32 v26, v30, 4, v26
v_lshl_add_u32 v26, v27, 3, v26
v_lshlrev_b32 v29, 6, v26
s_waitcnt lgkmcnt(6)
v_mfma_f32_32x32x16_bf16 v[48:63], a[160:163], a[24:27], v[48:63]
ds_read_b64_tr_b16 a[152:153], v14 offset:11264
ds_read_b64_tr_b16 a[154:155], v14 offset:11520
v_lshl_add_u32 v29, v28, 4, v29
v_lshl_add_u32 v29, v27, 3, v29
v_cmp_gt_u32 s[64:65], 4, v28
v_mfma_f32_32x32x16_bf16 v[48:63], a[164:167], a[28:31], v[48:63]
ds_read_b64_tr_b16 a[156:157], v14 offset:12288
ds_read_b64_tr_b16 a[158:159], v14 offset:12544
v_add_u32 v29, 147456, v29
v_lshlrev_b32 v30, 5, v26
v_lshl_add_u32 v30, v27, 4, v30
v_add_u32 v30, 152576, v30
s_waitcnt lgkmcnt(6)
v_mfma_f32_32x32x16_bf16 v[48:63], a[168:171], a[32:35], v[48:63]
ds_read_b64_tr_b16 a[160:161], v14 offset:13312
ds_read_b64_tr_b16 a[162:163], v14 offset:13568
buffer_load_dwordx4 v1, s[36:39], s49 offen offset:3072 sc1 lds
v_cndmask_b32 v31, v30, v29, s[64:65]
v_add_u32 v30, 2696, v30
v_mfma_f32_32x32x16_bf16 v[48:63], a[144:147], a[36:39], v[48:63]
ds_read_b64_tr_b16 a[164:165], v14 offset:14336
ds_read_b64_tr_b16 a[166:167], v14 offset:14592
v_cndmask_b32 v26, v30, v29, s[64:65]
v_mov_b32 v30, 161792
v_cndmask_b32 v31, v30, v31, s[62:63]
v_cndmask_b32 v26, v30, v26, s[62:63]
s_waitcnt lgkmcnt(6)
v_mfma_f32_32x32x16_bf16 v[48:63], a[148:151], a[40:43], v[48:63]
ds_read_b64_tr_b16 a[168:169], v14 offset:15360
ds_read_b64_tr_b16 a[170:171], v14 offset:15616
s_add_u32 s49, s78, 114688
s_add_u32 m0, s72, 114688
v_accvgpr_write_b32 a240, v31
v_mfma_f32_32x32x16_bf16 v[48:63], a[152:155], a[44:47], v[48:63]
ds_read_b64_tr_b16 a[144:145], v14 offset:16384
ds_read_b64_tr_b16 a[146:147], v14 offset:16640
buffer_load_dwordx4 v1, s[36:39], s49 offen offset:0 sc1 lds
v_accvgpr_write_b32 a241, v26
v_lshrrev_b32 v28, 8, v1
v_mul_u32_u24 v28, 3072, v28
s_waitcnt lgkmcnt(6)
v_mfma_f32_32x32x16_bf16 v[48:63], a[156:159], a[48:51], v[48:63]
ds_read_b64_tr_b16 a[148:149], v14 offset:17408
ds_read_b64_tr_b16 a[150:151], v14 offset:17664
v_and_b32 v29, 0xf0, v1
v_add_u32 v28, v28, v29
s_mul_i32 s57, s67, 768
v_mfma_f32_32x32x16_bf16 v[48:63], a[160:163], a[52:55], v[48:63]
ds_read_b64_tr_b16 a[152:153], v14 offset:18432
ds_read_b64_tr_b16 a[154:155], v14 offset:18688
s_sub_u32 s62, 2368, s57
v_cmp_gt_u32 s[64:65], s62, v29
v_mov_b32 v31, 2147483648
s_mul_i32 s62, s69, 49152
s_waitcnt lgkmcnt(6)
v_mfma_f32_32x32x16_bf16 v[48:63], a[164:167], a[56:59], v[48:63]
ds_read_b64_tr_b16 a[156:157], v14 offset:19456
ds_read_b64_tr_b16 a[158:159], v14 offset:19712
buffer_load_dwordx4 v1, s[36:39], s49 offen offset:1024 sc1 lds
s_add_u32 s57, s57, s62
s_add_u32 s57, s57, 131072
v_mfma_f32_32x32x16_bf16 v[48:63], a[168:171], a[60:63], v[48:63]
ds_read_b64_tr_b16 a[160:161], v14 offset:20480
ds_read_b64_tr_b16 a[162:163], v14 offset:20736
v_cndmask_b32 v29, v31, v28, s[64:65]
v_accvgpr_write_b32 a242, v28
v_accvgpr_write_b32 a243, v29
s_and_b32 s60, s67, 1
s_waitcnt lgkmcnt(6)
v_mfma_f32_32x32x16_bf16 v[48:63], a[144:147], a[64:67], v[48:63]
ds_read_b64_tr_b16 a[164:165], v14 offset:21504
ds_read_b64_tr_b16 a[166:167], v14 offset:21760
s_lshr_b32 s61, s67, 1
v_lshrrev_b32 v30, 8, v1
v_mul_u32_u24 v28, 288, v30
v_mfma_f32_32x32x16_bf16 v[48:63], a[148:151], a[68:71], v[48:63]
ds_read_b64_tr_b16 a[168:169], v14 offset:22528
ds_read_b64_tr_b16 a[170:171], v14 offset:22784
buffer_load_dwordx4 v1, s[36:39], s49 offen offset:2048 sc1 lds
v_cmp_eq_u32 s[64:65], 0, v30
v_mov_b32 v29, 1152
v_bfe_u32 v30, v1, 4, 4
s_waitcnt lgkmcnt(6)
v_mfma_f32_32x32x16_bf16 v[48:63], a[152:155], a[72:75], v[48:63]
ds_read_b64_tr_b16 a[144:145], v14 offset:23552
ds_read_b64_tr_b16 a[146:147], v14 offset:23808
v_cndmask_b32 v29, v31, v29, s[64:65]
s_cmp_eq_u32 s60, 1
s_cselect_b64 s[64:65], -1, 0
v_mfma_f32_32x32x16_bf16 v[48:63], a[156:159], a[76:79], v[48:63]
ds_read_b64_tr_b16 a[148:149], v14 offset:24576
ds_read_b64_tr_b16 a[150:151], v14 offset:24832
v_cndmask_b32 v28, v28, v29, s[64:65]
v_cmp_gt_u32 s[64:65], 4, v30
v_lshl_add_u32 v28, v30, 3, v28
s_lshl4_add_u32 s58, s69, s68
s_waitcnt lgkmcnt(6)
v_mfma_f32_32x32x16_bf16 v[48:63], a[160:163], a[80:83], v[48:63]
ds_read_b64_tr_b16 a[152:153], v14 offset:25600
ds_read_b64_tr_b16 a[154:155], v14 offset:25856
buffer_load_dwordx4 v1, s[36:39], s49 offen offset:3072 sc1 lds
s_mul_i32 s58, s58, 3072
s_mul_i32 s62, s61, 1440
v_mfma_f32_32x32x16_bf16 v[48:63], a[164:167], a[84:87], v[48:63]
ds_read_b64_tr_b16 a[156:157], v14 offset:26624
ds_read_b64_tr_b16 a[158:159], v14 offset:26880
v_cndmask_b32 v29, v31, v28, s[64:65]
s_add_u32 s58, s58, s62
s_add_u32 s58, s58, 131072
v_accvgpr_write_b32 a244, v28
s_waitcnt lgkmcnt(6)
v_mfma_f32_32x32x16_bf16 v[48:63], a[168:171], a[88:91], v[48:63]
ds_read_b64_tr_b16 a[160:161], v14 offset:27648
ds_read_b64_tr_b16 a[162:163], v14 offset:27904
s_add_u32 s49, s78, 118784
s_add_u32 m0, s72, 118784
v_accvgpr_write_b32 a245, v29
v_mfma_f32_32x32x16_bf16 v[48:63], a[144:147], a[92:95], v[48:63]
ds_read_b64_tr_b16 a[164:165], v14 offset:28672
ds_read_b64_tr_b16 a[166:167], v14 offset:28928
buffer_load_dwordx4 v1, s[36:39], s49 offen offset:0 sc1 lds
v_bfe_u32 v26, v1, 6, 3
v_lshrrev_b32 v27, 9, v1
v_lshl_add_u32 v26, v26, 2, v27
s_waitcnt lgkmcnt(6)
v_mfma_f32_32x32x16_bf16 v[48:63], a[148:151], a[96:99], v[48:63]
ds_read_b64_tr_b16 a[168:169], v14 offset:29696
ds_read_b64_tr_b16 a[170:171], v14 offset:29952
v_mul_u32_u24 v26, 232, v26
v_bfe_u32 v27, v1, 4, 2
v_lshl_add_u32 v27, v27, 3, v26
v_mfma_f32_32x32x16_bf16 v[48:63], a[152:155], a[100:103], v[48:63]
ds_read_b64_tr_b16 a[144:145], v14 offset:30720
ds_read_b64_tr_b16 a[146:147], v14 offset:30976
s_mul_i32 s62, s60, s61
s_mul_i32 s62, s62, 40
s_lshl_b32 s63, s60, 5
s_sub_u32 s63, s63, s62
s_waitcnt lgkmcnt(6)
v_mfma_f32_32x32x16_bf16 v[48:63], a[156:159], a[104:107], v[48:63]
ds_read_b64_tr_b16 a[148:149], v14 offset:31744
ds_read_b64_tr_b16 a[150:151], v14 offset:32000
buffer_load_dword a183, v21, s[20:23], s79 offen offset:384
v_lshrrev_b32 v20, 5, v1
v_mul_u32_u24 v20, 1152, v20
v_and_b32 v21, 2147483648, v21
v_mfma_f32_32x32x16_bf16 v[48:63], a[160:163], a[108:111], v[48:63]
ds_read_b64_tr_b16 a[152:153], v14 offset:32768
ds_read_b64_tr_b16 a[154:155], v14 offset:33024
v_or_b32 v21, v21, v20
v_and_b32 v20, 16, v1
v_lshl_add_u32 v21, v20, 3, v21
s_lshr_b32 s79, s2, 5
s_lshl2_add_u32 s79, s79, s67
s_waitcnt lgkmcnt(6)
v_mfma_f32_32x32x16_bf16 v[48:63], a[164:167], a[112:115], v[48:63]
ds_read_b64_tr_b16 a[156:157], v14 offset:33792
ds_read_b64_tr_b16 a[158:159], v14 offset:34048
s_lshl_b32 s49, s70, 7
s_add_u32 s79, s79, s49
s_mul_i32 s79, s79, 10368
s_mul_i32 s49, s71, 331776
v_mfma_f32_32x32x16_bf16 v[48:63], a[168:171], a[116:119], v[48:63]
ds_read_b64_tr_b16 a[160:161], v14 offset:34816
ds_read_b64_tr_b16 a[162:163], v14 offset:35072
s_add_u32 s49, s49, s79
s_lshl_b32 s50, s71, 8
s_add_u32 s79, s79, s50
buffer_load_dword a182, v21, s[24:27], s49 offen offset:896
s_waitcnt lgkmcnt(6)
v_mfma_f32_32x32x16_bf16 v[48:63], a[144:147], a[120:123], v[48:63]
ds_read_b64_tr_b16 a[164:165], v14 offset:35840
ds_read_b64_tr_b16 a[166:167], v14 offset:36096
s_waitcnt vmcnt(11)
s_barrier
s_mul_i32 s62, s61, 48
v_mfma_f32_32x32x16_bf16 v[48:63], a[148:151], a[124:127], v[48:63]
v_add_u32 v14, 73728, v13
ds_read_b64_tr_b16 a[168:169], v14 offset:0
ds_read_b64_tr_b16 a[170:171], v14 offset:256
s_add_u32 s63, s63, s62
s_add_u32 s63, s63, 73872
v_add_u32 v26, s63, v27
s_waitcnt lgkmcnt(6)
v_mfma_f32_32x32x16_bf16 v[48:63], a[152:155], a[128:131], v[48:63]
ds_read_b64_tr_b16 a[144:145], v14 offset:1024
ds_read_b64_tr_b16 a[146:147], v14 offset:1280
s_mul_i32 s62, s61, 72
s_add_u32 s62, s62, 73728
v_add_u32 v27, s62, v27
v_mfma_f32_32x32x16_bf16 v[48:63], a[156:159], a[132:135], v[48:63]
ds_read_b64_tr_b16 a[148:149], v14 offset:2048
ds_read_b64_tr_b16 a[150:151], v14 offset:2304
v_accvgpr_write_b32 a246, v26
v_accvgpr_write_b32 a247, v27
v_bfe_u32 v27, v1, 8, 1
v_mul_u32_u24 v26, 2688, v27
s_waitcnt lgkmcnt(6)
v_mfma_f32_32x32x16_bf16 v[48:63], a[160:163], a[136:139], v[48:63]
ds_read_b64_tr_b16 a[152:153], v14 offset:3072
ds_read_b64_tr_b16 a[154:155], v14 offset:3328
v_lshrrev_b32 v27, 9, v1
v_lshl_add_u32 v26, v27, 8, v26
v_bfe_u32 v27, v1, 6, 2
v_mfma_f32_32x32x16_bf16 v[48:63], a[164:167], a[140:143], v[48:63]
ds_read_b64_tr_b16 a[156:157], v14 offset:4096
ds_read_b64_tr_b16 a[158:159], v14 offset:4352
v_lshl_add_u32 v26, v27, 5, v26
v_bfe_u32 v27, v1, 4, 2
v_lshl_add_u32 v26, v27, 3, v26
v_add_u32 v26, 152576, v26
s_waitcnt lgkmcnt(6)
v_mfma_f32_32x32x16_bf16 v[32:47], a[168:171], a[0:3], 0
ds_read_b64_tr_b16 a[160:161], v14 offset:5120
ds_read_b64_tr_b16 a[162:163], v14 offset:5376
s_add_u32 s49, s78, 147456
s_add_u32 m0, s72, 0
v_accvgpr_write_b32 a248, v26
v_mfma_f32_32x32x16_bf16 v[32:47], a[144:147], a[4:7], v[32:47]
ds_read_b64_tr_b16 a[164:165], v14 offset:6144
ds_read_b64_tr_b16 a[166:167], v14 offset:6400
s_lshl2_add_u32 s60, s68, s67
s_lshl4_add_u32 s59, s60, s69
s_lshl_b32 s59, s59, 11
s_add_u32 s59, s59, 5242880
s_waitcnt lgkmcnt(6)
v_mfma_f32_32x32x16_bf16 v[32:47], a[148:151], a[8:11], v[32:47]
ds_read_b64_tr_b16 a[168:169], v14 offset:7168
ds_read_b64_tr_b16 a[170:171], v14 offset:7424
v_cvt_pk_bf16_f32 v144, v48, v49
v_cvt_pk_bf16_f32 v145, v50, v51
v_cvt_pk_bf16_f32 v146, v52, v53
v_mfma_f32_32x32x16_bf16 v[32:47], a[152:155], a[12:15], v[32:47]
ds_read_b64_tr_b16 a[144:145], v14 offset:8192
ds_read_b64_tr_b16 a[146:147], v14 offset:8448
v_cvt_pk_bf16_f32 v147, v54, v55
v_cvt_pk_bf16_f32 v148, v56, v57
v_cvt_pk_bf16_f32 v149, v58, v59
v_mov_b32 v150, 0
s_waitcnt lgkmcnt(6)
v_mfma_f32_32x32x16_bf16 v[32:47], a[156:159], a[16:19], v[32:47]
ds_read_b64_tr_b16 a[148:149], v14 offset:9216
ds_read_b64_tr_b16 a[150:151], v14 offset:9472
v_mov_b32 v151, 0
s_lshl_b32 s60, s60, 12
s_lshr_b32 s62, s69, 3
v_mfma_f32_32x32x16_bf16 v[32:47], a[160:163], a[20:23], v[32:47]
ds_read_b64_tr_b16 a[152:153], v14 offset:10240
ds_read_b64_tr_b16 a[154:155], v14 offset:10496
s_lshl2_add_u32 s62, s62, s71
s_lshl_b32 s62, s62, 9
s_add_u32 s60, s60, s62
s_and_b32 s62, s70, 1
s_waitcnt lgkmcnt(6)
v_mfma_f32_32x32x16_bf16 v[32:47], a[164:167], a[24:27], v[32:47]
ds_read_b64_tr_b16 a[156:157], v14 offset:11264
ds_read_b64_tr_b16 a[158:159], v14 offset:11520
buffer_load_dwordx4 v1, s[36:39], s49 offen offset:0 sc1 lds
s_lshl3_add_u32 s60, s62, s60
s_add_u32 s3, s60, 7340032
v_mfma_f32_32x32x16_bf16 v[32:47], a[168:171], a[28:31], v[32:47]
ds_read_b64_tr_b16 a[160:161], v14 offset:12288
ds_read_b64_tr_b16 a[162:163], v14 offset:12544
v_and_b32 v27, 0x1f0, v1
v_lshrrev_b32 v28, 9, v1
v_lshl_add_u32 v27, v28, 2, v27
v_accvgpr_write_b32 a249, v27
s_waitcnt lgkmcnt(6)
v_mfma_f32_32x32x16_bf16 v[32:47], a[144:147], a[32:35], v[32:47]
ds_read_b64_tr_b16 a[164:165], v14 offset:13312
ds_read_b64_tr_b16 a[166:167], v14 offset:13568
buffer_load_dwordx4 v1, s[36:39], s49 offen offset:1024 sc1 lds
v_bfe_u32 v30, v1, 4, 5
v_mul_u32_u24 v30, 232, v30
v_mfma_f32_32x32x16_bf16 v[32:47], a[148:151], a[36:39], v[32:47]
ds_read_b64_tr_b16 a[168:169], v14 offset:14336
ds_read_b64_tr_b16 a[170:171], v14 offset:14592
s_mul_i32 s60, s67, 7424
s_add_u32 s60, s60, 73728
v_add_u32 v30, s60, v30
v_lshrrev_b32 v31, 9, v1
s_waitcnt lgkmcnt(6)
v_mfma_f32_32x32x16_bf16 v[32:47], a[152:155], a[40:43], v[32:47]
ds_read_b64_tr_b16 a[144:145], v14 offset:15360
ds_read_b64_tr_b16 a[146:147], v14 offset:15616
buffer_load_dwordx4 v1, s[36:39], s49 offen offset:2048 sc1 lds
v_mul_u32_u24 v26, 72, v31
v_add_u32 v26, v26, v30
v_mfma_f32_32x32x16_bf16 v[32:47], a[156:159], a[44:47], v[32:47]
ds_read_b64_tr_b16 a[148:149], v14 offset:16384
ds_read_b64_tr_b16 a[150:151], v14 offset:16640
v_lshl_add_u32 v27, v31, 3, v30
v_lshl_add_u32 v28, v31, 4, v30
v_lshl_add_u32 v29, v31, 5, v30
v_mfma_f32_32x32x16_bf16 v[168:183], a[184:187], v[136:139], 0
v_mfma_f32_32x32x16_bf16 v[168:183], a[188:191], v[140:143], v[168:183]
s_waitcnt lgkmcnt(6)
v_mfma_f32_32x32x16_bf16 v[32:47], a[160:163], a[48:51], v[32:47]
ds_read_b64_tr_b16 a[152:153], v14 offset:17408
ds_read_b64_tr_b16 a[154:155], v14 offset:17664
buffer_load_dwordx4 v1, s[36:39], s49 offen offset:3072 sc1 lds
v_mfma_f32_32x32x16_bf16 v[168:183], a[192:195], v[144:147], v[168:183]
v_mfma_f32_16x16x32_bf16 v[184:187], a[196:199], v[136:139], 0
v_mfma_f32_32x32x16_bf16 v[32:47], a[164:167], a[52:55], v[32:47]
ds_read_b64_tr_b16 a[156:157], v14 offset:18432
ds_read_b64_tr_b16 a[158:159], v14 offset:18688
s_add_u32 s49, s78, 151552
s_add_u32 m0, s72, 4096
v_mfma_f32_16x16x32_bf16 v[184:187], a[200:203], v[140:143], v[184:187]
v_mfma_f32_16x16x32_bf16 v[184:187], a[204:207], v[144:147], v[184:187]
s_waitcnt lgkmcnt(6)
v_mfma_f32_32x32x16_bf16 v[32:47], a[168:171], a[56:59], v[32:47]
ds_read_b64_tr_b16 a[160:161], v14 offset:19456
ds_read_b64_tr_b16 a[162:163], v14 offset:19712
buffer_load_dwordx4 v1, s[36:39], s49 offen offset:0 sc1 lds
v_mfma_f32_32x32x16_bf16 v[32:47], a[144:147], a[60:63], v[32:47]
ds_read_b64_tr_b16 a[164:165], v14 offset:20480
ds_read_b64_tr_b16 a[166:167], v14 offset:20736
s_waitcnt lgkmcnt(6)
v_mfma_f32_32x32x16_bf16 v[32:47], a[148:151], a[64:67], v[32:47]
ds_read_b64_tr_b16 a[168:169], v14 offset:21504
ds_read_b64_tr_b16 a[170:171], v14 offset:21760
v_max3_f32 v224, v168, v169, v170
v_min3_f32 v225, v168, v169, v170
v_max3_f32 v224, v224, v171, v172
v_mfma_f32_32x32x16_bf16 v[32:47], a[152:155], a[68:71], v[32:47]
ds_read_b64_tr_b16 a[144:145], v14 offset:22528
ds_read_b64_tr_b16 a[146:147], v14 offset:22784
buffer_load_dwordx4 v1, s[36:39], s49 offen offset:1024 sc1 lds
v_min3_f32 v225, v225, v171, v172
v_max3_f32 v224, v224, v173, v174
v_min3_f32 v225, v225, v173, v174
s_waitcnt lgkmcnt(6)
v_mfma_f32_32x32x16_bf16 v[32:47], a[156:159], a[72:75], v[32:47]
ds_read_b64_tr_b16 a[148:149], v14 offset:23552
ds_read_b64_tr_b16 a[150:151], v14 offset:23808
v_max3_f32 v224, v224, v175, v176
v_min3_f32 v225, v225, v175, v176
v_max3_f32 v224, v224, v177, v178
v_mfma_f32_32x32x16_bf16 v[32:47], a[160:163], a[76:79], v[32:47]
ds_read_b64_tr_b16 a[152:153], v14 offset:24576
ds_read_b64_tr_b16 a[154:155], v14 offset:24832
buffer_load_dwordx4 v1, s[36:39], s49 offen offset:2048 sc1 lds
v_min3_f32 v225, v225, v177, v178
v_max3_f32 v224, v224, v179, v180
v_min3_f32 v225, v225, v179, v180
s_waitcnt lgkmcnt(6)
v_mfma_f32_32x32x16_bf16 v[32:47], a[164:167], a[80:83], v[32:47]
ds_read_b64_tr_b16 a[156:157], v14 offset:25600
ds_read_b64_tr_b16 a[158:159], v14 offset:25856
v_max3_f32 v224, v224, v181, v182
v_min3_f32 v225, v225, v181, v182
v_max3_f32 v224, v224, v183, v184
v_mfma_f32_32x32x16_bf16 v[32:47], a[168:171], a[84:87], v[32:47]
ds_read_b64_tr_b16 a[160:161], v14 offset:26624
ds_read_b64_tr_b16 a[162:163], v14 offset:26880
buffer_load_dwordx4 v1, s[36:39], s49 offen offset:3072 sc1 lds
v_min3_f32 v225, v225, v183, v184
v_max_f32 v224, v224, v185
v_min_f32 v225, v225, v185
s_waitcnt lgkmcnt(6)
v_mfma_f32_32x32x16_bf16 v[32:47], a[144:147], a[88:91], v[32:47]
ds_read_b64_tr_b16 a[164:165], v14 offset:27648
ds_read_b64_tr_b16 a[166:167], v14 offset:27904
s_add_u32 s49, s78, 155648
s_add_u32 m0, s72, 8192
v_mul_f32_e64 v224, -v18, v224
v_mfma_f32_32x32x16_bf16 v[32:47], a[148:151], a[92:95], v[32:47]
ds_read_b64_tr_b16 a[168:169], v14 offset:28672
ds_read_b64_tr_b16 a[170:171], v14 offset:28928
buffer_load_dwordx4 v1, s[36:39], s49 offen offset:0 sc1 lds
s_add_u32 s49, s71, 0
s_and_b32 s49, s49, 3
s_mul_i32 s49, s49, 331776
s_waitcnt lgkmcnt(6)
v_mfma_f32_32x32x16_bf16 v[32:47], a[152:155], a[96:99], v[32:47]
ds_read_b64_tr_b16 a[144:145], v14 offset:29696
ds_read_b64_tr_b16 a[146:147], v14 offset:29952
s_add_u32 s49, s49, s79
v_mul_f32 v225, v18, v225
v_fma_f32 v188, v168, v18, v224
v_mfma_f32_32x32x16_bf16 v[32:47], a[156:159], a[100:103], v[32:47]
ds_read_b64_tr_b16 a[148:149], v14 offset:30720
ds_read_b64_tr_b16 a[150:151], v14 offset:30976
v_fma_f32 v168, v168, -v18, v225
v_exp_f32 v188, v188
s_waitcnt lgkmcnt(6)
v_mfma_f32_32x32x16_bf16 v[32:47], a[160:163], a[104:107], v[32:47]
ds_read_b64_tr_b16 a[152:153], v14 offset:31744
ds_read_b64_tr_b16 a[154:155], v14 offset:32000
buffer_load_dword a183, v21, s[24:27], s49 offen
v_exp_f32 v168, v168
v_mfma_f32_32x32x16_bf16 v[32:47], a[164:167], a[108:111], v[32:47]
ds_read_b64_tr_b16 a[156:157], v14 offset:32768
ds_read_b64_tr_b16 a[158:159], v14 offset:33024
v_fma_f32 v189, v169, v18, v224
v_fma_f32 v169, v169, -v18, v225
v_exp_f32 v189, v189
s_waitcnt lgkmcnt(6)
v_mfma_f32_32x32x16_bf16 v[32:47], a[168:171], a[112:115], v[32:47]
ds_read_b64_tr_b16 a[160:161], v14 offset:33792
ds_read_b64_tr_b16 a[162:163], v14 offset:34048
v_exp_f32 v169, v169
v_fma_f32 v190, v170, v18, v224
v_mfma_f32_32x32x16_bf16 v[32:47], a[144:147], a[116:119], v[32:47]
ds_read_b64_tr_b16 a[164:165], v14 offset:34816
ds_read_b64_tr_b16 a[166:167], v14 offset:35072
v_fma_f32 v170, v170, -v18, v225
v_exp_f32 v190, v190
s_waitcnt lgkmcnt(6)
v_mfma_f32_32x32x16_bf16 v[32:47], a[148:151], a[120:123], v[32:47]
ds_read_b64_tr_b16 a[168:169], v14 offset:35840
ds_read_b64_tr_b16 a[170:171], v14 offset:36096
s_waitcnt vmcnt(12)
s_barrier
v_mfma_f32_32x32x16_bf16 v[32:47], a[152:155], a[124:127], v[32:47]
v_add_u32 v14, 110592, v13
ds_read_b64_tr_b16 a[144:145], v14 offset:0
ds_read_b64_tr_b16 a[146:147], v14 offset:256
v_exp_f32 v170, v170
v_add_f32 v226, v188, v189
s_waitcnt lgkmcnt(6)
v_mfma_f32_32x32x16_bf16 v[32:47], a[156:159], a[128:131], v[32:47]
ds_read_b64_tr_b16 a[148:149], v14 offset:1024
ds_read_b64_tr_b16 a[150:151], v14 offset:1280
v_add_f32 v227, v168, v169
v_fma_f32 v191, v171, v18, v224
v_fma_f32 v171, v171, -v18, v225
v_mfma_f32_32x32x16_bf16 v[32:47], a[160:163], a[132:135], v[32:47]
ds_read_b64_tr_b16 a[152:153], v14 offset:2048
ds_read_b64_tr_b16 a[154:155], v14 offset:2304
v_exp_f32 v191, v191
v_exp_f32 v171, v171
s_waitcnt lgkmcnt(6)
v_mfma_f32_32x32x16_bf16 v[32:47], a[164:167], a[136:139], v[32:47]
ds_read_b64_tr_b16 a[156:157], v14 offset:3072
ds_read_b64_tr_b16 a[158:159], v14 offset:3328
v_add_f32 v226, v226, v190
v_add_f32 v227, v227, v170
v_fma_f32 v192, v172, v18, v224
v_mfma_f32_32x32x16_bf16 v[32:47], a[168:171], a[140:143], v[32:47]
ds_read_b64_tr_b16 a[160:161], v14 offset:4096
ds_read_b64_tr_b16 a[162:163], v14 offset:4352
v_fma_f32 v172, v172, -v18, v225
v_exp_f32 v192, v192
s_waitcnt lgkmcnt(6)
v_mfma_f32_32x32x16_bf16 v[48:63], a[144:147], a[0:3], 0
ds_read_b64_tr_b16 a[164:165], v14 offset:5120
ds_read_b64_tr_b16 a[166:167], v14 offset:5376
v_add_u32 v11, 128, v11
s_add_u32 m0, s72, 36864
v_exp_f32 v172, v172
v_mfma_f32_32x32x16_bf16 v[48:63], a[148:151], a[4:7], v[48:63]
ds_read_b64_tr_b16 a[168:169], v14 offset:6144
ds_read_b64_tr_b16 a[170:171], v14 offset:6400
v_add_f32 v226, v226, v191
v_add_f32 v227, v227, v171
v_fma_f32 v193, v173, v18, v224
v_fma_f32 v173, v173, -v18, v225
s_waitcnt lgkmcnt(6)
v_mfma_f32_32x32x16_bf16 v[48:63], a[152:155], a[8:11], v[48:63]
ds_read_b64_tr_b16 a[144:145], v14 offset:7168
ds_read_b64_tr_b16 a[146:147], v14 offset:7424
v_cvt_pk_bf16_f32 v152, v32, v33
v_cvt_pk_bf16_f32 v153, v34, v35
v_cvt_pk_bf16_f32 v154, v36, v37
v_cvt_pk_bf16_f32 v155, v38, v39
v_mfma_f32_32x32x16_bf16 v[48:63], a[156:159], a[12:15], v[48:63]
ds_read_b64_tr_b16 a[148:149], v14 offset:8192
ds_read_b64_tr_b16 a[150:151], v14 offset:8448
v_cvt_pk_bf16_f32 v156, v40, v41
v_cvt_pk_bf16_f32 v157, v42, v43
v_cvt_pk_bf16_f32 v158, v44, v45
v_cvt_pk_bf16_f32 v159, v46, v47
s_waitcnt lgkmcnt(6)
v_mfma_f32_32x32x16_bf16 v[48:63], a[160:163], a[16:19], v[48:63]
ds_read_b64_tr_b16 a[152:153], v14 offset:9216
ds_read_b64_tr_b16 a[154:155], v14 offset:9472
v_exp_f32 v193, v193
v_exp_f32 v173, v173
v_mfma_f32_32x32x16_bf16 v[48:63], a[164:167], a[20:23], v[48:63]
ds_read_b64_tr_b16 a[156:157], v14 offset:10240
ds_read_b64_tr_b16 a[158:159], v14 offset:10496
v_add_f32 v226, v226, v192
v_add_f32 v227, v227, v172
v_fma_f32 v194, v174, v18, v224
v_fma_f32 v174, v174, -v18, v225
s_waitcnt lgkmcnt(6)
v_mfma_f32_32x32x16_bf16 v[48:63], a[168:171], a[24:27], v[48:63]
ds_read_b64_tr_b16 a[160:161], v14 offset:11264
ds_read_b64_tr_b16 a[162:163], v14 offset:11520
buffer_load_dwordx4 v11, s[20:23], s40 offen offset:0 lds
v_exp_f32 v194, v194
v_mfma_f32_32x32x16_bf16 v[48:63], a[144:147], a[28:31], v[48:63]
ds_read_b64_tr_b16 a[164:165], v14 offset:12288
ds_read_b64_tr_b16 a[166:167], v14 offset:12544
v_exp_f32 v174, v174
v_add_f32 v226, v226, v193
v_add_f32 v227, v227, v173
v_fma_f32 v195, v175, v18, v224
s_waitcnt lgkmcnt(6)
v_mfma_f32_32x32x16_bf16 v[48:63], a[148:151], a[32:35], v[48:63]
ds_read_b64_tr_b16 a[168:169], v14 offset:13312
ds_read_b64_tr_b16 a[170:171], v14 offset:13568
buffer_load_dwordx4 v11, s[20:23], s41 offen offset:1024 lds
v_fma_f32 v175, v175, -v18, v225
v_exp_f32 v195, v195
v_mfma_f32_32x32x16_bf16 v[48:63], a[152:155], a[36:39], v[48:63]
ds_read_b64_tr_b16 a[144:145], v14 offset:14336
ds_read_b64_tr_b16 a[146:147], v14 offset:14592
v_exp_f32 v175, v175
v_add_f32 v226, v226, v194
v_add_f32 v227, v227, v174
v_fma_f32 v196, v176, v18, v224
s_waitcnt lgkmcnt(6)
v_mfma_f32_32x32x16_bf16 v[48:63], a[156:159], a[40:43], v[48:63]
ds_read_b64_tr_b16 a[148:149], v14 offset:15360
ds_read_b64_tr_b16 a[150:151], v14 offset:15616
buffer_load_dwordx4 v11, s[20:23], s42 offen offset:2048 lds
v_fma_f32 v176, v176, -v18, v225
v_exp_f32 v196, v196
v_mfma_f32_32x32x16_bf16 v[48:63], a[160:163], a[44:47], v[48:63]
ds_read_b64_tr_b16 a[152:153], v14 offset:16384
ds_read_b64_tr_b16 a[154:155], v14 offset:16640
v_exp_f32 v176, v176
v_add_f32 v226, v226, v195
v_add_f32 v227, v227, v175
v_fma_f32 v197, v177, v18, v224
s_waitcnt lgkmcnt(6)
v_mfma_f32_32x32x16_bf16 v[48:63], a[164:167], a[48:51], v[48:63]
ds_read_b64_tr_b16 a[156:157], v14 offset:17408
ds_read_b64_tr_b16 a[158:159], v14 offset:17664
buffer_load_dwordx4 v11, s[20:23], s43 offen offset:3072 lds
v_fma_f32 v177, v177, -v18, v225
v_exp_f32 v197, v197
v_mfma_f32_32x32x16_bf16 v[48:63], a[168:171], a[52:55], v[48:63]
ds_read_b64_tr_b16 a[160:161], v14 offset:18432
ds_read_b64_tr_b16 a[162:163], v14 offset:18688
s_add_u32 m0, s72, 40960
v_exp_f32 v177, v177
v_add_f32 v226, v226, v196
v_add_f32 v227, v227, v176
s_waitcnt lgkmcnt(6)
v_mfma_f32_32x32x16_bf16 v[48:63], a[144:147], a[56:59], v[48:63]
ds_read_b64_tr_b16 a[164:165], v14 offset:19456
ds_read_b64_tr_b16 a[166:167], v14 offset:19712
buffer_load_dwordx4 v11, s[20:23], s44 offen offset:0 lds
v_fma_f32 v198, v178, v18, v224
v_fma_f32 v178, v178, -v18, v225
v_mfma_f32_32x32x16_bf16 v[48:63], a[148:151], a[60:63], v[48:63]
ds_read_b64_tr_b16 a[168:169], v14 offset:20480
ds_read_b64_tr_b16 a[170:171], v14 offset:20736
v_exp_f32 v198, v198
v_exp_f32 v178, v178
v_add_f32 v226, v226, v197
s_waitcnt lgkmcnt(6)
v_mfma_f32_32x32x16_bf16 v[48:63], a[152:155], a[64:67], v[48:63]
ds_read_b64_tr_b16 a[144:145], v14 offset:21504
ds_read_b64_tr_b16 a[146:147], v14 offset:21760
v_add_f32 v227, v227, v177
v_fma_f32 v199, v179, v18, v224
v_fma_f32 v179, v179, -v18, v225
v_mfma_f32_32x32x16_bf16 v[48:63], a[156:159], a[68:71], v[48:63]
ds_read_b64_tr_b16 a[148:149], v14 offset:22528
ds_read_b64_tr_b16 a[150:151], v14 offset:22784
buffer_load_dwordx4 v11, s[20:23], s45 offen offset:1024 lds
v_exp_f32 v199, v199
v_exp_f32 v179, v179
s_waitcnt lgkmcnt(6)
v_mfma_f32_32x32x16_bf16 v[48:63], a[160:163], a[72:75], v[48:63]
ds_read_b64_tr_b16 a[152:153], v14 offset:23552
ds_read_b64_tr_b16 a[154:155], v14 offset:23808
v_add_f32 v226, v226, v198
v_add_f32 v227, v227, v178
v_fma_f32 v200, v180, v18, v224
v_fma_f32 v180, v180, -v18, v225
v_mfma_f32_32x32x16_bf16 v[48:63], a[164:167], a[76:79], v[48:63]
ds_read_b64_tr_b16 a[156:157], v14 offset:24576
ds_read_b64_tr_b16 a[158:159], v14 offset:24832
buffer_load_dwordx4 v11, s[20:23], s46 offen offset:2048 lds
v_exp_f32 v200, v200
v_exp_f32 v180, v180
s_waitcnt lgkmcnt(6)
v_mfma_f32_32x32x16_bf16 v[48:63], a[168:171], a[80:83], v[48:63]
ds_read_b64_tr_b16 a[160:161], v14 offset:25600
ds_read_b64_tr_b16 a[162:163], v14 offset:25856
v_add_f32 v226, v226, v199
v_add_f32 v227, v227, v179
v_fma_f32 v201, v181, v18, v224
v_fma_f32 v181, v181, -v18, v225
v_mfma_f32_32x32x16_bf16 v[48:63], a[144:147], a[84:87], v[48:63]
ds_read_b64_tr_b16 a[164:165], v14 offset:26624
ds_read_b64_tr_b16 a[166:167], v14 offset:26880
buffer_load_dwordx4 v11, s[20:23], s47 offen offset:3072 lds
v_exp_f32 v201, v201
v_exp_f32 v181, v181
s_waitcnt lgkmcnt(6)
v_mfma_f32_32x32x16_bf16 v[48:63], a[148:151], a[88:91], v[48:63]
ds_read_b64_tr_b16 a[168:169], v14 offset:27648
ds_read_b64_tr_b16 a[170:171], v14 offset:27904
s_add_u32 m0, s72, 45056
v_add_f32 v226, v226, v200
v_add_f32 v227, v227, v180
v_fma_f32 v202, v182, v18, v224
v_mfma_f32_32x32x16_bf16 v[48:63], a[152:155], a[92:95], v[48:63]
ds_read_b64_tr_b16 a[144:145], v14 offset:28672
ds_read_b64_tr_b16 a[146:147], v14 offset:28928
buffer_load_dwordx4 v11, s[20:23], s48 offen offset:0 lds
s_add_u32 s49, s71, 1
s_and_b32 s49, s49, 3
s_mul_i32 s49, s49, 331776
s_add_u32 s49, s49, s79
s_waitcnt lgkmcnt(6)
v_mfma_f32_32x32x16_bf16 v[48:63], a[156:159], a[96:99], v[48:63]
ds_read_b64_tr_b16 a[148:149], v14 offset:29696
ds_read_b64_tr_b16 a[150:151], v14 offset:29952
v_fma_f32 v182, v182, -v18, v225
v_exp_f32 v202, v202
v_mfma_f32_32x32x16_bf16 v[48:63], a[160:163], a[100:103], v[48:63]
ds_read_b64_tr_b16 a[152:153], v14 offset:30720
ds_read_b64_tr_b16 a[154:155], v14 offset:30976
v_exp_f32 v182, v182
v_add_f32 v226, v226, v201
v_add_f32 v227, v227, v181
v_fma_f32 v203, v183, v18, v224
s_waitcnt lgkmcnt(6)
v_mfma_f32_32x32x16_bf16 v[48:63], a[164:167], a[104:107], v[48:63]
ds_read_b64_tr_b16 a[156:157], v14 offset:31744
ds_read_b64_tr_b16 a[158:159], v14 offset:32000
buffer_load_dword a182, v21, s[24:27], s49 offen
s_add_u32 s49, s71, 2
s_and_b32 s49, s49, 3
s_mul_i32 s49, s49, 331776
s_add_u32 s49, s49, s79
v_mfma_f32_32x32x16_bf16 v[48:63], a[168:171], a[108:111], v[48:63]
ds_read_b64_tr_b16 a[160:161], v14 offset:32768
ds_read_b64_tr_b16 a[162:163], v14 offset:33024
buffer_load_dword a183, v21, s[24:27], s49 offen
v_fma_f32 v183, v183, -v18, v225
v_exp_f32 v203, v203
s_waitcnt lgkmcnt(6)
v_mfma_f32_32x32x16_bf16 v[48:63], a[144:147], a[112:115], v[48:63]
ds_read_b64_tr_b16 a[164:165], v14 offset:33792
ds_read_b64_tr_b16 a[166:167], v14 offset:34048
v_exp_f32 v183, v183
v_add_f32 v226, v226, v202
v_add_f32 v227, v227, v182
v_mfma_f32_32x32x16_bf16 v[48:63], a[148:151], a[116:119], v[48:63]
ds_read_b64_tr_b16 a[168:169], v14 offset:34816
ds_read_b64_tr_b16 a[170:171], v14 offset:35072
v_fma_f32 v204, v184, v18, v224
v_fma_f32 v184, v184, -v18, v225
v_exp_f32 v204, v204
s_waitcnt lgkmcnt(6)
v_mfma_f32_32x32x16_bf16 v[48:63], a[152:155], a[120:123], v[48:63]
ds_read_b64_tr_b16 a[144:145], v14 offset:35840
ds_read_b64_tr_b16 a[146:147], v14 offset:36096
s_waitcnt vmcnt(12)
s_barrier
v_exp_f32 v184, v184
v_mfma_f32_32x32x16_bf16 v[48:63], a[156:159], a[124:127], v[48:63]
v_add_u32 v14, 0, v13
ds_read_b64_tr_b16 a[148:149], v14 offset:0
ds_read_b64_tr_b16 a[150:151], v14 offset:256
v_add_f32 v226, v226, v203
v_add_f32 v227, v227, v183
v_fma_f32 v205, v185, v18, v224
v_fma_f32 v185, v185, -v18, v225
s_waitcnt lgkmcnt(6)
v_mfma_f32_32x32x16_bf16 v[48:63], a[160:163], a[128:131], v[48:63]
ds_read_b64_tr_b16 a[152:153], v14 offset:1024
ds_read_b64_tr_b16 a[154:155], v14 offset:1280
v_and_b32 v13, 0x1ff, v12
v_lshrrev_b32 v135, 9, v1
v_lshl_add_u32 v13, v135, 9, v13
v_mfma_f32_32x32x16_bf16 v[48:63], a[164:167], a[132:135], v[48:63]
ds_read_b64_tr_b16 a[156:157], v14 offset:2048
ds_read_b64_tr_b16 a[158:159], v14 offset:2304
v_exp_f32 v205, v205
v_exp_f32 v185, v185
v_add_f32 v226, v226, v204
s_waitcnt lgkmcnt(6)
v_mfma_f32_32x32x16_bf16 v[48:63], a[168:171], a[136:139], v[48:63]
ds_read_b64_tr_b16 a[160:161], v14 offset:3072
ds_read_b64_tr_b16 a[162:163], v14 offset:3328
v_add_f32 v227, v227, v184
v_add_f32 v226, v226, v205
v_add_f32 v227, v227, v185
v_mfma_f32_32x32x16_bf16 v[48:63], a[144:147], a[140:143], v[48:63]
ds_read_b64_tr_b16 a[164:165], v14 offset:4096
ds_read_b64_tr_b16 a[166:167], v14 offset:4352
v_rcp_f32 v226, v226
v_rcp_f32 v227, v227
v_mul_f32 v226, v17, v226
s_waitcnt lgkmcnt(6)
v_mfma_f32_32x32x16_bf16 v[32:47], a[148:151], a[0:3], 0
ds_read_b64_tr_b16 a[168:169], v14 offset:5120
ds_read_b64_tr_b16 a[170:171], v14 offset:5376
s_add_u32 m0, s72, 110592
v_mul_f32 v227, v17, v227
v_mul_f32 v188, v226, v188
v_mul_f32 v189, v226, v189
v_mfma_f32_32x32x16_bf16 v[32:47], a[152:155], a[4:7], v[32:47]
ds_read_b64_tr_b16 a[144:145], v14 offset:6144
ds_read_b64_tr_b16 a[146:147], v14 offset:6400
v_cvt_pk_bf16_f32 v206, v188, v189
v_mul_f32 v190, v226, v190
v_mul_f32 v191, v226, v191
v_cvt_pk_bf16_f32 v207, v190, v191
v_mul_f32 v192, v226, v192
s_waitcnt lgkmcnt(6)
v_mfma_f32_32x32x16_bf16 v[32:47], a[156:159], a[8:11], v[32:47]
ds_read_b64_tr_b16 a[148:149], v14 offset:7168
ds_read_b64_tr_b16 a[150:151], v14 offset:7424
v_cvt_pk_bf16_f32 v160, v48, v49
v_cvt_pk_bf16_f32 v161, v50, v51
v_cvt_pk_bf16_f32 v162, v52, v53
v_cvt_pk_bf16_f32 v163, v54, v55
v_mfma_f32_32x32x16_bf16 v[32:47], a[160:163], a[12:15], v[32:47]
ds_read_b64_tr_b16 a[152:153], v14 offset:8192
ds_read_b64_tr_b16 a[154:155], v14 offset:8448
v_cvt_pk_bf16_f32 v164, v56, v57
v_cvt_pk_bf16_f32 v165, v58, v59
v_cvt_pk_bf16_f32 v166, v60, v61
v_cvt_pk_bf16_f32 v167, v62, v63
v_mul_f32 v193, v226, v193
s_waitcnt lgkmcnt(6)
v_mfma_f32_32x32x16_bf16 v[32:47], a[164:167], a[16:19], v[32:47]
ds_read_b64_tr_b16 a[156:157], v14 offset:9216
ds_read_b64_tr_b16 a[158:159], v14 offset:9472
v_cvt_pk_bf16_f32 v208, v192, v193
v_mul_f32 v194, v226, v194
v_mul_f32 v195, v226, v195
v_cvt_pk_bf16_f32 v209, v194, v195
v_mfma_f32_32x32x16_bf16 v[32:47], a[168:171], a[20:23], v[32:47]
ds_read_b64_tr_b16 a[160:161], v14 offset:10240
ds_read_b64_tr_b16 a[162:163], v14 offset:10496
v_mul_f32 v196, v226, v196
v_mul_f32 v197, v226, v197
v_cvt_pk_bf16_f32 v210, v196, v197
v_mul_f32 v198, v226, v198
v_mul_f32 v199, v226, v199
s_waitcnt lgkmcnt(6)
v_mfma_f32_32x32x16_bf16 v[32:47], a[144:147], a[24:27], v[32:47]
ds_read_b64_tr_b16 a[164:165], v14 offset:11264
ds_read_b64_tr_b16 a[166:167], v14 offset:11520
buffer_load_dwordx4 v11, s[20:23], s88 offen offset:0 lds
v_cvt_pk_bf16_f32 v211, v198, v199
v_mul_f32 v200, v226, v200
v_mul_f32 v201, v226, v201
v_mfma_f32_32x32x16_bf16 v[32:47], a[148:151], a[28:31], v[32:47]
ds_read_b64_tr_b16 a[168:169], v14 offset:12288
ds_read_b64_tr_b16 a[170:171], v14 offset:12544
v_cvt_pk_bf16_f32 v212, v200, v201
v_mul_f32 v202, v226, v202
v_mul_f32 v203, v226, v203
v_cvt_pk_bf16_f32 v213, v202, v203
v_mul_f32 v204, v226, v204
s_waitcnt lgkmcnt(6)
v_mfma_f32_32x32x16_bf16 v[32:47], a[152:155], a[32:35], v[32:47]
ds_read_b64_tr_b16 a[144:145], v14 offset:13312
ds_read_b64_tr_b16 a[146:147], v14 offset:13568
buffer_load_dwordx4 v11, s[20:23], s89 offen offset:1024 lds
v_mul_f32 v205, v226, v205
v_cvt_pk_bf16_f32 v214, v204, v205
v_mul_f32 v168, v227, v168
v_mfma_f32_32x32x16_bf16 v[32:47], a[156:159], a[36:39], v[32:47]
ds_read_b64_tr_b16 a[148:149], v14 offset:14336
ds_read_b64_tr_b16 a[150:151], v14 offset:14592
v_mul_f32 v169, v227, v169
v_cvt_pk_bf16_f32 v215, v168, v169
v_mul_f32 v170, v227, v170
v_mul_f32 v171, v227, v171
v_cvt_pk_bf16_f32 v216, v170, v171
s_waitcnt lgkmcnt(6)
v_mfma_f32_32x32x16_bf16 v[32:47], a[160:163], a[40:43], v[32:47]
ds_read_b64_tr_b16 a[152:153], v14 offset:15360
ds_read_b64_tr_b16 a[154:155], v14 offset:15616
buffer_load_dwordx4 v11, s[20:23], s90 offen offset:2048 lds
v_and_b32 v24, 0xf8, v24
s_and_b32 s66, s70, 1
s_lshl1_add_u32 s66, s71, s66
v_mfma_f32_32x32x16_bf16 v[32:47], a[164:167], a[44:47], v[32:47]
ds_read_b64_tr_b16 a[156:157], v14 offset:16384
ds_read_b64_tr_b16 a[158:159], v14 offset:16640
s_add_u32 m0, s72, 113664
s_lshl_b32 s66, s66, 8
s_add_u32 s66, s66, 57344
buffer_load_dwordx2 v[22:23], v24, s[36:39], s66 offen sc1
v_mul_f32 v172, v227, v172
s_waitcnt lgkmcnt(6)
v_mfma_f32_32x32x16_bf16 v[32:47], a[168:171], a[48:51], v[32:47]
ds_read_b64_tr_b16 a[160:161], v14 offset:17408
ds_read_b64_tr_b16 a[162:163], v14 offset:17664
buffer_load_dwordx4 v11, s[20:23], s91 offen offset:0 lds
v_mul_f32 v173, v227, v173
v_cvt_pk_bf16_f32 v217, v172, v173
v_mul_f32 v174, v227, v174
v_mfma_f32_32x32x16_bf16 v[32:47], a[144:147], a[52:55], v[32:47]
ds_read_b64_tr_b16 a[164:165], v14 offset:18432
ds_read_b64_tr_b16 a[166:167], v14 offset:18688
v_mul_f32 v175, v227, v175
v_cvt_pk_bf16_f32 v218, v174, v175
v_mul_f32 v176, v227, v176
v_mul_f32 v177, v227, v177
v_cvt_pk_bf16_f32 v219, v176, v177
s_waitcnt lgkmcnt(6)
v_mfma_f32_32x32x16_bf16 v[32:47], a[148:151], a[56:59], v[32:47]
ds_read_b64_tr_b16 a[168:169], v14 offset:19456
ds_read_b64_tr_b16 a[170:171], v14 offset:19712
buffer_load_dwordx4 v11, s[20:23], s92 offen offset:1024 lds
v_mul_f32 v178, v227, v178
v_mul_f32 v179, v227, v179
v_cvt_pk_bf16_f32 v220, v178, v179
v_mfma_f32_32x32x16_bf16 v[32:47], a[152:155], a[60:63], v[32:47]
ds_read_b64_tr_b16 a[144:145], v14 offset:20480
ds_read_b64_tr_b16 a[146:147], v14 offset:20736
v_mul_f32 v180, v227, v180
v_mul_f32 v181, v227, v181
v_cvt_pk_bf16_f32 v221, v180, v181
v_mul_f32 v182, v227, v182
v_mul_f32 v183, v227, v183
s_waitcnt lgkmcnt(6)
v_mfma_f32_32x32x16_bf16 v[32:47], a[156:159], a[64:67], v[32:47]
ds_read_b64_tr_b16 a[148:149], v14 offset:21504
ds_read_b64_tr_b16 a[150:151], v14 offset:21760
v_cvt_pk_bf16_f32 v222, v182, v183
v_mul_f32 v184, v227, v184
v_mul_f32 v185, v227, v185
v_cvt_pk_bf16_f32 v223, v184, v185
v_mfma_f32_32x32x16_bf16 v[32:47], a[160:163], a[68:71], v[32:47]
ds_read_b64_tr_b16 a[152:153], v14 offset:22528
ds_read_b64_tr_b16 a[154:155], v14 offset:22784
buffer_load_dwordx4 v11, s[20:23], s93 offen offset:2048 lds
ds_write_b64 v26, v[206:207] offset:0
ds_write_b64 v26, v[208:209] offset:8
ds_write_b64 v26, v[210:211] offset:16
ds_write_b64 v26, v[212:213] offset:24
s_waitcnt lgkmcnt(10)
v_mfma_f32_32x32x16_bf16 v[32:47], a[164:167], a[72:75], v[32:47]
ds_read_b64_tr_b16 a[156:157], v14 offset:23552
ds_read_b64_tr_b16 a[158:159], v14 offset:23808
ds_write_b64 v26, v[214:215] offset:32
ds_write_b64 v26, v[216:217] offset:40
ds_write_b64 v26, v[218:219] offset:48
ds_write_b64 v26, v[220:221] offset:56
v_mfma_f32_32x32x16_bf16 v[32:47], a[168:171], a[76:79], v[32:47]
ds_read_b64_tr_b16 a[160:161], v14 offset:24576
ds_read_b64_tr_b16 a[162:163], v14 offset:24832
buffer_load_dwordx4 v11, s[20:23], s96 offen offset:3072 lds
ds_write_b64 v26, v[222:223] offset:64
ds_write_b64 v27, v[152:153] offset:144
ds_write_b64 v27, v[154:155] offset:160
ds_write_b64 v27, v[158:159] offset:200
s_waitcnt lgkmcnt(15)
v_mfma_f32_32x32x16_bf16 v[32:47], a[144:147], a[80:83], v[32:47]
ds_read_b64_tr_b16 a[164:165], v14 offset:25600
ds_read_b64_tr_b16 a[166:167], v14 offset:25856
s_add_u32 m0, s72, 117760
v_cndmask_b32 v30, v19, v146, s[98:99]
v_cndmask_b32 v31, v157, v147, s[98:99]
ds_write_b64 v29, v[30:31] offset:184
v_mfma_f32_32x32x16_bf16 v[32:47], a[148:151], a[84:87], v[32:47]
ds_read_b64_tr_b16 a[168:169], v14 offset:26624
ds_read_b64_tr_b16 a[170:171], v14 offset:26880
buffer_load_dwordx4 v11, s[20:23], s97 offen offset:0 lds
v_cndmask_b32 v157, v19, v157, s[98:99]
ds_write_b64 v28, v[156:157] offset:176
v_accvgpr_read_b32 v26, a246
v_accvgpr_read_b32 v27, a247
s_waitcnt lgkmcnt(15)
v_mfma_f32_32x32x16_bf16 v[32:47], a[152:155], a[88:91], v[32:47]
ds_read_b64_tr_b16 a[144:145], v14 offset:27648
ds_read_b64_tr_b16 a[146:147], v14 offset:27904
v_mfma_f32_32x32x16_bf16 v[32:47], a[156:159], a[92:95], v[32:47]
ds_read_b64_tr_b16 a[148:149], v14 offset:28672
ds_read_b64_tr_b16 a[150:151], v14 offset:28928
buffer_load_dwordx4 v11, s[20:23], s101 offen offset:1024 lds
s_add_u32 s49, s71, 3
s_and_b32 s49, s49, 3
s_mul_i32 s49, s49, 331776
s_add_u32 s49, s49, s79
s_waitcnt lgkmcnt(8)
v_mfma_f32_32x32x16_bf16 v[32:47], a[160:163], a[96:99], v[32:47]
ds_read_b64_tr_b16 a[152:153], v14 offset:29696
ds_read_b64_tr_b16 a[154:155], v14 offset:29952
v_mfma_f32_32x32x16_bf16 v[32:47], a[164:167], a[100:103], v[32:47]
ds_read_b64_tr_b16 a[156:157], v14 offset:30720
ds_read_b64_tr_b16 a[158:159], v14 offset:30976
s_waitcnt lgkmcnt(6)
v_mfma_f32_32x32x16_bf16 v[32:47], a[168:171], a[104:107], v[32:47]
ds_read_b64_tr_b16 a[160:161], v14 offset:31744
ds_read_b64_tr_b16 a[162:163], v14 offset:32000
buffer_load_dword a182, v21, s[24:27], s49 offen
v_mfma_f32_32x32x16_bf16 v[32:47], a[144:147], a[108:111], v[32:47]
ds_read_b64_tr_b16 a[164:165], v14 offset:32768
ds_read_b64_tr_b16 a[166:167], v14 offset:33024
s_waitcnt lgkmcnt(6)
v_mfma_f32_32x32x16_bf16 v[32:47], a[148:151], a[112:115], v[32:47]
ds_read_b64_tr_b16 a[168:169], v14 offset:33792
ds_read_b64_tr_b16 a[170:171], v14 offset:34048
v_mfma_f32_32x32x16_bf16 v[32:47], a[152:155], a[116:119], v[32:47]
ds_read_b64_tr_b16 a[144:145], v14 offset:34816
ds_read_b64_tr_b16 a[146:147], v14 offset:35072
s_waitcnt lgkmcnt(6)
v_mfma_f32_32x32x16_bf16 v[32:47], a[156:159], a[120:123], v[32:47]
ds_read_b64_tr_b16 a[148:149], v14 offset:35840
ds_read_b64_tr_b16 a[150:151], v14 offset:36096
s_waitcnt vmcnt(13)
s_barrier
v_mfma_f32_32x32x16_bf16 v[32:47], a[160:163], a[124:127], v[32:47]
v_add_u32 v14, 36864, v12
ds_read_b64_tr_b16 a[152:153], v14 offset:0
ds_read_b64_tr_b16 a[154:155], v14 offset:512
ds_read_b64_tr_b16 v[188:189], v26 offset:0
ds_read_b64_tr_b16 v[190:191], v26 offset:464
ds_read_b64_tr_b16 v[204:205], v27 offset:0
ds_read_b64_tr_b16 v[206:207], v27 offset:464
s_waitcnt lgkmcnt(10)
v_mfma_f32_32x32x16_bf16 v[32:47], a[164:167], a[128:131], v[32:47]
ds_read_b64_tr_b16 a[156:157], v14 offset:18432
ds_read_b64_tr_b16 a[158:159], v14 offset:18944
s_waitcnt vmcnt(7)
v_cmp_ne_u64 vcc, s[94:95], v[22:23]
s_nop 0
s_cbranch_vccnz SLOW_wo
BACK_wo:
ds_read_b64_tr_b16 v[192:193], v26 offset:7424
v_mfma_f32_32x32x16_bf16 v[32:47], a[168:171], a[132:135], v[32:47]
ds_read_b64_tr_b16 a[160:161], v14 offset:1024
ds_read_b64_tr_b16 a[162:163], v14 offset:1536
ds_read_b64_tr_b16 v[194:195], v26 offset:7888
ds_read_b64_tr_b16 v[208:209], v27 offset:7424
ds_read_b64_tr_b16 v[210:211], v27 offset:7888
ds_read_b64_tr_b16 v[196:197], v26 offset:14848
ds_read_b64_tr_b16 v[198:199], v26 offset:15312
s_waitcnt lgkmcnt(15)
v_mfma_f32_32x32x16_bf16 v[32:47], a[144:147], a[136:139], v[32:47]
ds_read_b64_tr_b16 a[164:165], v14 offset:19456
ds_read_b64_tr_b16 a[166:167], v14 offset:19968
ds_read_b64_tr_b16 v[212:213], v27 offset:14848
ds_read_b64_tr_b16 v[214:215], v27 offset:15312
ds_read_b64_tr_b16 v[200:201], v26 offset:22272
ds_read_b64_tr_b16 v[202:203], v26 offset:22736
v_mfma_f32_32x32x16_bf16 v[32:47], a[148:151], a[140:143], v[32:47]
ds_read_b64_tr_b16 a[168:169], v14 offset:2048
ds_read_b64_tr_b16 a[170:171], v14 offset:2560
ds_read_b64_tr_b16 v[216:217], v27 offset:22272
ds_read_b64_tr_b16 v[218:219], v27 offset:22736
v_accvgpr_read_b32 v28, a244
v_accvgpr_read_b32 v29, a245
s_waitcnt lgkmcnt(15)
v_mfma_f32_16x16x32_bf16 v[168:171], v[188:191], v[204:207], 0
ds_read_b64_tr_b16 v[220:221], v27 offset:32
v_mfma_f32_32x32x16_bf16 v[48:63], a[152:155], a[0:3], 0
ds_read_b64_tr_b16 a[144:145], v14 offset:20480
ds_read_b64_tr_b16 a[146:147], v14 offset:20992
v_add_u32 v11, 128, v11
s_add_u32 m0, s72, 0
ds_read_b64_tr_b16 v[222:223], v27 offset:496
s_waitcnt lgkmcnt(15)
v_mfma_f32_16x16x32_bf16 v[168:171], v[192:195], v[208:211], v[168:171]
ds_read_b64_tr_b16 v[224:225], v27 offset:7456
v_mfma_f32_32x32x16_bf16 v[48:63], a[156:159], a[4:7], v[48:63]
ds_read_b64_tr_b16 a[148:149], v14 offset:3072
ds_read_b64_tr_b16 a[150:151], v14 offset:3584
ds_read_b64_tr_b16 v[226:227], v27 offset:7920
s_waitcnt lgkmcnt(14)
v_mfma_f32_16x16x32_bf16 v[168:171], v[196:199], v[212:215], v[168:171]
ds_read_b64_tr_b16 v[204:205], v27 offset:14880
v_mfma_f32_32x32x16_bf16 v[48:63], a[160:163], a[8:11], v[48:63]
ds_read_b64_tr_b16 a[152:153], v14 offset:21504
ds_read_b64_tr_b16 a[154:155], v14 offset:22016
v_cvt_pk_bf16_f32 v96, v32, v33
v_cvt_pk_bf16_f32 v97, v34, v35
v_cvt_pk_bf16_f32 v98, v36, v37
v_cvt_pk_bf16_f32 v99, v38, v39
v_mfma_f32_32x32x16_bf16 v[48:63], a[164:167], a[12:15], v[48:63]
ds_read_b64_tr_b16 a[156:157], v14 offset:4096
ds_read_b64_tr_b16 a[158:159], v14 offset:4608
v_cvt_pk_bf16_f32 v100, v40, v41
v_cvt_pk_bf16_f32 v101, v42, v43
v_cvt_pk_bf16_f32 v102, v44, v45
v_cvt_pk_bf16_f32 v103, v46, v47
v_pk_max_i16 v96, v96, 0
s_waitcnt lgkmcnt(10)
v_mfma_f32_32x32x16_bf16 v[48:63], a[168:171], a[16:19], v[48:63]
ds_read_b64_tr_b16 a[160:161], v14 offset:22528
ds_read_b64_tr_b16 a[162:163], v14 offset:23040
v_pk_max_i16 v97, v97, 0
v_pk_max_i16 v98, v98, 0
v_pk_max_i16 v99, v99, 0
v_pk_max_i16 v100, v100, 0
v_mfma_f32_32x32x16_bf16 v[48:63], a[144:147], a[20:23], v[48:63]
ds_read_b64_tr_b16 a[164:165], v14 offset:5120
ds_read_b64_tr_b16 a[166:167], v14 offset:5632
v_pk_max_i16 v101, v101, 0
v_pk_max_i16 v102, v102, 0
v_pk_max_i16 v103, v103, 0
s_add_u32 s73, s73, 2097152
buffer_store_dwordx4 v[96:99], v1, s[36:39], s73 offen offset:0 sc1
s_waitcnt lgkmcnt(6)
v_mfma_f32_32x32x16_bf16 v[48:63], a[148:151], a[24:27], v[48:63]
ds_read_b64_tr_b16 a[168:169], v14 offset:23552
ds_read_b64_tr_b16 a[170:171], v14 offset:24064
buffer_load_dwordx4 v11, s[20:23], s40 offen offset:0 lds
buffer_store_dwordx4 v[100:103], v1, s[36:39], s73 offen offset:1024 sc1
ds_read_b64_tr_b16 v[206:207], v27 offset:15344
v_mfma_f32_16x16x32_bf16 v[168:171], v[200:203], v[216:219], v[168:171]
ds_read_b64_tr_b16 v[208:209], v27 offset:22304
v_mfma_f32_32x32x16_bf16 v[48:63], a[152:155], a[28:31], v[48:63]
ds_read_b64_tr_b16 a[144:145], v14 offset:6144
ds_read_b64_tr_b16 a[146:147], v14 offset:6656
ds_read_b64_tr_b16 v[210:211], v27 offset:22768
v_mfma_f32_16x16x32_bf16 v[172:175], v[188:191], v[220:223], 0
ds_read_b64_tr_b16 v[212:213], v27 offset:64
s_waitcnt lgkmcnt(10)
v_mfma_f32_32x32x16_bf16 v[48:63], a[156:159], a[32:35], v[48:63]
ds_read_b64_tr_b16 a[148:149], v14 offset:24576
ds_read_b64_tr_b16 a[150:151], v14 offset:25088
buffer_load_dwordx4 v11, s[20:23], s41 offen offset:1024 lds
ds_read_b64_tr_b16 v[214:215], v27 offset:528
v_mfma_f32_16x16x32_bf16 v[172:175], v[192:195], v[224:227], v[172:175]
ds_read_b64_tr_b16 v[216:217], v27 offset:7488
v_mfma_f32_32x32x16_bf16 v[48:63], a[160:163], a[36:39], v[48:63]
ds_read_b64_tr_b16 a[152:153], v14 offset:7168
ds_read_b64_tr_b16 a[154:155], v14 offset:7680
ds_read_b64_tr_b16 v[218:219], v27 offset:7952
s_waitcnt lgkmcnt(12)
v_mfma_f32_16x16x32_bf16 v[172:175], v[196:199], v[204:207], v[172:175]
ds_read_b64_tr_b16 v[220:221], v27 offset:14912
v_mfma_f32_32x32x16_bf16 v[48:63], a[164:167], a[40:43], v[48:63]
ds_read_b64_tr_b16 a[156:157], v14 offset:25600
ds_read_b64_tr_b16 a[158:159], v14 offset:26112
ds_read_b64_tr_b16 v[222:223], v27 offset:15376
s_waitcnt lgkmcnt(12)
v_mfma_f32_16x16x32_bf16 v[172:175], v[200:203], v[208:211], v[172:175]
ds_read_b64_tr_b16 v[224:225], v27 offset:22336
v_mfma_f32_32x32x16_bf16 v[48:63], a[168:171], a[44:47], v[48:63]
ds_read_b64_tr_b16 a[160:161], v14 offset:8192
ds_read_b64_tr_b16 a[162:163], v14 offset:8704
buffer_load_dwordx4 v11, s[20:23], s42 offen offset:2048 lds
ds_read_b64_tr_b16 v[226:227], v27 offset:22800
s_waitcnt lgkmcnt(12)
v_mfma_f32_16x16x32_bf16 v[176:179], v[188:191], v[212:215], 0
s_waitcnt lgkmcnt(8)
v_mfma_f32_16x16x32_bf16 v[176:179], v[192:195], v[216:219], v[176:179]
v_mfma_f32_32x32x16_bf16 v[48:63], a[144:147], a[48:51], v[48:63]
ds_read_b64_tr_b16 a[164:165], v14 offset:26624
ds_read_b64_tr_b16 a[166:167], v14 offset:27136
s_waitcnt lgkmcnt(6)
v_mfma_f32_16x16x32_bf16 v[176:179], v[196:199], v[220:223], v[176:179]
s_waitcnt lgkmcnt(2)
v_mfma_f32_16x16x32_bf16 v[176:179], v[200:203], v[224:227], v[176:179]
v_cvt_pk_bf16_f32 v168, v168, v169
v_mfma_f32_32x32x16_bf16 v[48:63], a[148:151], a[52:55], v[48:63]
v_xor_b32 v14, 64, v14
ds_read_b64_tr_b16 a[168:169], v14 offset:0
ds_read_b64_tr_b16 a[170:171], v14 offset:512
buffer_load_dwordx4 v11, s[20:23], s43 offen offset:3072 lds
v_cvt_pk_bf16_f32 v169, v170, v171
v_cvt_pk_bf16_f32 v172, v172, v173
v_cvt_pk_bf16_f32 v173, v174, v175
v_mfma_f32_32x32x16_bf16 v[48:63], a[152:155], a[56:59], v[48:63]
ds_read_b64_tr_b16 a[144:145], v14 offset:18432
ds_read_b64_tr_b16 a[146:147], v14 offset:18944
v_cvt_pk_bf16_f32 v176, v176, v177
v_cvt_pk_bf16_f32 v177, v178, v179
buffer_store_dwordx2 v[168:169], v28, s[36:39], s58 offen offset:0 sc1
buffer_store_dwordx2 v[172:173], v28, s[36:39], s58 offen offset:128 sc1
v_mfma_f32_32x32x16_bf16 v[48:63], a[156:159], a[60:63], v[48:63]
ds_read_b64_tr_b16 a[148:149], v14 offset:1024
ds_read_b64_tr_b16 a[150:151], v14 offset:1536
s_add_u32 m0, s72, 4096
buffer_store_dwordx2 v[176:177], v29, s[36:39], s58 offen offset:256 sc1
v_mfma_f32_32x32x16_bf16 v[168:183], a[184:187], v[160:163], 0
v_mfma_f32_32x32x16_bf16 v[168:183], a[188:191], v[164:167], v[168:183]
s_waitcnt lgkmcnt(6)
v_mfma_f32_32x32x16_bf16 v[48:63], a[160:163], a[64:67], v[48:63]
ds_read_b64_tr_b16 a[152:153], v14 offset:19456
ds_read_b64_tr_b16 a[154:155], v14 offset:19968
buffer_load_dwordx4 v11, s[20:23], s44 offen offset:0 lds
v_mfma_f32_32x32x16_bf16 v[168:183], a[192:195], v[148:151], v[168:183]
v_mfma_f32_16x16x32_bf16 v[184:187], a[196:199], v[160:163], 0
v_mfma_f32_32x32x16_bf16 v[48:63], a[164:167], a[68:71], v[48:63]
ds_read_b64_tr_b16 a[156:157], v14 offset:2048
ds_read_b64_tr_b16 a[158:159], v14 offset:2560
v_mfma_f32_16x16x32_bf16 v[184:187], a[200:203], v[164:167], v[184:187]
v_mfma_f32_16x16x32_bf16 v[184:187], a[204:207], v[148:151], v[184:187]
s_waitcnt lgkmcnt(6)
v_mfma_f32_32x32x16_bf16 v[32:47], a[168:171], a[0:3], 0
ds_read_b64_tr_b16 a[160:161], v14 offset:20480
ds_read_b64_tr_b16 a[162:163], v14 offset:20992
buffer_load_dwordx4 v11, s[20:23], s45 offen offset:1024 lds
v_mfma_f32_32x32x16_bf16 v[32:47], a[144:147], a[4:7], v[32:47]
ds_read_b64_tr_b16 a[164:165], v14 offset:3072
ds_read_b64_tr_b16 a[166:167], v14 offset:3584
s_waitcnt lgkmcnt(6)
v_mfma_f32_32x32x16_bf16 v[32:47], a[148:151], a[8:11], v[32:47]
ds_read_b64_tr_b16 a[168:169], v14 offset:21504
ds_read_b64_tr_b16 a[170:171], v14 offset:22016
v_max3_f32 v154, v168, v169, v170
v_min3_f32 v155, v168, v169, v170
v_max3_f32 v154, v154, v171, v172
v_min3_f32 v155, v155, v171, v172
v_mfma_f32_32x32x16_bf16 v[32:47], a[152:155], a[12:15], v[32:47]
ds_read_b64_tr_b16 a[144:145], v14 offset:4096
ds_read_b64_tr_b16 a[146:147], v14 offset:4608
buffer_load_dwordx4 v11, s[20:23], s46 offen offset:2048 lds
v_max3_f32 v154, v154, v173, v174
v_min3_f32 v155, v155, v173, v174
v_max3_f32 v154, v154, v175, v176
v_min3_f32 v155, v155, v175, v176
s_waitcnt lgkmcnt(6)
v_mfma_f32_32x32x16_bf16 v[32:47], a[156:159], a[16:19], v[32:47]
ds_read_b64_tr_b16 a[148:149], v14 offset:22528
ds_read_b64_tr_b16 a[150:151], v14 offset:23040
v_max3_f32 v154, v154, v177, v178
v_min3_f32 v155, v155, v177, v178
v_max3_f32 v154, v154, v179, v180
v_min3_f32 v155, v155, v179, v180
v_mfma_f32_32x32x16_bf16 v[32:47], a[160:163], a[20:23], v[32:47]
ds_read_b64_tr_b16 a[152:153], v14 offset:5120
ds_read_b64_tr_b16 a[154:155], v14 offset:5632
buffer_load_dwordx4 v11, s[20:23], s47 offen offset:3072 lds
v_max3_f32 v154, v154, v181, v182
v_min3_f32 v155, v155, v181, v182
v_max3_f32 v154, v154, v183, v184
v_min3_f32 v155, v155, v183, v184
s_waitcnt lgkmcnt(6)
v_mfma_f32_32x32x16_bf16 v[32:47], a[164:167], a[24:27], v[32:47]
ds_read_b64_tr_b16 a[156:157], v14 offset:23552
ds_read_b64_tr_b16 a[158:159], v14 offset:24064
v_max_f32 v154, v154, v185
v_min_f32 v155, v155, v185
v_mul_f32_e64 v154, -v18, v154
v_mul_f32 v155, v18, v155
v_mfma_f32_32x32x16_bf16 v[32:47], a[168:171], a[28:31], v[32:47]
ds_read_b64_tr_b16 a[160:161], v14 offset:6144
ds_read_b64_tr_b16 a[162:163], v14 offset:6656
s_add_u32 m0, s72, 8192
v_fma_f32 v136, v168, v18, v154
v_fma_f32 v168, v168, -v18, v155
v_exp_f32 v136, v136
s_waitcnt lgkmcnt(6)
v_mfma_f32_32x32x16_bf16 v[32:47], a[144:147], a[32:35], v[32:47]
ds_read_b64_tr_b16 a[164:165], v14 offset:24576
ds_read_b64_tr_b16 a[166:167], v14 offset:25088
buffer_load_dwordx4 v11, s[20:23], s48 offen offset:0 lds
v_exp_f32 v168, v168
v_fma_f32 v137, v169, v18, v154
v_mfma_f32_32x32x16_bf16 v[32:47], a[148:151], a[36:39], v[32:47]
ds_read_b64_tr_b16 a[168:169], v14 offset:7168
ds_read_b64_tr_b16 a[170:171], v14 offset:7680
v_fma_f32 v169, v169, -v18, v155
v_exp_f32 v137, v137
v_exp_f32 v169, v169
s_waitcnt lgkmcnt(6)
v_mfma_f32_32x32x16_bf16 v[32:47], a[152:155], a[40:43], v[32:47]
ds_read_b64_tr_b16 a[144:145], v14 offset:25600
ds_read_b64_tr_b16 a[146:147], v14 offset:26112
v_fma_f32 v138, v170, v18, v154
v_fma_f32 v170, v170, -v18, v155
v_exp_f32 v138, v138
v_mfma_f32_32x32x16_bf16 v[32:47], a[156:159], a[44:47], v[32:47]
ds_read_b64_tr_b16 a[148:149], v14 offset:8192
ds_read_b64_tr_b16 a[150:151], v14 offset:8704
v_exp_f32 v170, v170
v_add_f32 v156, v136, v137
v_add_f32 v157, v168, v169
v_fma_f32 v139, v171, v18, v154
s_waitcnt lgkmcnt(6)
v_mfma_f32_32x32x16_bf16 v[32:47], a[160:163], a[48:51], v[32:47]
ds_read_b64_tr_b16 a[152:153], v14 offset:26624
ds_read_b64_tr_b16 a[154:155], v14 offset:27136
s_waitcnt vmcnt(15)
s_barrier
v_fma_f32 v171, v171, -v18, v155
v_mfma_f32_32x32x16_bf16 v[32:47], a[164:167], a[52:55], v[32:47]
v_add_u32 v14, 110592, v12
ds_read_b64_tr_b16 a[156:157], v14 offset:0
ds_read_b64_tr_b16 a[158:159], v14 offset:512
v_exp_f32 v139, v139
v_exp_f32 v171, v171
s_waitcnt lgkmcnt(6)
v_mfma_f32_32x32x16_bf16 v[32:47], a[168:171], a[56:59], v[32:47]
ds_read_b64_tr_b16 a[160:161], v14 offset:18432
ds_read_b64_tr_b16 a[162:163], v14 offset:18944
s_add_u32 m0, s72, 36864
s_waitcnt vmcnt(11)
buffer_store_dwordx2 a[180:181], v15, s[36:39], s74 offen sc1
v_add_f32 v156, v156, v138
v_mfma_f32_32x32x16_bf16 v[32:47], a[144:147], a[60:63], v[32:47]
ds_read_b64_tr_b16 a[164:165], v14 offset:1024
ds_read_b64_tr_b16 a[166:167], v14 offset:1536
v_add_f32 v157, v157, v170
v_fma_f32 v140, v172, v18, v154
v_fma_f32 v172, v172, -v18, v155
v_exp_f32 v140, v140
s_waitcnt lgkmcnt(6)
v_mfma_f32_32x32x16_bf16 v[32:47], a[148:151], a[64:67], v[32:47]
ds_read_b64_tr_b16 a[168:169], v14 offset:19456
ds_read_b64_tr_b16 a[170:171], v14 offset:19968
s_waitcnt vmcnt(6)
buffer_store_dwordx2 a[180:181], v15, s[36:39], s75 offen sc1
v_lshrrev_b32 v26, 1, v1
s_and_b32 s60, s75, 0xfffffe00
v_mfma_f32_32x32x16_bf16 v[32:47], a[152:155], a[68:71], v[32:47]
ds_read_b64_tr_b16 a[144:145], v14 offset:2048
ds_read_b64_tr_b16 a[146:147], v14 offset:2560
v_exp_f32 v172, v172
v_add_f32 v156, v156, v139
v_add_f32 v157, v157, v171
v_fma_f32 v141, v173, v18, v154
s_waitcnt lgkmcnt(6)
v_mfma_f32_32x32x16_bf16 v[48:63], a[156:159], a[72:75], v[48:63]
ds_read_b64_tr_b16 a[148:149], v14 offset:20480
ds_read_b64_tr_b16 a[150:151], v14 offset:20992
buffer_load_dwordx4 v11, s[20:23], s88 offen offset:0 lds
v_fma_f32 v173, v173, -v18, v155
v_mfma_f32_32x32x16_bf16 v[48:63], a[160:163], a[76:79], v[48:63]
ds_read_b64_tr_b16 a[152:153], v14 offset:3072
ds_read_b64_tr_b16 a[154:155], v14 offset:3584
buffer_load_dwordx4 v11, s[20:23], s89 offen offset:1024 lds
v_exp_f32 v141, v141
s_waitcnt lgkmcnt(6)
v_mfma_f32_32x32x16_bf16 v[48:63], a[164:167], a[80:83], v[48:63]
ds_read_b64_tr_b16 a[156:157], v14 offset:21504
ds_read_b64_tr_b16 a[158:159], v14 offset:22016
v_exp_f32 v173, v173
v_add_f32 v156, v156, v140
v_mfma_f32_32x32x16_bf16 v[48:63], a[168:171], a[84:87], v[48:63]
ds_read_b64_tr_b16 a[160:161], v14 offset:4096
ds_read_b64_tr_b16 a[162:163], v14 offset:4608
buffer_load_dwordx4 v11, s[20:23], s90 offen offset:2048 lds
s_add_u32 m0, s72, 39936
v_add_f32 v157, v157, v172
v_fma_f32 v142, v174, v18, v154
s_waitcnt lgkmcnt(6)
v_mfma_f32_32x32x16_bf16 v[48:63], a[144:147], a[88:91], v[48:63]
ds_read_b64_tr_b16 a[164:165], v14 offset:22528
ds_read_b64_tr_b16 a[166:167], v14 offset:23040
buffer_load_dwordx4 v11, s[20:23], s91 offen offset:0 lds
v_fma_f32 v174, v174, -v18, v155
v_mfma_f32_32x32x16_bf16 v[48:63], a[148:151], a[92:95], v[48:63]
ds_read_b64_tr_b16 a[168:169], v14 offset:5120
ds_read_b64_tr_b16 a[170:171], v14 offset:5632
v_exp_f32 v142, v142
v_exp_f32 v174, v174
s_waitcnt lgkmcnt(6)
v_mfma_f32_32x32x16_bf16 v[48:63], a[152:155], a[96:99], v[48:63]
ds_read_b64_tr_b16 a[144:145], v14 offset:23552
ds_read_b64_tr_b16 a[146:147], v14 offset:24064
buffer_load_dwordx4 v11, s[20:23], s92 offen offset:1024 lds
v_add_f32 v156, v156, v141
v_add_f32 v157, v157, v173
v_mfma_f32_32x32x16_bf16 v[48:63], a[156:159], a[100:103], v[48:63]
ds_read_b64_tr_b16 a[148:149], v14 offset:6144
ds_read_b64_tr_b16 a[150:151], v14 offset:6656
buffer_load_dwordx4 v11, s[20:23], s93 offen offset:2048 lds
v_fma_f32 v143, v175, v18, v154
v_fma_f32 v175, v175, -v18, v155
s_waitcnt lgkmcnt(6)
v_mfma_f32_32x32x16_bf16 v[48:63], a[160:163], a[104:107], v[48:63]
ds_read_b64_tr_b16 a[152:153], v14 offset:24576
ds_read_b64_tr_b16 a[154:155], v14 offset:25088
v_exp_f32 v143, v143
v_mfma_f32_32x32x16_bf16 v[48:63], a[164:167], a[108:111], v[48:63]
ds_read_b64_tr_b16 a[156:157], v14 offset:7168
ds_read_b64_tr_b16 a[158:159], v14 offset:7680
buffer_load_dwordx4 v11, s[20:23], s96 offen offset:3072 lds
s_add_u32 m0, s72, 44032
v_exp_f32 v175, v175
s_waitcnt lgkmcnt(6)
v_mfma_f32_32x32x16_bf16 v[48:63], a[168:171], a[112:115], v[48:63]
ds_read_b64_tr_b16 a[160:161], v14 offset:25600
ds_read_b64_tr_b16 a[162:163], v14 offset:26112
buffer_load_dwordx4 v11, s[20:23], s97 offen offset:0 lds
v_add_f32 v156, v156, v142
v_add_f32 v157, v157, v174
v_mfma_f32_32x32x16_bf16 v[48:63], a[144:147], a[116:119], v[48:63]
ds_read_b64_tr_b16 a[164:165], v14 offset:8192
ds_read_b64_tr_b16 a[166:167], v14 offset:8704
v_fma_f32 v144, v176, v18, v154
v_fma_f32 v176, v176, -v18, v155
v_exp_f32 v144, v144
s_waitcnt lgkmcnt(6)
v_mfma_f32_32x32x16_bf16 v[48:63], a[148:151], a[120:123], v[48:63]
ds_read_b64_tr_b16 a[168:169], v14 offset:26624
ds_read_b64_tr_b16 a[170:171], v14 offset:27136
buffer_load_dwordx4 v11, s[20:23], s101 offen offset:1024 lds
s_lshl_b32 s50, s71, 1
s_and_b32 s49, s70, 1
s_add_u32 s50, s50, s49
v_mfma_f32_32x32x16_bf16 v[48:63], a[152:155], a[124:127], v[48:63]
v_xor_b32 v14, 64, v14
ds_read_b64_tr_b16 a[144:145], v14 offset:0
ds_read_b64_tr_b16 a[146:147], v14 offset:512
s_mul_i32 s50, s50, 82944
s_add_u32 s50, s50, s72
s_add_u32 s49, s50, 4194304
s_add_u32 m0, s72, 73728
s_waitcnt lgkmcnt(6)
v_mfma_f32_32x32x16_bf16 v[48:63], a[156:159], a[128:131], v[48:63]
ds_read_b64_tr_b16 a[148:149], v14 offset:18432
ds_read_b64_tr_b16 a[150:151], v14 offset:18944
buffer_load_dwordx4 v1, s[36:39], s49 offen offset:0 sc1 lds
v_exp_f32 v176, v176
v_mfma_f32_32x32x16_bf16 v[48:63], a[160:163], a[132:135], v[48:63]
ds_read_b64_tr_b16 a[152:153], v14 offset:1024
ds_read_b64_tr_b16 a[154:155], v14 offset:1536
buffer_load_dwordx4 v1, s[36:39], s49 offen offset:1024 sc1 lds
v_add_f32 v156, v156, v143
v_add_f32 v157, v157, v175
v_fma_f32 v145, v177, v18, v154
s_waitcnt lgkmcnt(6)
v_mfma_f32_32x32x16_bf16 v[48:63], a[164:167], a[136:139], v[48:63]
ds_read_b64_tr_b16 a[156:157], v14 offset:19456
ds_read_b64_tr_b16 a[158:159], v14 offset:19968
v_fma_f32 v177, v177, -v18, v155
v_exp_f32 v145, v145
v_mfma_f32_32x32x16_bf16 v[48:63], a[168:171], a[140:143], v[48:63]
ds_read_b64_tr_b16 a[160:161], v14 offset:2048
ds_read_b64_tr_b16 a[162:163], v14 offset:2560
buffer_load_dwordx4 v1, s[36:39], s49 offen offset:2048 sc1 lds
v_exp_f32 v177, v177
v_add_f32 v156, v156, v144
s_waitcnt lgkmcnt(6)
v_mfma_f32_32x32x16_bf16 v[32:47], a[144:147], a[72:75], v[32:47]
ds_read_b64_tr_b16 a[164:165], v14 offset:20480
ds_read_b64_tr_b16 a[166:167], v14 offset:20992
buffer_load_dwordx4 v1, s[36:39], s49 offen offset:3072 sc1 lds
v_add_f32 v157, v157, v176
v_fma_f32 v146, v178, v18, v154
v_mfma_f32_32x32x16_bf16 v[32:47], a[148:151], a[76:79], v[32:47]
ds_read_b64_tr_b16 a[168:169], v14 offset:3072
ds_read_b64_tr_b16 a[170:171], v14 offset:3584
s_add_u32 s49, s50, 4198400
s_add_u32 m0, s72, 77824
v_fma_f32 v178, v178, -v18, v155
s_waitcnt lgkmcnt(6)
v_mfma_f32_32x32x16_bf16 v[32:47], a[152:155], a[80:83], v[32:47]
ds_read_b64_tr_b16 a[144:145], v14 offset:21504
ds_read_b64_tr_b16 a[146:147], v14 offset:22016
buffer_load_dwordx4 v1, s[36:39], s49 offen offset:0 sc1 lds
v_cvt_pk_bf16_f32 v104, v48, v49
v_cvt_pk_bf16_f32 v105, v50, v51
v_mfma_f32_32x32x16_bf16 v[32:47], a[156:159], a[84:87], v[32:47]
ds_read_b64_tr_b16 a[148:149], v14 offset:4096
ds_read_b64_tr_b16 a[150:151], v14 offset:4608
buffer_load_dwordx4 v1, s[36:39], s49 offen offset:1024 sc1 lds
v_cvt_pk_bf16_f32 v106, v52, v53
v_cvt_pk_bf16_f32 v107, v54, v55
v_cvt_pk_bf16_f32 v108, v56, v57
s_waitcnt lgkmcnt(6)
v_mfma_f32_32x32x16_bf16 v[32:47], a[160:163], a[88:91], v[32:47]
ds_read_b64_tr_b16 a[152:153], v14 offset:22528
ds_read_b64_tr_b16 a[154:155], v14 offset:23040
v_cvt_pk_bf16_f32 v109, v58, v59
v_cvt_pk_bf16_f32 v110, v60, v61
v_cvt_pk_bf16_f32 v111, v62, v63
v_mfma_f32_32x32x16_bf16 v[32:47], a[164:167], a[92:95], v[32:47]
ds_read_b64_tr_b16 a[156:157], v14 offset:5120
ds_read_b64_tr_b16 a[158:159], v14 offset:5632
buffer_load_dwordx4 v1, s[36:39], s49 offen offset:2048 sc1 lds
v_pk_max_i16 v104, v104, 0
v_pk_max_i16 v105, v105, 0
v_pk_max_i16 v106, v106, 0
s_waitcnt lgkmcnt(6)
v_mfma_f32_32x32x16_bf16 v[32:47], a[168:171], a[96:99], v[32:47]
ds_read_b64_tr_b16 a[160:161], v14 offset:23552
ds_read_b64_tr_b16 a[162:163], v14 offset:24064
buffer_load_dwordx4 v1, s[36:39], s49 offen offset:3072 sc1 lds
v_pk_max_i16 v107, v107, 0
v_pk_max_i16 v108, v108, 0
v_mfma_f32_32x32x16_bf16 v[32:47], a[144:147], a[100:103], v[32:47]
ds_read_b64_tr_b16 a[164:165], v14 offset:6144
ds_read_b64_tr_b16 a[166:167], v14 offset:6656
s_add_u32 s49, s50, 4202496
s_add_u32 m0, s72, 81920
v_pk_max_i16 v109, v109, 0
v_pk_max_i16 v110, v110, 0
s_waitcnt lgkmcnt(6)
v_mfma_f32_32x32x16_bf16 v[32:47], a[148:151], a[104:107], v[32:47]
ds_read_b64_tr_b16 a[168:169], v14 offset:24576
ds_read_b64_tr_b16 a[170:171], v14 offset:25088
buffer_load_dwordx4 v1, s[36:39], s49 offen offset:0 sc1 lds
v_pk_max_i16 v111, v111, 0
s_add_u32 s73, s73, 2097152
v_mfma_f32_32x32x16_bf16 v[32:47], a[152:155], a[108:111], v[32:47]
ds_read_b64_tr_b16 a[144:145], v14 offset:7168
ds_read_b64_tr_b16 a[146:147], v14 offset:7680
buffer_store_dwordx4 v[104:107], v1, s[36:39], s73 offen offset:0 sc1
buffer_store_dwordx4 v[108:111], v1, s[36:39], s73 offen offset:1024 sc1
v_exp_f32 v146, v146
s_waitcnt lgkmcnt(6)
v_mfma_f32_32x32x16_bf16 v[32:47], a[156:159], a[112:115], v[32:47]
ds_read_b64_tr_b16 a[148:149], v14 offset:25600
ds_read_b64_tr_b16 a[150:151], v14 offset:26112
v_exp_f32 v178, v178
v_add_f32 v156, v156, v145
v_mfma_f32_32x32x16_bf16 v[32:47], a[160:163], a[116:119], v[32:47]
ds_read_b64_tr_b16 a[152:153], v14 offset:8192
ds_read_b64_tr_b16 a[154:155], v14 offset:8704
v_add_f32 v157, v157, v177
v_fma_f32 v147, v179, v18, v154
v_fma_f32 v179, v179, -v18, v155
s_waitcnt lgkmcnt(6)
v_mfma_f32_32x32x16_bf16 v[32:47], a[164:167], a[120:123], v[32:47]
ds_read_b64_tr_b16 a[156:157], v14 offset:26624
ds_read_b64_tr_b16 a[158:159], v14 offset:27136
s_waitcnt vmcnt(22)
s_barrier
v_mfma_f32_32x32x16_bf16 v[32:47], a[168:171], a[124:127], v[32:47]
v_add_u32 v14, 0, v12
ds_read_b64_tr_b16 a[160:161], v14 offset:0
ds_read_b64_tr_b16 a[162:163], v14 offset:512
v_exp_f32 v147, v147
s_waitcnt lgkmcnt(6)
v_mfma_f32_32x32x16_bf16 v[32:47], a[144:147], a[128:131], v[32:47]
ds_read_b64_tr_b16 a[164:165], v14 offset:18432
ds_read_b64_tr_b16 a[166:167], v14 offset:18944
s_mul_i32 s50, s69, 36
s_add_u32 s50, s50, s67
s_mul_i32 s50, s50, 9216
v_mfma_f32_32x32x16_bf16 v[32:47], a[148:151], a[132:135], v[32:47]
ds_read_b64_tr_b16 a[168:169], v14 offset:1024
ds_read_b64_tr_b16 a[170:171], v14 offset:1536
s_add_u32 s50, s50, 1024
s_and_b32 s49, s71, 1
s_mul_i32 s51, s49, 36864
s_add_u32 s51, s51, s50
s_waitcnt lgkmcnt(6)
v_mfma_f32_32x32x16_bf16 v[32:47], a[152:155], a[136:139], v[32:47]
ds_read_b64_tr_b16 a[144:145], v14 offset:19456
ds_read_b64_tr_b16 a[146:147], v14 offset:19968
s_mul_i32 s49, s49, 294912
s_sub_u32 s50, s50, s49
v_lshrrev_b32 v11, 7, v1
v_mul_u32_u24 v11, 1152, v11
v_mfma_f32_32x32x16_bf16 v[32:47], a[156:159], a[140:143], v[32:47]
ds_read_b64_tr_b16 a[148:149], v14 offset:2048
ds_read_b64_tr_b16 a[150:151], v14 offset:2560
v_bfe_u32 v20, v1, 8, 1
v_lshl_add_u32 v11, v20, 6, v11
v_and_b32 v20, 0x70, v1
v_xor_b32 v11, v11, v20
s_add_u32 s49, s51, 0
s_waitcnt lgkmcnt(6)
v_mfma_f32_32x32x16_bf16 v[48:63], a[160:163], a[0:3], 0
ds_read_b64_tr_b16 a[152:153], v14 offset:20480
ds_read_b64_tr_b16 a[154:155], v14 offset:20992
s_add_u32 m0, s72, 110592
s_nop 0
buffer_load_dwordx4 v11, s[24:27], s49 offen offset:0 lds
v_mfma_f32_32x32x16_bf16 v[48:63], a[164:167], a[4:7], v[48:63]
ds_read_b64_tr_b16 a[156:157], v14 offset:3072
ds_read_b64_tr_b16 a[158:159], v14 offset:3584
v_exp_f32 v179, v179
v_add_f32 v156, v156, v146
v_add_f32 v157, v157, v178
s_waitcnt lgkmcnt(6)
v_mfma_f32_32x32x16_bf16 v[48:63], a[168:171], a[8:11], v[48:63]
ds_read_b64_tr_b16 a[160:161], v14 offset:21504
ds_read_b64_tr_b16 a[162:163], v14 offset:22016
s_add_u32 s49, s51, 35840
v_cvt_pk_bf16_f32 v112, v32, v33
v_cvt_pk_bf16_f32 v113, v34, v35
v_mfma_f32_32x32x16_bf16 v[48:63], a[144:147], a[12:15], v[48:63]
ds_read_b64_tr_b16 a[164:165], v14 offset:4096
ds_read_b64_tr_b16 a[166:167], v14 offset:4608
buffer_load_dwordx4 v11, s[24:27], s49 offen offset:1024 lds
v_cvt_pk_bf16_f32 v114, v36, v37
v_cvt_pk_bf16_f32 v115, v38, v39
v_cvt_pk_bf16_f32 v116, v40, v41
s_waitcnt lgkmcnt(6)
v_mfma_f32_32x32x16_bf16 v[48:63], a[148:151], a[16:19], v[48:63]
ds_read_b64_tr_b16 a[168:169], v14 offset:22528
ds_read_b64_tr_b16 a[170:171], v14 offset:23040
v_cvt_pk_bf16_f32 v117, v42, v43
v_cvt_pk_bf16_f32 v118, v44, v45
v_cvt_pk_bf16_f32 v119, v46, v47
v_mfma_f32_32x32x16_bf16 v[48:63], a[152:155], a[20:23], v[48:63]
ds_read_b64_tr_b16 a[144:145], v14 offset:5120
ds_read_b64_tr_b16 a[146:147], v14 offset:5632
s_add_u32 s49, s51, 71680
v_pk_max_i16 v112, v112, 0
v_pk_max_i16 v113, v113, 0
v_pk_max_i16 v114, v114, 0
s_waitcnt lgkmcnt(6)
v_mfma_f32_32x32x16_bf16 v[48:63], a[156:159], a[24:27], v[48:63]
ds_read_b64_tr_b16 a[148:149], v14 offset:23552
ds_read_b64_tr_b16 a[150:151], v14 offset:24064
buffer_load_dwordx4 v11, s[24:27], s49 offen offset:2048 lds
v_pk_max_i16 v115, v115, 0
v_pk_max_i16 v116, v116, 0
v_mfma_f32_32x32x16_bf16 v[48:63], a[160:163], a[28:31], v[48:63]
ds_read_b64_tr_b16 a[152:153], v14 offset:6144
ds_read_b64_tr_b16 a[154:155], v14 offset:6656
v_pk_max_i16 v117, v117, 0
v_pk_max_i16 v118, v118, 0
v_pk_max_i16 v119, v119, 0
s_add_u32 s73, s73, 2097152
s_waitcnt lgkmcnt(6)
v_mfma_f32_32x32x16_bf16 v[48:63], a[164:167], a[32:35], v[48:63]
ds_read_b64_tr_b16 a[156:157], v14 offset:24576
ds_read_b64_tr_b16 a[158:159], v14 offset:25088
s_add_u32 s49, s51, 107520
buffer_store_dwordx4 v[112:115], v1, s[36:39], s73 offen offset:0 sc1
buffer_store_dwordx4 v[116:119], v1, s[36:39], s73 offen offset:1024 sc1
v_mfma_f32_32x32x16_bf16 v[48:63], a[168:171], a[36:39], v[48:63]
ds_read_b64_tr_b16 a[160:161], v14 offset:7168
ds_read_b64_tr_b16 a[162:163], v14 offset:7680
buffer_load_dwordx4 v11, s[24:27], s49 offen offset:3072 lds
v_fma_f32 v148, v180, v18, v154
v_fma_f32 v180, v180, -v18, v155
s_waitcnt lgkmcnt(6)
v_mfma_f32_32x32x16_bf16 v[48:63], a[144:147], a[40:43], v[48:63]
ds_read_b64_tr_b16 a[164:165], v14 offset:25600
ds_read_b64_tr_b16 a[166:167], v14 offset:26112
buffer_load_dwordx2 v[30:31], v26, s[36:39], s60 offen sc1
v_accvgpr_read_b32 v212, a236
v_accvgpr_read_b32 v213, a237
v_mfma_f32_32x32x16_bf16 v[48:63], a[148:151], a[44:47], v[48:63]
ds_read_b64_tr_b16 a[168:169], v14 offset:8192
ds_read_b64_tr_b16 a[170:171], v14 offset:8704
s_add_u32 s49, s50, 294912
s_add_u32 m0, s72, 114688
v_accvgpr_read_b32 v214, a238
v_accvgpr_read_b32 v215, a239
s_waitcnt lgkmcnt(6)
v_mfma_f32_32x32x16_bf16 v[48:63], a[152:155], a[48:51], v[48:63]
ds_read_b64_tr_b16 a[144:145], v14 offset:26624
ds_read_b64_tr_b16 a[146:147], v14 offset:27136
buffer_load_dwordx4 v11, s[24:27], s49 offen offset:0 lds
v_accvgpr_read_b32 v216, a240
v_accvgpr_read_b32 v217, a241
v_accvgpr_read_b32 v28, a242
v_mfma_f32_32x32x16_bf16 v[48:63], a[156:159], a[52:55], v[48:63]
v_xor_b32 v14, 64, v14
ds_read_b64_tr_b16 a[148:149], v14 offset:0
ds_read_b64_tr_b16 a[150:151], v14 offset:512
v_accvgpr_read_b32 v29, a243
v_accvgpr_read_b32 v254, a248
v_accvgpr_read_b32 v255, a249
s_waitcnt lgkmcnt(6)
v_mfma_f32_32x32x16_bf16 v[48:63], a[160:163], a[56:59], v[48:63]
ds_read_b64_tr_b16 a[152:153], v14 offset:18432
ds_read_b64_tr_b16 a[154:155], v14 offset:18944
v_exp_f32 v148, v148
v_mfma_f32_32x32x16_bf16 v[48:63], a[164:167], a[60:63], v[48:63]
ds_read_b64_tr_b16 a[156:157], v14 offset:1024
ds_read_b64_tr_b16 a[158:159], v14 offset:1536
s_add_u32 s49, s51, 146432
v_exp_f32 v180, v180
v_add_f32 v156, v156, v147
s_waitcnt lgkmcnt(6)
v_mfma_f32_32x32x16_bf16 v[48:63], a[168:171], a[64:67], v[48:63]
ds_read_b64_tr_b16 a[160:161], v14 offset:19456
ds_read_b64_tr_b16 a[162:163], v14 offset:19968
buffer_load_dwordx4 v11, s[24:27], s49 offen offset:1024 lds
v_add_f32 v157, v157, v179
v_fma_f32 v149, v181, v18, v154
v_mfma_f32_32x32x16_bf16 v[48:63], a[144:147], a[68:71], v[48:63]
ds_read_b64_tr_b16 a[164:165], v14 offset:2048
ds_read_b64_tr_b16 a[166:167], v14 offset:2560
v_fma_f32 v181, v181, -v18, v155
v_exp_f32 v149, v149
s_waitcnt lgkmcnt(6)
v_mfma_f32_32x32x16_bf16 v[32:47], a[148:151], a[0:3], 0
ds_read_b64_tr_b16 a[168:169], v14 offset:20480
ds_read_b64_tr_b16 a[170:171], v14 offset:20992
s_add_u32 s49, s51, 182272
v_exp_f32 v181, v181
v_mfma_f32_32x32x16_bf16 v[32:47], a[152:155], a[4:7], v[32:47]
ds_read_b64_tr_b16 a[144:145], v14 offset:3072
ds_read_b64_tr_b16 a[146:147], v14 offset:3584
buffer_load_dwordx4 v11, s[24:27], s49 offen offset:2048 lds
v_add_f32 v156, v156, v148
v_add_f32 v157, v157, v180
v_fma_f32 v150, v182, v18, v154
s_waitcnt lgkmcnt(6)
v_mfma_f32_32x32x16_bf16 v[32:47], a[156:159], a[8:11], v[32:47]
ds_read_b64_tr_b16 a[148:149], v14 offset:21504
ds_read_b64_tr_b16 a[150:151], v14 offset:22016
v_fma_f32 v182, v182, -v18, v155
v_exp_f32 v150, v150
v_mfma_f32_32x32x16_bf16 v[32:47], a[160:163], a[12:15], v[32:47]
ds_read_b64_tr_b16 a[152:153], v14 offset:4096
ds_read_b64_tr_b16 a[154:155], v14 offset:4608
s_add_u32 s49, s51, 218112
v_exp_f32 v182, v182
v_add_f32 v156, v156, v149
s_waitcnt lgkmcnt(6)
v_mfma_f32_32x32x16_bf16 v[32:47], a[164:167], a[16:19], v[32:47]
ds_read_b64_tr_b16 a[156:157], v14 offset:22528
ds_read_b64_tr_b16 a[158:159], v14 offset:23040
buffer_load_dwordx4 v11, s[24:27], s49 offen offset:3072 lds
v_add_f32 v157, v157, v181
v_fma_f32 v151, v183, v18, v154
v_mfma_f32_32x32x16_bf16 v[32:47], a[168:171], a[20:23], v[32:47]
ds_read_b64_tr_b16 a[160:161], v14 offset:5120
ds_read_b64_tr_b16 a[162:163], v14 offset:5632
v_fma_f32 v183, v183, -v18, v155
v_exp_f32 v151, v151
s_waitcnt lgkmcnt(6)
v_mfma_f32_32x32x16_bf16 v[32:47], a[144:147], a[24:27], v[32:47]
ds_read_b64_tr_b16 a[164:165], v14 offset:23552
ds_read_b64_tr_b16 a[166:167], v14 offset:24064
s_add_u32 s49, s51, 258048
s_add_u32 m0, s72, 118784
v_mfma_f32_32x32x16_bf16 v[32:47], a[148:151], a[28:31], v[32:47]
ds_read_b64_tr_b16 a[168:169], v14 offset:6144
ds_read_b64_tr_b16 a[170:171], v14 offset:6656
buffer_load_dwordx4 v11, s[24:27], s49 offen offset:0 lds
v_exp_f32 v183, v183
v_add_f32 v156, v156, v150
s_waitcnt lgkmcnt(6)
v_mfma_f32_32x32x16_bf16 v[32:47], a[152:155], a[32:35], v[32:47]
ds_read_b64_tr_b16 a[144:145], v14 offset:24576
ds_read_b64_tr_b16 a[146:147], v14 offset:25088
v_add_f32 v157, v157, v182
v_fma_f32 v152, v184, v18, v154
v_fma_f32 v184, v184, -v18, v155
v_mfma_f32_32x32x16_bf16 v[32:47], a[156:159], a[36:39], v[32:47]
ds_read_b64_tr_b16 a[148:149], v14 offset:7168
ds_read_b64_tr_b16 a[150:151], v14 offset:7680
v_exp_f32 v152, v152
v_exp_f32 v184, v184
s_waitcnt lgkmcnt(6)
v_mfma_f32_32x32x16_bf16 v[32:47], a[160:163], a[40:43], v[32:47]
ds_read_b64_tr_b16 a[152:153], v14 offset:25600
ds_read_b64_tr_b16 a[154:155], v14 offset:26112
v_add_f32 v156, v156, v151
v_add_f32 v157, v157, v183
v_fma_f32 v153, v185, v18, v154
v_mfma_f32_32x32x16_bf16 v[32:47], a[164:167], a[44:47], v[32:47]
ds_read_b64_tr_b16 a[156:157], v14 offset:8192
ds_read_b64_tr_b16 a[158:159], v14 offset:8704
v_fma_f32 v185, v185, -v18, v155
v_exp_f32 v153, v153
s_waitcnt lgkmcnt(6)
v_mfma_f32_32x32x16_bf16 v[32:47], a[168:171], a[48:51], v[32:47]
ds_read_b64_tr_b16 a[160:161], v14 offset:26624
ds_read_b64_tr_b16 a[162:163], v14 offset:27136
s_waitcnt vmcnt(23)
s_barrier
v_mfma_f32_32x32x16_bf16 v[32:47], a[144:147], a[52:55], v[32:47]
v_add_u32 v14, 36864, v12
ds_read_b64_tr_b16 a[164:165], v14 offset:0
ds_read_b64_tr_b16 a[166:167], v14 offset:512
v_exp_f32 v185, v185
v_add_f32 v156, v156, v152
s_waitcnt lgkmcnt(6)
v_mfma_f32_32x32x16_bf16 v[32:47], a[148:151], a[56:59], v[32:47]
ds_read_b64_tr_b16 a[168:169], v14 offset:18432
ds_read_b64_tr_b16 a[170:171], v14 offset:18944
s_add_u32 s49, s71, 0
s_and_b32 s49, s49, 3
s_and_b32 s52, s49, 1
v_mfma_f32_32x32x16_bf16 v[32:47], a[152:155], a[60:63], v[32:47]
ds_read_b64_tr_b16 a[144:145], v14 offset:1024
ds_read_b64_tr_b16 a[146:147], v14 offset:1536
s_lshl2_add_u32 s49, s70, s49
s_mul_i32 s49, s49, 72
s_add_u32 s49, s49, s67
s_mul_i32 s49, s49, 4608
s_waitcnt lgkmcnt(6)
v_mfma_f32_32x32x16_bf16 v[32:47], a[156:159], a[64:67], v[32:47]
ds_read_b64_tr_b16 a[148:149], v14 offset:19456
ds_read_b64_tr_b16 a[150:151], v14 offset:19968
s_lshl_b32 s50, s71, 8
s_add_u32 s49, s49, s50
s_mul_i32 s50, s52, 36864
s_add_u32 s50, s50, s49
v_mfma_f32_32x32x16_bf16 v[32:47], a[160:163], a[68:71], v[32:47]
ds_read_b64_tr_b16 a[152:153], v14 offset:2048
ds_read_b64_tr_b16 a[154:155], v14 offset:2560
s_mul_i32 s51, s52, 4294672384
s_add_u32 s51, s51, s49
s_add_u32 s51, s51, 147456
s_add_u32 m0, s72, 0
s_waitcnt lgkmcnt(6)
v_mfma_f32_32x32x16_bf16 v[48:63], a[164:167], a[72:75], v[48:63]
ds_read_b64_tr_b16 a[156:157], v14 offset:20480
ds_read_b64_tr_b16 a[158:159], v14 offset:20992
buffer_load_dwordx4 v2, s[24:27], s50 offen offset:0 lds
s_waitcnt vmcnt(6)
v_cmp_ne_u64 vcc, s[94:95], v[30:31]
s_nop 0
s_cbranch_vccnz SLOW_kvf
BACK_kvf:
v_mfma_f32_32x32x16_bf16 v[48:63], a[168:171], a[76:79], v[48:63]
ds_read_b64_tr_b16 a[160:161], v14 offset:3072
ds_read_b64_tr_b16 a[162:163], v14 offset:3584
s_add_u32 s62, s68, 0
s_and_b32 s62, s62, 3
s_mul_i32 s62, s62, 12288
s_add_u32 s62, s62, s57
buffer_load_dwordx4 a[208:211], v28, s[36:39], s62 offen offset:0 sc1
s_waitcnt lgkmcnt(6)
v_mfma_f32_32x32x16_bf16 v[48:63], a[144:147], a[80:83], v[48:63]
ds_read_b64_tr_b16 a[164:165], v14 offset:21504
ds_read_b64_tr_b16 a[166:167], v14 offset:22016
buffer_load_dwordx4 a[212:215], v28, s[36:39], s62 offen offset:256 sc1
v_add_f32 v157, v157, v184
v_add_f32 v156, v156, v153
v_mfma_f32_32x32x16_bf16 v[48:63], a[148:151], a[84:87], v[48:63]
ds_read_b64_tr_b16 a[168:169], v14 offset:4096
ds_read_b64_tr_b16 a[170:171], v14 offset:4608
buffer_load_dwordx4 v3, s[24:27], s50 offen offset:1024 lds
buffer_load_dwordx4 a[216:219], v29, s[36:39], s62 offen offset:512 sc1
s_add_u32 s62, s68, 1
s_and_b32 s62, s62, 3
s_waitcnt lgkmcnt(6)
v_mfma_f32_32x32x16_bf16 v[48:63], a[152:155], a[88:91], v[48:63]
ds_read_b64_tr_b16 a[144:145], v14 offset:22528
ds_read_b64_tr_b16 a[146:147], v14 offset:23040
s_mul_i32 s62, s62, 12288
s_add_u32 s62, s62, s57
v_add_f32 v157, v157, v185
v_mfma_f32_32x32x16_bf16 v[48:63], a[156:159], a[92:95], v[48:63]
ds_read_b64_tr_b16 a[148:149], v14 offset:5120
ds_read_b64_tr_b16 a[150:151], v14 offset:5632
buffer_load_dwordx4 a[220:223], v28, s[36:39], s62 offen offset:0 sc1
v_rcp_f32 v157, v157
v_mul_f32 v252, 0x358637bd, v156
s_waitcnt lgkmcnt(6)
v_mfma_f32_32x32x16_bf16 v[48:63], a[160:163], a[96:99], v[48:63]
ds_read_b64_tr_b16 a[152:153], v14 offset:23552
ds_read_b64_tr_b16 a[154:155], v14 offset:24064
buffer_load_dwordx4 v4, s[24:27], s50 offen offset:2048 lds
v_cvt_pk_bf16_f32 v232, v136, v137
v_cvt_pk_bf16_f32 v233, v138, v139
v_mfma_f32_32x32x16_bf16 v[48:63], a[164:167], a[100:103], v[48:63]
ds_read_b64_tr_b16 a[156:157], v14 offset:6144
ds_read_b64_tr_b16 a[158:159], v14 offset:6656
v_cvt_pk_bf16_f32 v234, v140, v141
v_cvt_pk_bf16_f32 v235, v142, v143
v_cvt_pk_bf16_f32 v236, v144, v145
v_cvt_pk_bf16_f32 v237, v146, v147
s_waitcnt lgkmcnt(6)
v_mfma_f32_32x32x16_bf16 v[48:63], a[168:171], a[104:107], v[48:63]
ds_read_b64_tr_b16 a[160:161], v14 offset:24576
ds_read_b64_tr_b16 a[162:163], v14 offset:25088
buffer_load_dwordx4 a[224:227], v28, s[36:39], s62 offen offset:256 sc1
v_cvt_pk_bf16_f32 v238, v148, v149
v_cvt_pk_bf16_f32 v239, v150, v151
v_mfma_f32_32x32x16_bf16 v[48:63], a[144:147], a[108:111], v[48:63]
ds_read_b64_tr_b16 a[164:165], v14 offset:7168
ds_read_b64_tr_b16 a[166:167], v14 offset:7680
buffer_load_dwordx4 v5, s[24:27], s50 offen offset:3072 lds
v_cvt_pk_bf16_f32 v240, v152, v153
v_mul_f32 v157, v156, v157
v_mul_f32 v168, v157, v168
s_waitcnt lgkmcnt(6)
v_mfma_f32_32x32x16_bf16 v[48:63], a[148:151], a[112:115], v[48:63]
ds_read_b64_tr_b16 a[168:169], v14 offset:25600
ds_read_b64_tr_b16 a[170:171], v14 offset:26112
buffer_load_dwordx4 a[228:231], v29, s[36:39], s62 offen offset:512 sc1
v_mul_f32 v169, v157, v169
v_cvt_pk_bf16_f32 v241, v168, v169
v_mfma_f32_32x32x16_bf16 v[48:63], a[152:155], a[116:119], v[48:63]
ds_read_b64_tr_b16 a[144:145], v14 offset:8192
ds_read_b64_tr_b16 a[146:147], v14 offset:8704
s_add_u32 m0, s72, 4096
s_add_u32 s62, s68, 2
s_and_b32 s62, s62, 3
s_mul_i32 s62, s62, 12288
s_waitcnt lgkmcnt(6)
v_mfma_f32_32x32x16_bf16 v[48:63], a[156:159], a[120:123], v[48:63]
ds_read_b64_tr_b16 a[148:149], v14 offset:26624
ds_read_b64_tr_b16 a[150:151], v14 offset:27136
buffer_load_dwordx4 v6, s[24:27], s50 offen offset:0 lds
s_add_u32 s62, s62, s57
v_mul_f32 v170, v157, v170
v_mfma_f32_32x32x16_bf16 v[48:63], a[160:163], a[124:127], v[48:63]
v_xor_b32 v14, 64, v14
ds_read_b64_tr_b16 a[152:153], v14 offset:0
ds_read_b64_tr_b16 a[154:155], v14 offset:512
buffer_load_dwordx4 a[232:235], v28, s[36:39], s62 offen offset:0 sc1
v_mul_f32 v171, v157, v171
v_cvt_pk_bf16_f32 v242, v170, v171
s_waitcnt lgkmcnt(6)
v_mfma_f32_32x32x16_bf16 v[48:63], a[164:167], a[128:131], v[48:63]
ds_read_b64_tr_b16 a[156:157], v14 offset:18432
ds_read_b64_tr_b16 a[158:159], v14 offset:18944
v_and_b32 v24, 0x18, v24
s_and_b32 s66, s74, 0xffffff80
buffer_load_dwordx2 v[22:23], v24, s[36:39], s66 offen sc1
v_mfma_f32_32x32x16_bf16 v[48:63], a[168:171], a[132:135], v[48:63]
ds_read_b64_tr_b16 a[160:161], v14 offset:1024
ds_read_b64_tr_b16 a[162:163], v14 offset:1536
s_lshl4_add_u32 s81, s70, s68
s_lshl4_add_u32 s81, s81, s67
s_mul_i32 s81, s81, 2048
s_add_u32 s81, s81, 25165824
s_waitcnt lgkmcnt(6)
v_mfma_f32_32x32x16_bf16 v[48:63], a[144:147], a[136:139], v[48:63]
ds_read_b64_tr_b16 a[164:165], v14 offset:19456
ds_read_b64_tr_b16 a[166:167], v14 offset:19968
buffer_load_dwordx4 v7, s[24:27], s50 offen offset:1024 lds
buffer_load_dwordx4 a[236:239], v28, s[36:39], s62 offen offset:256 sc1
v_mul_f32 v172, v157, v172
v_mfma_f32_32x32x16_bf16 v[48:63], a[148:151], a[140:143], v[48:63]
ds_read_b64_tr_b16 a[168:169], v14 offset:2048
ds_read_b64_tr_b16 a[170:171], v14 offset:2560
v_mul_f32 v173, v157, v173
v_cvt_pk_bf16_f32 v243, v172, v173
v_mul_f32 v174, v157, v174
v_mul_f32 v175, v157, v175
s_waitcnt lgkmcnt(6)
v_mfma_f32_32x32x16_bf16 v[32:47], a[152:155], a[72:75], v[32:47]
ds_read_b64_tr_b16 a[144:145], v14 offset:20480
ds_read_b64_tr_b16 a[146:147], v14 offset:20992
buffer_load_dwordx4 a[240:243], v29, s[36:39], s62 offen offset:512 sc1
s_add_u32 s62, s68, 3
s_and_b32 s62, s62, 3
v_mfma_f32_32x32x16_bf16 v[32:47], a[156:159], a[76:79], v[32:47]
ds_read_b64_tr_b16 a[148:149], v14 offset:3072
ds_read_b64_tr_b16 a[150:151], v14 offset:3584
buffer_load_dwordx4 v8, s[24:27], s50 offen offset:2048 lds
s_mul_i32 s62, s62, 12288
s_add_u32 s62, s62, s57
v_cvt_pk_bf16_f32 v244, v174, v175
s_waitcnt lgkmcnt(6)
v_mfma_f32_32x32x16_bf16 v[32:47], a[160:163], a[80:83], v[32:47]
ds_read_b64_tr_b16 a[152:153], v14 offset:21504
ds_read_b64_tr_b16 a[154:155], v14 offset:22016
v_cvt_pk_bf16_f32 v120, v48, v49
v_cvt_pk_bf16_f32 v121, v50, v51
v_cvt_pk_bf16_f32 v122, v52, v53
v_mfma_f32_32x32x16_bf16 v[32:47], a[164:167], a[84:87], v[32:47]
ds_read_b64_tr_b16 a[156:157], v14 offset:4096
ds_read_b64_tr_b16 a[158:159], v14 offset:4608
v_cvt_pk_bf16_f32 v123, v54, v55
v_cvt_pk_bf16_f32 v124, v56, v57
v_cvt_pk_bf16_f32 v125, v58, v59
v_cvt_pk_bf16_f32 v126, v60, v61
s_waitcnt lgkmcnt(6)
v_mfma_f32_32x32x16_bf16 v[32:47], a[168:171], a[88:91], v[32:47]
ds_read_b64_tr_b16 a[160:161], v14 offset:22528
ds_read_b64_tr_b16 a[162:163], v14 offset:23040
buffer_load_dwordx4 v9, s[24:27], s50 offen offset:3072 lds
v_cvt_pk_bf16_f32 v127, v62, v63
v_pk_max_i16 v120, v120, 0
buffer_load_dwordx4 a[244:247], v28, s[36:39], s62 offen offset:0 sc1
v_mfma_f32_32x32x16_bf16 v[32:47], a[144:147], a[92:95], v[32:47]
ds_read_b64_tr_b16 a[164:165], v14 offset:5120
ds_read_b64_tr_b16 a[166:167], v14 offset:5632
v_pk_max_i16 v121, v121, 0
v_pk_max_i16 v122, v122, 0
v_pk_max_i16 v123, v123, 0
v_pk_max_i16 v124, v124, 0
s_waitcnt lgkmcnt(6)
v_mfma_f32_32x32x16_bf16 v[32:47], a[148:151], a[96:99], v[32:47]
ds_read_b64_tr_b16 a[168:169], v14 offset:23552
ds_read_b64_tr_b16 a[170:171], v14 offset:24064
s_add_u32 m0, s72, 8192
v_pk_max_i16 v125, v125, 0
v_pk_max_i16 v126, v126, 0
v_mfma_f32_32x32x16_bf16 v[32:47], a[152:155], a[100:103], v[32:47]
ds_read_b64_tr_b16 a[144:145], v14 offset:6144
ds_read_b64_tr_b16 a[146:147], v14 offset:6656
buffer_load_dwordx4 v10, s[24:27], s51 offen offset:0 lds
v_pk_max_i16 v127, v127, 0
s_add_u32 s73, s73, 2097152
buffer_store_dwordx4 v[120:123], v1, s[36:39], s73 offen offset:0 sc1
buffer_load_dwordx4 a[248:251], v28, s[36:39], s62 offen offset:256 sc1
s_waitcnt lgkmcnt(6)
v_mfma_f32_32x32x16_bf16 v[32:47], a[156:159], a[104:107], v[32:47]
ds_read_b64_tr_b16 a[148:149], v14 offset:24576
ds_read_b64_tr_b16 a[150:151], v14 offset:25088
buffer_store_dwordx4 v[124:127], v1, s[36:39], s73 offen offset:1024 sc1
buffer_load_dwordx4 a[252:255], v29, s[36:39], s62 offen offset:512 sc1
v_mul_f32 v176, v157, v176
v_mfma_f32_32x32x16_bf16 v[32:47], a[160:163], a[108:111], v[32:47]
ds_read_b64_tr_b16 a[152:153], v14 offset:7168
ds_read_b64_tr_b16 a[154:155], v14 offset:7680
v_mul_f32 v177, v157, v177
v_cvt_pk_bf16_f32 v245, v176, v177
v_mul_f32 v178, v157, v178
v_mul_f32 v179, v157, v179
s_waitcnt lgkmcnt(6)
v_mfma_f32_32x32x16_bf16 v[32:47], a[164:167], a[112:115], v[32:47]
ds_read_b64_tr_b16 a[156:157], v14 offset:25600
ds_read_b64_tr_b16 a[158:159], v14 offset:26112
v_cvt_pk_bf16_f32 v246, v178, v179
v_mul_f32 v180, v157, v180
v_mul_f32 v181, v157, v181
v_mfma_f32_32x32x16_bf16 v[32:47], a[168:171], a[116:119], v[32:47]
ds_read_b64_tr_b16 a[160:161], v14 offset:8192
ds_read_b64_tr_b16 a[162:163], v14 offset:8704
v_cvt_pk_bf16_f32 v247, v180, v181
v_mul_f32 v182, v157, v182
v_mul_f32 v183, v157, v183
v_cvt_pk_bf16_f32 v248, v182, v183
s_waitcnt lgkmcnt(6)
v_mfma_f32_32x32x16_bf16 v[32:47], a[144:147], a[120:123], v[32:47]
ds_read_b64_tr_b16 a[164:165], v14 offset:26624
ds_read_b64_tr_b16 a[166:167], v14 offset:27136
s_waitcnt vmcnt(24)
s_barrier
v_mul_f32 v184, v157, v184
v_mfma_f32_32x32x16_bf16 v[32:47], a[148:151], a[124:127], v[32:47]
v_add_u32 v14, 110592, v13
ds_read_b64_tr_b16 a[168:169], v14 offset:0
ds_read_b64_tr_b16 a[170:171], v14 offset:9216
v_mul_f32 v185, v157, v185
v_cvt_pk_bf16_f32 v249, v184, v185
v_mov_b32 v250, 0
s_waitcnt lgkmcnt(6)
v_mfma_f32_32x32x16_bf16 v[32:47], a[152:155], a[128:131], v[32:47]
ds_read_b64_tr_b16 a[144:145], v14 offset:18432
ds_read_b64_tr_b16 a[146:147], v14 offset:27648
s_add_u32 s49, s71, 0
s_and_b32 s49, s49, 3
s_and_b32 s52, s49, 1
v_mfma_f32_32x32x16_bf16 v[32:47], a[156:159], a[132:135], v[32:47]
ds_read_b64_tr_b16 a[148:149], v14 offset:1024
ds_read_b64_tr_b16 a[150:151], v14 offset:10240
s_lshl2_add_u32 s49, s70, s49
s_mul_i32 s49, s49, 72
s_add_u32 s49, s49, s67
s_mul_i32 s49, s49, 4608
s_waitcnt lgkmcnt(6)
v_mfma_f32_32x32x16_bf16 v[32:47], a[160:163], a[136:139], v[32:47]
ds_read_b64_tr_b16 a[152:153], v14 offset:19456
ds_read_b64_tr_b16 a[154:155], v14 offset:28672
s_lshl_b32 s50, s71, 8
s_add_u32 s49, s49, s50
s_mul_i32 s50, s52, 4294672384
s_add_u32 s50, s50, s49
v_mfma_f32_32x32x16_bf16 v[32:47], a[164:167], a[140:143], v[32:47]
ds_read_b64_tr_b16 a[156:157], v14 offset:2048
ds_read_b64_tr_b16 a[158:159], v14 offset:11264
s_add_u32 s50, s50, 313344
s_mul_i32 s51, s52, 36864
s_add_u32 s51, s51, s49
s_add_u32 s51, s51, 129024
s_add_u32 m0, s72, 36864
s_waitcnt lgkmcnt(6)
v_mfma_f32_32x32x16_bf16 v[48:63], a[168:171], v[64:67], 0
ds_read_b64_tr_b16 a[160:161], v14 offset:20480
ds_read_b64_tr_b16 a[162:163], v14 offset:29696
buffer_load_dwordx4 v2, s[24:27], s50 offen offset:0 lds
v_mov_b32 v251, 0
v_mfma_f32_32x32x16_bf16 v[48:63], a[144:147], v[68:71], v[48:63]
ds_read_b64_tr_b16 a[164:165], v14 offset:3072
ds_read_b64_tr_b16 a[166:167], v14 offset:12288
s_waitcnt vmcnt(12)
v_cmp_ne_u64 vcc, s[94:95], v[22:23]
s_nop 0
s_cbranch_vccnz SLOW_hA
BACK_hA:
s_add_u32 s80, s71, 1
s_and_b32 s80, s80, 3
s_waitcnt lgkmcnt(6)
v_mfma_f32_32x32x16_bf16 v[48:63], a[148:151], v[72:75], v[48:63]
ds_read_b64_tr_b16 a[168:169], v14 offset:21504
ds_read_b64_tr_b16 a[170:171], v14 offset:30720
v_cvt_pk_bf16_f32 v128, v32, v33
v_cvt_pk_bf16_f32 v129, v34, v35
v_cvt_pk_bf16_f32 v130, v36, v37
s_mul_i32 s80, s80, 8192
v_mfma_f32_32x32x16_bf16 v[48:63], a[152:155], v[76:79], v[48:63]
ds_read_b64_tr_b16 a[144:145], v14 offset:4096
ds_read_b64_tr_b16 a[146:147], v14 offset:13312
buffer_load_dwordx4 v3, s[24:27], s51 offen offset:1024 lds
v_cvt_pk_bf16_f32 v131, v38, v39
v_cvt_pk_bf16_f32 v132, v40, v41
v_cvt_pk_bf16_f32 v133, v42, v43
s_add_u32 s80, s80, s81
s_waitcnt lgkmcnt(6)
v_mfma_f32_32x32x16_bf16 v[48:63], a[156:159], v[80:83], v[48:63]
ds_read_b64_tr_b16 a[148:149], v14 offset:22528
ds_read_b64_tr_b16 a[150:151], v14 offset:31744
v_cvt_pk_bf16_f32 v134, v44, v45
v_cvt_pk_bf16_f32 v135, v46, v47
v_pk_max_i16 v128, v128, 0
buffer_load_dwordx4 a[0:3], v1, s[36:39], s80 offen offset:0 sc1
v_mfma_f32_32x32x16_bf16 v[48:63], a[160:163], v[84:87], v[48:63]
ds_read_b64_tr_b16 a[152:153], v14 offset:5120
ds_read_b64_tr_b16 a[154:155], v14 offset:14336
v_pk_max_i16 v129, v129, 0
v_pk_max_i16 v130, v130, 0
v_pk_max_i16 v131, v131, 0
v_pk_max_i16 v132, v132, 0
s_waitcnt lgkmcnt(6)
v_mfma_f32_32x32x16_bf16 v[48:63], a[164:167], v[88:91], v[48:63]
ds_read_b64_tr_b16 a[156:157], v14 offset:23552
ds_read_b64_tr_b16 a[158:159], v14 offset:32768
buffer_load_dwordx4 v4, s[24:27], s51 offen offset:2048 lds
v_pk_max_i16 v133, v133, 0
v_pk_max_i16 v134, v134, 0
v_mfma_f32_32x32x16_bf16 v[48:63], a[168:171], v[92:95], v[48:63]
ds_read_b64_tr_b16 a[160:161], v14 offset:6144
ds_read_b64_tr_b16 a[162:163], v14 offset:15360
v_pk_max_i16 v135, v135, 0
s_add_u32 s73, s73, 2097152
buffer_store_dwordx4 v[128:131], v1, s[36:39], s73 offen offset:0 sc1
buffer_store_dwordx4 v[132:135], v1, s[36:39], s73 offen offset:1024 sc1
buffer_load_dwordx4 a[4:7], v1, s[36:39], s80 offen offset:1024 sc1
s_waitcnt lgkmcnt(6)
v_mfma_f32_32x32x16_bf16 v[48:63], a[144:147], v[96:99], v[48:63]
ds_read_b64_tr_b16 a[164:165], v14 offset:24576
ds_read_b64_tr_b16 a[166:167], v14 offset:33792
v_lshrrev_b32 v20, 9, v1
v_lshlrev_b32 v20, 11, v20
v_and_b32 v11, 0x1f0, v1
v_mfma_f32_32x32x16_bf16 v[48:63], a[148:151], v[100:103], v[48:63]
ds_read_b64_tr_b16 a[168:169], v14 offset:7168
ds_read_b64_tr_b16 a[170:171], v14 offset:16384
buffer_load_dwordx4 v5, s[24:27], s51 offen offset:3072 lds
v_add_u32 v20, v20, v11
s_lshl4_add_u32 s82, s70, s68
s_lshl2_add_u32 s82, s82, s67
s_waitcnt lgkmcnt(6)
v_mfma_f32_32x32x16_bf16 v[48:63], a[152:155], v[104:107], v[48:63]
ds_read_b64_tr_b16 a[144:145], v14 offset:25600
ds_read_b64_tr_b16 a[146:147], v14 offset:34816
s_lshl3_add_u32 s82, s82, s71
s_lshl_b32 s82, s82, 9
s_add_u32 s82, s82, 8388608
s_add_u32 s80, s80, 2097152
v_mfma_f32_32x32x16_bf16 v[48:63], a[156:159], v[108:111], v[48:63]
ds_read_b64_tr_b16 a[148:149], v14 offset:8192
ds_read_b64_tr_b16 a[150:151], v14 offset:17408
s_add_u32 m0, s72, 40960
buffer_load_dwordx4 a[8:11], v1, s[36:39], s80 offen offset:0 sc1
s_waitcnt lgkmcnt(6)
v_mfma_f32_32x32x16_bf16 v[48:63], a[160:163], v[112:115], v[48:63]
ds_read_b64_tr_b16 a[152:153], v14 offset:26624
ds_read_b64_tr_b16 a[154:155], v14 offset:35840
buffer_load_dwordx4 v6, s[24:27], s51 offen offset:0 lds
v_mfma_f32_32x32x16_bf16 v[48:63], a[164:167], v[116:119], v[48:63]
v_xor_b32 v14, 64, v14
ds_read_b64_tr_b16 a[156:157], v14 offset:0
ds_read_b64_tr_b16 a[158:159], v14 offset:9216
buffer_load_dwordx4 a[12:15], v1, s[36:39], s80 offen offset:1024 sc1
s_waitcnt lgkmcnt(6)
v_mfma_f32_32x32x16_bf16 v[48:63], a[168:171], v[120:123], v[48:63]
ds_read_b64_tr_b16 a[160:161], v14 offset:18432
ds_read_b64_tr_b16 a[162:163], v14 offset:27648
v_mfma_f32_32x32x16_bf16 v[48:63], a[144:147], v[124:127], v[48:63]
ds_read_b64_tr_b16 a[164:165], v14 offset:1024
ds_read_b64_tr_b16 a[166:167], v14 offset:10240
s_waitcnt lgkmcnt(6)
v_mfma_f32_32x32x16_bf16 v[48:63], a[148:151], v[128:131], v[48:63]
ds_read_b64_tr_b16 a[168:169], v14 offset:19456
ds_read_b64_tr_b16 a[170:171], v14 offset:28672
buffer_load_dwordx4 v7, s[24:27], s51 offen offset:1024 lds
s_add_u32 s80, s80, 2097152
v_mfma_f32_32x32x16_bf16 v[48:63], a[152:155], v[132:135], v[48:63]
ds_read_b64_tr_b16 a[144:145], v14 offset:2048
ds_read_b64_tr_b16 a[146:147], v14 offset:11264
buffer_load_dwordx4 a[16:19], v1, s[36:39], s80 offen offset:0 sc1
s_waitcnt lgkmcnt(6)
v_mfma_f32_32x32x16_bf16 v[32:47], a[156:159], v[64:67], 0
ds_read_b64_tr_b16 a[148:149], v14 offset:20480
ds_read_b64_tr_b16 a[150:151], v14 offset:29696
v_mfma_f32_32x32x16_bf16 v[32:47], a[160:163], v[68:71], v[32:47]
ds_read_b64_tr_b16 a[152:153], v14 offset:3072
ds_read_b64_tr_b16 a[154:155], v14 offset:12288
buffer_load_dwordx4 v8, s[24:27], s51 offen offset:2048 lds
s_waitcnt lgkmcnt(6)
v_mfma_f32_32x32x16_bf16 v[32:47], a[164:167], v[72:75], v[32:47]
ds_read_b64_tr_b16 a[156:157], v14 offset:21504
ds_read_b64_tr_b16 a[158:159], v14 offset:30720
v_cvt_pk_bf16_f32 v48, v48, v49
v_cvt_pk_bf16_f32 v49, v50, v51
v_cvt_pk_bf16_f32 v50, v52, v53
v_mfma_f32_16x16x32_bf16 v[200:203], a[176:179], a[208:211], 0
v_cvt_pk_bf16_f32 v51, v54, v55
v_mfma_f32_16x16x32_bf16 v[204:207], a[176:179], a[212:215], 0
v_cvt_pk_bf16_f32 v52, v56, v57
v_cvt_pk_bf16_f32 v53, v58, v59
v_mfma_f32_32x32x16_bf16 v[32:47], a[168:171], v[76:79], v[32:47]
ds_read_b64_tr_b16 a[160:161], v14 offset:4096
ds_read_b64_tr_b16 a[162:163], v14 offset:13312
v_cvt_pk_bf16_f32 v54, v60, v61
v_cvt_pk_bf16_f32 v55, v62, v63
v_permlane32_swap_b32 v48, v50
v_mfma_f32_16x16x32_bf16 v[208:211], a[176:179], a[216:219], 0
v_permlane32_swap_b32 v49, v51
v_mfma_f32_16x16x32_bf16 v[200:203], a[176:179], a[220:223], v[200:203]
buffer_load_dwordx4 a[20:23], v1, s[36:39], s80 offen offset:1024 sc1
s_waitcnt lgkmcnt(6)
v_mfma_f32_32x32x16_bf16 v[32:47], a[144:147], v[80:83], v[32:47]
ds_read_b64_tr_b16 a[164:165], v14 offset:22528
ds_read_b64_tr_b16 a[166:167], v14 offset:31744
buffer_load_dwordx4 v9, s[24:27], s51 offen offset:3072 lds
v_permlane32_swap_b32 v52, v54
v_mfma_f32_16x16x32_bf16 v[204:207], a[176:179], a[224:227], v[204:207]
v_permlane32_swap_b32 v53, v55
v_mfma_f32_16x16x32_bf16 v[208:211], a[176:179], a[228:231], v[208:211]
buffer_store_dwordx4 v[48:51], v20, s[36:39], s82 offen sc1
s_add_u32 s82, s82, 1048576
v_mfma_f32_32x32x16_bf16 v[32:47], a[148:151], v[84:87], v[32:47]
ds_read_b64_tr_b16 a[168:169], v14 offset:5120
ds_read_b64_tr_b16 a[170:171], v14 offset:14336
buffer_store_dwordx4 v[52:55], v20, s[36:39], s82 offen sc1
s_add_u32 s80, s80, 2097152
s_waitcnt vmcnt(26)
v_mfma_f32_16x16x32_bf16 v[200:203], a[176:179], a[232:235], v[200:203]
v_mfma_f32_16x16x32_bf16 v[204:207], a[176:179], a[236:239], v[204:207]
s_waitcnt lgkmcnt(6)
v_mfma_f32_32x32x16_bf16 v[32:47], a[152:155], v[88:91], v[32:47]
ds_read_b64_tr_b16 a[144:145], v14 offset:23552
ds_read_b64_tr_b16 a[146:147], v14 offset:32768
s_add_u32 m0, s72, 45056
buffer_load_dwordx4 a[24:27], v1, s[36:39], s80 offen offset:0 sc1
v_mfma_f32_16x16x32_bf16 v[208:211], a[176:179], a[240:243], v[208:211]
s_waitcnt vmcnt(19)
v_mfma_f32_16x16x32_bf16 v[200:203], a[176:179], a[244:247], v[200:203]
v_mfma_f32_32x32x16_bf16 v[32:47], a[156:159], v[92:95], v[32:47]
ds_read_b64_tr_b16 a[148:149], v14 offset:6144
ds_read_b64_tr_b16 a[150:151], v14 offset:15360
buffer_load_dwordx4 v10, s[24:27], s51 offen offset:0 lds
v_mfma_f32_16x16x32_bf16 v[204:207], a[176:179], a[248:251], v[204:207]
v_mfma_f32_16x16x32_bf16 v[208:211], a[176:179], a[252:255], v[208:211]
s_waitcnt lgkmcnt(6)
v_mfma_f32_32x32x16_bf16 v[32:47], a[160:163], v[96:99], v[32:47]
ds_read_b64_tr_b16 a[152:153], v14 offset:24576
ds_read_b64_tr_b16 a[154:155], v14 offset:33792
v_cvt_pk_bf16_f32 v200, v200, v201
v_cvt_pk_bf16_f32 v201, v202, v203
s_nop 0
v_cvt_pk_bf16_f32 v204, v204, v205
v_cvt_pk_bf16_f32 v205, v206, v207
v_mfma_f32_32x32x16_bf16 v[32:47], a[164:167], v[100:103], v[32:47]
ds_read_b64_tr_b16 a[156:157], v14 offset:7168
ds_read_b64_tr_b16 a[158:159], v14 offset:16384
v_cvt_pk_bf16_f32 v208, v208, v209
v_cvt_pk_bf16_f32 v209, v210, v211
ds_write_b64 v212, v[200:201]
ds_write_b64 v213, v[200:201]
ds_write_b64 v214, v[204:205]
s_waitcnt lgkmcnt(9)
v_mfma_f32_32x32x16_bf16 v[32:47], a[168:171], v[104:107], v[32:47]
ds_read_b64_tr_b16 a[160:161], v14 offset:25600
ds_read_b64_tr_b16 a[162:163], v14 offset:34816
buffer_load_dwordx4 a[28:31], v1, s[36:39], s80 offen offset:1024 sc1
ds_write_b64 v215, v[204:205]
ds_write_b64 v216, v[208:209]
ds_write_b64 v217, v[208:209]
v_mfma_f32_32x32x16_bf16 v[32:47], a[144:147], v[108:111], v[32:47]
ds_read_b64_tr_b16 a[164:165], v14 offset:8192
ds_read_b64_tr_b16 a[166:167], v14 offset:17408
s_waitcnt lgkmcnt(12)
v_mfma_f32_32x32x16_bf16 v[32:47], a[148:151], v[112:115], v[32:47]
ds_read_b64_tr_b16 a[168:169], v14 offset:26624
ds_read_b64_tr_b16 a[170:171], v14 offset:35840
s_waitcnt lgkmcnt(4)
s_barrier
v_mfma_f32_32x32x16_bf16 v[32:47], a[152:155], v[116:119], v[32:47]
v_add_u32 v14, 0, v25
ds_read_b64_tr_b16 a[144:145], v14 offset:0
ds_read_b64_tr_b16 a[146:147], v14 offset:18432
s_add_u32 s80, s80, 2097152
ds_read_b64_tr_b16 a[184:185], v253 offset:0
ds_read_b64_tr_b16 a[186:187], v253 offset:256
v_mfma_f32_32x32x16_bf16 v[32:47], a[156:159], v[120:123], v[32:47]
ds_read_b64_tr_b16 a[148:149], v14 offset:1024
ds_read_b64_tr_b16 a[150:151], v14 offset:19456
s_add_u32 s49, s71, 1
s_and_b32 s49, s49, 3
s_and_b32 s52, s49, 1
v_mfma_f32_32x32x16_bf16 v[32:47], a[160:163], v[124:127], v[32:47]
ds_read_b64_tr_b16 a[152:153], v14 offset:2048
ds_read_b64_tr_b16 a[154:155], v14 offset:20480
s_lshl2_add_u32 s49, s70, s49
s_mul_i32 s49, s49, 72
s_add_u32 s49, s49, s67
s_mul_i32 s49, s49, 4608
s_waitcnt lgkmcnt(8)
v_mfma_f32_32x32x16_bf16 v[32:47], a[164:167], v[128:131], v[32:47]
ds_read_b64_tr_b16 a[156:157], v14 offset:3072
ds_read_b64_tr_b16 a[158:159], v14 offset:21504
s_lshl_b32 s50, s71, 8
s_add_u32 s49, s49, s50
s_mul_i32 s50, s52, 36864
s_add_u32 s50, s50, s49
v_mfma_f32_32x32x16_bf16 v[32:47], a[168:171], v[132:135], v[32:47]
ds_read_b64_tr_b16 a[160:161], v14 offset:4096
ds_read_b64_tr_b16 a[162:163], v14 offset:22528
s_mul_i32 s51, s52, 4294672384
s_add_u32 s51, s51, s49
s_add_u32 s51, s51, 147456
s_add_u32 m0, s72, 110592
buffer_load_dwordx4 a[32:35], v1, s[36:39], s80 offen offset:0 sc1
s_waitcnt lgkmcnt(6)
v_mfma_f32_32x32x16_bf16 v[136:151], a[144:147], v[64:67], 0
ds_read_b64_tr_b16 a[164:165], v14 offset:5120
ds_read_b64_tr_b16 a[166:167], v14 offset:23552
buffer_load_dwordx4 v2, s[24:27], s50 offen offset:0 lds
s_waitcnt vmcnt(17)
buffer_store_dwordx2 a[180:181], v15, s[36:39], s74 offen offset:32 sc1
v_mfma_f32_32x32x16_bf16 v[136:151], a[148:151], v[68:71], v[136:151]
ds_read_b64_tr_b16 a[168:169], v14 offset:6144
ds_read_b64_tr_b16 a[170:171], v14 offset:24576
s_add_u32 s80, s71, 2
s_and_b32 s80, s80, 3
s_mul_i32 s80, s80, 8192
s_add_u32 s80, s80, s81
s_waitcnt lgkmcnt(6)
v_mfma_f32_32x32x16_bf16 v[136:151], a[152:155], v[72:75], v[136:151]
ds_read_b64_tr_b16 a[144:145], v14 offset:7168
ds_read_b64_tr_b16 a[146:147], v14 offset:25600
v_cvt_pk_bf16_f32 v32, v32, v33
v_cvt_pk_bf16_f32 v33, v34, v35
v_cvt_pk_bf16_f32 v34, v36, v37
v_mfma_f32_32x32x16_bf16 v[136:151], a[156:159], v[76:79], v[136:151]
ds_read_b64_tr_b16 a[148:149], v14 offset:8192
ds_read_b64_tr_b16 a[150:151], v14 offset:26624
buffer_load_dwordx4 v3, s[24:27], s50 offen offset:1024 lds
v_cvt_pk_bf16_f32 v35, v38, v39
v_cvt_pk_bf16_f32 v36, v40, v41
v_cvt_pk_bf16_f32 v37, v42, v43
s_waitcnt lgkmcnt(6)
v_mfma_f32_32x32x16_bf16 v[136:151], a[160:163], v[80:83], v[136:151]
v_xor_b32 v14, 64, v14
ds_read_b64_tr_b16 a[152:153], v14 offset:0
ds_read_b64_tr_b16 a[154:155], v14 offset:18432
v_cvt_pk_bf16_f32 v38, v44, v45
v_cvt_pk_bf16_f32 v39, v46, v47
buffer_load_dwordx4 a[36:39], v1, s[36:39], s80 offen offset:0 sc1
v_mfma_f32_32x32x16_bf16 v[136:151], a[164:167], v[84:87], v[136:151]
ds_read_b64_tr_b16 a[156:157], v14 offset:1024
ds_read_b64_tr_b16 a[158:159], v14 offset:19456
v_permlane32_swap_b32 v32, v34
v_permlane32_swap_b32 v33, v35
s_waitcnt lgkmcnt(6)
v_mfma_f32_32x32x16_bf16 v[136:151], a[168:171], v[88:91], v[136:151]
ds_read_b64_tr_b16 a[160:161], v14 offset:2048
ds_read_b64_tr_b16 a[162:163], v14 offset:20480
buffer_load_dwordx4 v4, s[24:27], s50 offen offset:2048 lds
v_permlane32_swap_b32 v36, v38
v_mfma_f32_32x32x16_bf16 v[136:151], a[144:147], v[92:95], v[136:151]
ds_read_b64_tr_b16 a[164:165], v14 offset:3072
ds_read_b64_tr_b16 a[166:167], v14 offset:21504
v_permlane32_swap_b32 v37, v39
s_add_u32 s82, s82, 1048576
buffer_store_dwordx4 v[32:35], v20, s[36:39], s82 offen sc1
buffer_load_dwordx4 a[40:43], v1, s[36:39], s80 offen offset:1024 sc1
s_waitcnt lgkmcnt(6)
v_mfma_f32_32x32x16_bf16 v[136:151], a[148:151], v[96:99], v[136:151]
ds_read_b64_tr_b16 a[168:169], v14 offset:4096
ds_read_b64_tr_b16 a[170:171], v14 offset:22528
s_add_u32 s82, s82, 1048576
buffer_store_dwordx4 v[36:39], v20, s[36:39], s82 offen sc1
s_add_u32 s80, s80, 2097152
v_mfma_f32_32x32x16_bf16 v[152:167], a[152:155], v[64:67], 0
ds_read_b64_tr_b16 a[144:145], v14 offset:5120
ds_read_b64_tr_b16 a[146:147], v14 offset:23552
buffer_load_dwordx4 v5, s[24:27], s50 offen offset:3072 lds
buffer_load_dwordx4 a[44:47], v1, s[36:39], s80 offen offset:0 sc1
ds_read_b64_tr_b16 a[188:189], v254 offset:0
ds_read_b64_tr_b16 a[190:191], v254 offset:128
s_waitcnt lgkmcnt(8)
v_mfma_f32_32x32x16_bf16 v[152:167], a[156:159], v[68:71], v[152:167]
ds_read_b64_tr_b16 a[148:149], v14 offset:6144
ds_read_b64_tr_b16 a[150:151], v14 offset:24576
ds_read_b64_tr_b16 a[192:193], v253 offset:1024
ds_read_b64_tr_b16 a[194:195], v253 offset:1280
ds_read_b64_tr_b16 a[196:197], v254 offset:512
v_mfma_f32_32x32x16_bf16 v[152:167], a[160:163], v[72:75], v[152:167]
ds_read_b64_tr_b16 a[152:153], v14 offset:7168
ds_read_b64_tr_b16 a[154:155], v14 offset:25600
s_add_u32 m0, s72, 114688
ds_read_b64_tr_b16 a[198:199], v254 offset:640
v_mfma_f32_32x32x16_bf16 v[208:223], a[184:187], v[232:235], 0
ds_read_b64_tr_b16 a[200:201], v253 offset:2048
ds_read_b64_tr_b16 a[202:203], v253 offset:2304
s_waitcnt lgkmcnt(10)
v_mfma_f32_16x16x32_bf16 v[224:227], a[188:191], v[232:235], 0
ds_read_b64_tr_b16 a[204:205], v254 offset:1024
v_mfma_f32_32x32x16_bf16 v[152:167], a[164:167], v[76:79], v[152:167]
ds_read_b64_tr_b16 a[156:157], v14 offset:8192
ds_read_b64_tr_b16 a[158:159], v14 offset:26624
buffer_load_dwordx4 v6, s[24:27], s50 offen offset:0 lds
ds_read_b64_tr_b16 a[206:207], v254 offset:1152
s_waitcnt lgkmcnt(10)
v_mfma_f32_32x32x16_bf16 v[208:223], a[192:195], v[236:239], v[208:223]
ds_read_b64_tr_b16 a[184:185], v253 offset:3072
ds_read_b64_tr_b16 a[186:187], v253 offset:3328
s_waitcnt lgkmcnt(8)
v_mfma_f32_16x16x32_bf16 v[224:227], a[196:199], v[236:239], v[224:227]
ds_read_b64_tr_b16 a[188:189], v254 offset:1536
v_mfma_f32_32x32x16_bf16 v[152:167], a[168:171], v[80:83], v[152:167]
v_xor_b32 v14, 192, v14
ds_read_b64_tr_b16 a[160:161], v14 offset:0
ds_read_b64_tr_b16 a[162:163], v14 offset:18432
buffer_load_dwordx4 a[48:51], v1, s[36:39], s80 offen offset:1024 sc1
ds_read_b64_tr_b16 a[190:191], v254 offset:1664
s_waitcnt lgkmcnt(10)
v_mfma_f32_32x32x16_bf16 v[208:223], a[200:203], v[240:243], v[208:223]
ds_read_b64_tr_b16 a[192:193], v253 offset:4096
ds_read_b64_tr_b16 a[194:195], v253 offset:4352
s_waitcnt lgkmcnt(8)
v_mfma_f32_16x16x32_bf16 v[224:227], a[204:207], v[240:243], v[224:227]
ds_read_b64_tr_b16 a[196:197], v254 offset:2048
v_mfma_f32_32x32x16_bf16 v[152:167], a[144:147], v[84:87], v[152:167]
ds_read_b64_tr_b16 a[164:165], v14 offset:1024
ds_read_b64_tr_b16 a[166:167], v14 offset:19456
ds_read_b64_tr_b16 a[198:199], v254 offset:2176
s_waitcnt lgkmcnt(10)
v_mfma_f32_32x32x16_bf16 v[208:223], a[184:187], v[244:247], v[208:223]
s_waitcnt lgkmcnt(6)
v_mfma_f32_16x16x32_bf16 v[224:227], a[188:191], v[244:247], v[224:227]
v_mfma_f32_32x32x16_bf16 v[152:167], a[148:151], v[88:91], v[152:167]
ds_read_b64_tr_b16 a[168:169], v14 offset:2048
ds_read_b64_tr_b16 a[170:171], v14 offset:20480
s_waitcnt lgkmcnt(6)
v_mfma_f32_32x32x16_bf16 v[208:223], a[192:195], v[248:251], v[208:223]
s_waitcnt lgkmcnt(2)
v_mfma_f32_16x16x32_bf16 v[224:227], a[196:199], v[248:251], v[224:227]
v_mfma_f32_32x32x16_bf16 v[152:167], a[152:155], v[92:95], v[152:167]
ds_read_b64_tr_b16 a[144:145], v14 offset:3072
ds_read_b64_tr_b16 a[146:147], v14 offset:21504
buffer_load_dwordx4 v7, s[24:27], s50 offen offset:1024 lds
s_add_u32 s80, s80, 2097152
v_mfma_f32_32x32x16_bf16 v[152:167], a[156:159], v[96:99], v[152:167]
ds_read_b64_tr_b16 a[148:149], v14 offset:4096
ds_read_b64_tr_b16 a[150:151], v14 offset:22528
buffer_load_dwordx4 a[52:55], v1, s[36:39], s80 offen offset:0 sc1
v_cndmask_b32 v29, v226, v224, s[98:99]
v_add_f32 v29, v29, v252
v_mfma_f32_32x32x16_bf16 v[168:183], a[160:163], v[64:67], 0
ds_read_b64_tr_b16 a[152:153], v14 offset:5120
ds_read_b64_tr_b16 a[154:155], v14 offset:23552
v_rcp_f32 v29, v29
v_cndmask_b32 v224, v224, v226, s[98:99]
v_mfma_f32_32x32x16_bf16 v[168:183], a[164:167], v[68:71], v[168:183]
ds_read_b64_tr_b16 a[156:157], v14 offset:6144
ds_read_b64_tr_b16 a[158:159], v14 offset:24576
buffer_load_dwordx4 v8, s[24:27], s50 offen offset:2048 lds
v_cndmask_b32 v225, v225, v227, s[98:99]
v_mul_f32 v208, v29, v208
v_mul_f32 v209, v29, v209
s_waitcnt lgkmcnt(6)
v_mfma_f32_32x32x16_bf16 v[168:183], a[168:171], v[72:75], v[168:183]
ds_read_b64_tr_b16 a[160:161], v14 offset:7168
ds_read_b64_tr_b16 a[162:163], v14 offset:25600
buffer_load_dwordx4 a[56:59], v1, s[36:39], s80 offen offset:1024 sc1
v_cvt_pk_bf16_f32 v232, v208, v209
v_mul_f32 v210, v29, v210
v_mfma_f32_32x32x16_bf16 v[168:183], a[144:147], v[76:79], v[168:183]
ds_read_b64_tr_b16 a[164:165], v14 offset:8192
ds_read_b64_tr_b16 a[166:167], v14 offset:26624
v_mul_f32 v211, v29, v211
v_cvt_pk_bf16_f32 v233, v210, v211
v_mul_f32 v212, v29, v212
v_mul_f32 v213, v29, v213
s_waitcnt lgkmcnt(6)
v_mfma_f32_32x32x16_bf16 v[168:183], a[148:151], v[80:83], v[168:183]
v_xor_b32 v14, 64, v14
ds_read_b64_tr_b16 a[168:169], v14 offset:0
ds_read_b64_tr_b16 a[170:171], v14 offset:18432
buffer_load_dwordx4 v9, s[24:27], s50 offen offset:3072 lds
v_cvt_pk_bf16_f32 v234, v212, v213
v_mfma_f32_32x32x16_bf16 v[168:183], a[152:155], v[84:87], v[168:183]
ds_read_b64_tr_b16 a[144:145], v14 offset:1024
ds_read_b64_tr_b16 a[146:147], v14 offset:19456
s_add_u32 s80, s80, 2097152
v_mul_f32 v214, v29, v214
v_mul_f32 v215, v29, v215
v_cvt_pk_bf16_f32 v235, v214, v215
s_waitcnt lgkmcnt(6)
v_mfma_f32_32x32x16_bf16 v[168:183], a[156:159], v[88:91], v[168:183]
ds_read_b64_tr_b16 a[148:149], v14 offset:2048
ds_read_b64_tr_b16 a[150:151], v14 offset:20480
s_add_u32 m0, s72, 118784
buffer_load_dwordx4 a[60:63], v1, s[36:39], s80 offen offset:0 sc1
v_mul_f32 v216, v29, v216
v_mfma_f32_32x32x16_bf16 v[168:183], a[160:163], v[92:95], v[168:183]
ds_read_b64_tr_b16 a[152:153], v14 offset:3072
ds_read_b64_tr_b16 a[154:155], v14 offset:21504
buffer_load_dwordx4 v10, s[24:27], s51 offen offset:0 lds
v_mul_f32 v217, v29, v217
v_cvt_pk_bf16_f32 v236, v216, v217
v_mul_f32 v218, v29, v218
s_waitcnt lgkmcnt(6)
v_mfma_f32_32x32x16_bf16 v[168:183], a[164:167], v[96:99], v[168:183]
ds_read_b64_tr_b16 a[156:157], v14 offset:4096
ds_read_b64_tr_b16 a[158:159], v14 offset:22528
v_mul_f32 v219, v29, v219
v_cvt_pk_bf16_f32 v237, v218, v219
v_mul_f32 v220, v29, v220
v_mfma_f32_32x32x16_bf16 v[184:199], a[168:171], v[64:67], 0
ds_read_b64_tr_b16 a[160:161], v14 offset:5120
ds_read_b64_tr_b16 a[162:163], v14 offset:23552
v_mul_f32 v221, v29, v221
v_cvt_pk_bf16_f32 v238, v220, v221
v_mul_f32 v222, v29, v222
v_mul_f32 v223, v29, v223
s_waitcnt lgkmcnt(6)
v_mfma_f32_32x32x16_bf16 v[184:199], a[144:147], v[68:71], v[184:199]
ds_read_b64_tr_b16 a[164:165], v14 offset:6144
ds_read_b64_tr_b16 a[166:167], v14 offset:24576
buffer_load_dwordx4 a[64:67], v1, s[36:39], s80 offen offset:1024 sc1
v_cvt_pk_bf16_f32 v239, v222, v223
v_mul_f32 v224, v29, v224
v_mfma_f32_32x32x16_bf16 v[184:199], a[148:151], v[72:75], v[184:199]
ds_read_b64_tr_b16 a[168:169], v14 offset:7168
ds_read_b64_tr_b16 a[170:171], v14 offset:25600
v_mul_f32 v225, v29, v225
v_cvt_pk_bf16_f32 v240, v224, v225
buffer_store_dwordx4 v[232:235], v1, s[36:39], s59 offen offset:0 sc1
buffer_store_dwordx4 v[236:239], v1, s[36:39], s59 offen offset:1024 sc1
s_waitcnt lgkmcnt(6)
v_mfma_f32_32x32x16_bf16 v[184:199], a[152:155], v[76:79], v[184:199]
ds_read_b64_tr_b16 a[144:145], v14 offset:8192
ds_read_b64_tr_b16 a[146:147], v14 offset:26624
s_waitcnt vmcnt(24)
s_barrier
buffer_store_dword v240, v255, s[36:39], s3 offen sc1
v_mfma_f32_32x32x16_bf16 v[184:199], a[156:159], v[80:83], v[184:199]
v_add_u32 v14, 36864, v25
ds_read_b64_tr_b16 a[148:149], v14 offset:0
ds_read_b64_tr_b16 a[150:151], v14 offset:18432
s_lshl_b32 s40, s71, 1
s_and_b32 s41, s70, 1
s_add_u32 s40, s40, s41
s_waitcnt lgkmcnt(6)
v_mfma_f32_32x32x16_bf16 v[184:199], a[160:163], v[84:87], v[184:199]
ds_read_b64_tr_b16 a[152:153], v14 offset:1024
ds_read_b64_tr_b16 a[154:155], v14 offset:19456
s_mul_i32 s41, s40, 82944
s_mul_i32 s42, s67, 2304
s_add_u32 s41, s41, s42
v_mfma_f32_32x32x16_bf16 v[184:199], a[164:167], v[88:91], v[184:199]
ds_read_b64_tr_b16 a[156:157], v14 offset:2048
ds_read_b64_tr_b16 a[158:159], v14 offset:20480
s_add_u32 s41, s41, 4268032
s_add_u32 m0, s42, 147456
s_mov_b64 exec, 0xffff
buffer_load_dwordx4 v1, s[36:39], s41 offen offset:2048 sc1 lds
s_mov_b64 exec, -1
s_waitcnt lgkmcnt(6)
v_mfma_f32_32x32x16_bf16 v[184:199], a[168:171], v[92:95], v[184:199]
ds_read_b64_tr_b16 a[160:161], v14 offset:3072
ds_read_b64_tr_b16 a[162:163], v14 offset:21504
buffer_load_dwordx4 v1, s[36:39], s41 offen offset:0 sc1 lds
buffer_load_dwordx4 v1, s[36:39], s41 offen offset:1024 sc1 lds
s_add_u32 s49, s71, 2
s_and_b32 s49, s49, 3
v_mfma_f32_32x32x16_bf16 v[184:199], a[144:147], v[96:99], v[184:199]
ds_read_b64_tr_b16 a[164:165], v14 offset:4096
ds_read_b64_tr_b16 a[166:167], v14 offset:22528
s_and_b32 s52, s49, 1
s_lshl2_add_u32 s49, s70, s49
s_mul_i32 s49, s49, 72
s_add_u32 s49, s49, s67
s_mul_i32 s49, s49, 4608
s_waitcnt lgkmcnt(6)
v_mfma_f32_32x32x16_bf16 v[136:151], a[148:151], v[100:103], v[136:151]
ds_read_b64_tr_b16 a[168:169], v14 offset:5120
ds_read_b64_tr_b16 a[170:171], v14 offset:23552
s_lshl_b32 s50, s71, 8
s_add_u32 s49, s49, s50
s_mul_i32 s50, s52, 36864
s_add_u32 s50, s50, s49
v_mfma_f32_32x32x16_bf16 v[136:151], a[152:155], v[104:107], v[136:151]
ds_read_b64_tr_b16 a[144:145], v14 offset:6144
ds_read_b64_tr_b16 a[146:147], v14 offset:24576
s_mul_i32 s51, s52, 4294672384
s_add_u32 s51, s51, s49
s_add_u32 s51, s51, 147456
s_add_u32 m0, s72, 0
s_add_u32 s80, s80, 2097152
s_waitcnt lgkmcnt(6)
v_mfma_f32_32x32x16_bf16 v[136:151], a[156:159], v[108:111], v[136:151]
ds_read_b64_tr_b16 a[148:149], v14 offset:7168
ds_read_b64_tr_b16 a[150:151], v14 offset:25600
buffer_load_dwordx4 v2, s[24:27], s50 offen offset:0 lds
buffer_load_dwordx4 a[68:71], v1, s[36:39], s80 offen offset:0 sc1
s_add_u32 s80, s71, 3
s_and_b32 s80, s80, 3
v_mfma_f32_32x32x16_bf16 v[136:151], a[160:163], v[112:115], v[136:151]
ds_read_b64_tr_b16 a[152:153], v14 offset:8192
ds_read_b64_tr_b16 a[154:155], v14 offset:26624
buffer_load_dwordx4 v3, s[24:27], s50 offen offset:1024 lds
s_mul_i32 s80, s80, 8192
s_add_u32 s80, s80, s81
buffer_load_dwordx4 a[72:75], v1, s[36:39], s80 offen offset:0 sc1
s_waitcnt lgkmcnt(6)
v_mfma_f32_32x32x16_bf16 v[136:151], a[164:167], v[116:119], v[136:151]
v_xor_b32 v14, 64, v14
ds_read_b64_tr_b16 a[156:157], v14 offset:0
ds_read_b64_tr_b16 a[158:159], v14 offset:18432
v_mfma_f32_32x32x16_bf16 v[136:151], a[168:171], v[120:123], v[136:151]
ds_read_b64_tr_b16 a[160:161], v14 offset:1024
ds_read_b64_tr_b16 a[162:163], v14 offset:19456
buffer_load_dwordx4 a[76:79], v1, s[36:39], s80 offen offset:1024 sc1
s_waitcnt lgkmcnt(6)
v_mfma_f32_32x32x16_bf16 v[136:151], a[144:147], v[124:127], v[136:151]
ds_read_b64_tr_b16 a[164:165], v14 offset:2048
ds_read_b64_tr_b16 a[166:167], v14 offset:20480
buffer_load_dwordx4 v4, s[24:27], s50 offen offset:2048 lds
v_mfma_f32_32x32x16_bf16 v[136:151], a[148:151], v[128:131], v[136:151]
ds_read_b64_tr_b16 a[168:169], v14 offset:3072
ds_read_b64_tr_b16 a[170:171], v14 offset:21504
s_waitcnt lgkmcnt(6)
v_mfma_f32_32x32x16_bf16 v[136:151], a[152:155], v[132:135], v[136:151]
ds_read_b64_tr_b16 a[144:145], v14 offset:4096
ds_read_b64_tr_b16 a[146:147], v14 offset:22528
s_add_u32 s80, s80, 2097152
v_mfma_f32_32x32x16_bf16 v[152:167], a[156:159], v[100:103], v[152:167]
ds_read_b64_tr_b16 a[148:149], v14 offset:5120
ds_read_b64_tr_b16 a[150:151], v14 offset:23552
buffer_load_dwordx4 v5, s[24:27], s50 offen offset:3072 lds
buffer_load_dwordx4 a[80:83], v1, s[36:39], s80 offen offset:0 sc1
s_waitcnt lgkmcnt(6)
v_mfma_f32_32x32x16_bf16 v[152:167], a[160:163], v[104:107], v[152:167]
ds_read_b64_tr_b16 a[152:153], v14 offset:6144
ds_read_b64_tr_b16 a[154:155], v14 offset:24576
v_mfma_f32_32x32x16_bf16 v[152:167], a[164:167], v[108:111], v[152:167]
ds_read_b64_tr_b16 a[156:157], v14 offset:7168
ds_read_b64_tr_b16 a[158:159], v14 offset:25600
s_add_u32 m0, s72, 4096
s_waitcnt lgkmcnt(6)
v_mfma_f32_32x32x16_bf16 v[152:167], a[168:171], v[112:115], v[152:167]
ds_read_b64_tr_b16 a[160:161], v14 offset:8192
ds_read_b64_tr_b16 a[162:163], v14 offset:26624
buffer_load_dwordx4 v6, s[24:27], s50 offen offset:0 lds
v_mfma_f32_32x32x16_bf16 v[152:167], a[144:147], v[116:119], v[152:167]
v_xor_b32 v14, 192, v14
ds_read_b64_tr_b16 a[164:165], v14 offset:0
ds_read_b64_tr_b16 a[166:167], v14 offset:18432
buffer_load_dwordx4 a[84:87], v1, s[36:39], s80 offen offset:1024 sc1
s_waitcnt lgkmcnt(6)
v_mfma_f32_32x32x16_bf16 v[152:167], a[148:151], v[120:123], v[152:167]
ds_read_b64_tr_b16 a[168:169], v14 offset:1024
ds_read_b64_tr_b16 a[170:171], v14 offset:19456
v_mfma_f32_32x32x16_bf16 v[152:167], a[152:155], v[124:127], v[152:167]
ds_read_b64_tr_b16 a[144:145], v14 offset:2048
ds_read_b64_tr_b16 a[146:147], v14 offset:20480
s_waitcnt lgkmcnt(6)
v_mfma_f32_32x32x16_bf16 v[152:167], a[156:159], v[128:131], v[152:167]
ds_read_b64_tr_b16 a[148:149], v14 offset:3072
ds_read_b64_tr_b16 a[150:151], v14 offset:21504
buffer_load_dwordx4 v7, s[24:27], s50 offen offset:1024 lds
s_add_u32 s80, s80, 2097152
v_mfma_f32_32x32x16_bf16 v[152:167], a[160:163], v[132:135], v[152:167]
ds_read_b64_tr_b16 a[152:153], v14 offset:4096
ds_read_b64_tr_b16 a[154:155], v14 offset:22528
buffer_load_dwordx4 a[88:91], v1, s[36:39], s80 offen offset:0 sc1
s_waitcnt lgkmcnt(6)
v_mfma_f32_32x32x16_bf16 v[168:183], a[164:167], v[100:103], v[168:183]
ds_read_b64_tr_b16 a[156:157], v14 offset:5120
ds_read_b64_tr_b16 a[158:159], v14 offset:23552
v_mfma_f32_32x32x16_bf16 v[168:183], a[168:171], v[104:107], v[168:183]
ds_read_b64_tr_b16 a[160:161], v14 offset:6144
ds_read_b64_tr_b16 a[162:163], v14 offset:24576
buffer_load_dwordx4 v8, s[24:27], s50 offen offset:2048 lds
s_waitcnt lgkmcnt(6)
v_mfma_f32_32x32x16_bf16 v[168:183], a[144:147], v[108:111], v[168:183]
ds_read_b64_tr_b16 a[164:165], v14 offset:7168
ds_read_b64_tr_b16 a[166:167], v14 offset:25600
buffer_load_dwordx4 a[92:95], v1, s[36:39], s80 offen offset:1024 sc1
v_mfma_f32_32x32x16_bf16 v[168:183], a[148:151], v[112:115], v[168:183]
ds_read_b64_tr_b16 a[168:169], v14 offset:8192
ds_read_b64_tr_b16 a[170:171], v14 offset:26624
s_waitcnt lgkmcnt(6)
v_mfma_f32_32x32x16_bf16 v[168:183], a[152:155], v[116:119], v[168:183]
v_xor_b32 v14, 64, v14
ds_read_b64_tr_b16 a[144:145], v14 offset:0
ds_read_b64_tr_b16 a[146:147], v14 offset:18432
buffer_load_dwordx4 v9, s[24:27], s50 offen offset:3072 lds
v_mfma_f32_32x32x16_bf16 v[168:183], a[156:159], v[120:123], v[168:183]
ds_read_b64_tr_b16 a[148:149], v14 offset:1024
ds_read_b64_tr_b16 a[150:151], v14 offset:19456
s_add_u32 s80, s80, 2097152
s_waitcnt lgkmcnt(6)
v_mfma_f32_32x32x16_bf16 v[168:183], a[160:163], v[124:127], v[168:183]
ds_read_b64_tr_b16 a[152:153], v14 offset:2048
ds_read_b64_tr_b16 a[154:155], v14 offset:20480
s_add_u32 m0, s72, 8192
buffer_load_dwordx4 a[96:99], v1, s[36:39], s80 offen offset:0 sc1
v_mfma_f32_32x32x16_bf16 v[168:183], a[164:167], v[128:131], v[168:183]
ds_read_b64_tr_b16 a[156:157], v14 offset:3072
ds_read_b64_tr_b16 a[158:159], v14 offset:21504
buffer_load_dwordx4 v10, s[24:27], s51 offen offset:0 lds
s_waitcnt vmcnt(20)
buffer_store_dwordx2 a[180:181], v15, s[36:39], s76 offen sc1
s_waitcnt lgkmcnt(6)
v_mfma_f32_32x32x16_bf16 v[168:183], a[168:171], v[132:135], v[168:183]
ds_read_b64_tr_b16 a[160:161], v14 offset:4096
ds_read_b64_tr_b16 a[162:163], v14 offset:22528
v_mfma_f32_32x32x16_bf16 v[184:199], a[144:147], v[100:103], v[184:199]
ds_read_b64_tr_b16 a[164:165], v14 offset:5120
ds_read_b64_tr_b16 a[166:167], v14 offset:23552
s_waitcnt lgkmcnt(6)
v_mfma_f32_32x32x16_bf16 v[184:199], a[148:151], v[104:107], v[184:199]
ds_read_b64_tr_b16 a[168:169], v14 offset:6144
ds_read_b64_tr_b16 a[170:171], v14 offset:24576
buffer_load_dwordx4 a[100:103], v1, s[36:39], s80 offen offset:1024 sc1
v_mfma_f32_32x32x16_bf16 v[184:199], a[152:155], v[108:111], v[184:199]
ds_read_b64_tr_b16 a[144:145], v14 offset:7168
ds_read_b64_tr_b16 a[146:147], v14 offset:25600
s_waitcnt lgkmcnt(6)
v_mfma_f32_32x32x16_bf16 v[184:199], a[156:159], v[112:115], v[184:199]
ds_read_b64_tr_b16 a[148:149], v14 offset:8192
ds_read_b64_tr_b16 a[150:151], v14 offset:26624
s_barrier
v_mfma_f32_32x32x16_bf16 v[184:199], a[160:163], v[116:119], v[184:199]
v_add_u32 v14, 110592, v25
ds_read_b64_tr_b16 a[152:153], v14 offset:0
ds_read_b64_tr_b16 a[154:155], v14 offset:18432
s_add_u32 s80, s80, 2097152
s_waitcnt lgkmcnt(6)
v_mfma_f32_32x32x16_bf16 v[184:199], a[164:167], v[120:123], v[184:199]
ds_read_b64_tr_b16 a[156:157], v14 offset:1024
ds_read_b64_tr_b16 a[158:159], v14 offset:19456
s_add_u32 s49, s71, 3
s_and_b32 s49, s49, 3
s_and_b32 s52, s49, 1
v_mfma_f32_32x32x16_bf16 v[184:199], a[168:171], v[124:127], v[184:199]
ds_read_b64_tr_b16 a[160:161], v14 offset:2048
ds_read_b64_tr_b16 a[162:163], v14 offset:20480
s_lshl2_add_u32 s49, s70, s49
s_mul_i32 s49, s49, 72
s_add_u32 s49, s49, s67
s_mul_i32 s49, s49, 4608
s_waitcnt lgkmcnt(6)
v_mfma_f32_32x32x16_bf16 v[184:199], a[144:147], v[128:131], v[184:199]
ds_read_b64_tr_b16 a[164:165], v14 offset:3072
ds_read_b64_tr_b16 a[166:167], v14 offset:21504
s_lshl_b32 s50, s71, 8
s_add_u32 s49, s49, s50
s_mul_i32 s50, s52, 36864
s_add_u32 s50, s50, s49
v_mfma_f32_32x32x16_bf16 v[184:199], a[148:151], v[132:135], v[184:199]
ds_read_b64_tr_b16 a[168:169], v14 offset:4096
ds_read_b64_tr_b16 a[170:171], v14 offset:22528
s_mul_i32 s51, s52, 4294672384
s_add_u32 s51, s51, s49
s_add_u32 s51, s51, 147456
s_add_u32 m0, s72, 36864
buffer_load_dwordx4 a[104:107], v1, s[36:39], s80 offen offset:0 sc1
s_waitcnt lgkmcnt(6)
v_mfma_f32_32x32x16_bf16 v[136:151], a[152:155], a[0:3], v[136:151]
ds_read_b64_tr_b16 a[144:145], v14 offset:5120
ds_read_b64_tr_b16 a[146:147], v14 offset:23552
buffer_load_dwordx4 v2, s[24:27], s50 offen offset:0 lds
buffer_load_dwordx2 v[22:23], v24, s[36:39], s66 offen offset:32 sc1
s_and_b32 s43, s70, 2
v_mfma_f32_32x32x16_bf16 v[136:151], a[156:159], a[4:7], v[136:151]
ds_read_b64_tr_b16 a[148:149], v14 offset:6144
ds_read_b64_tr_b16 a[150:151], v14 offset:24576
s_lshr_b32 s44, s67, 1
s_add_u32 s45, s43, s44
s_lshl2_add_u32 s43, s68, s45
s_waitcnt lgkmcnt(6)
v_mfma_f32_32x32x16_bf16 v[136:151], a[160:163], a[8:11], v[136:151]
ds_read_b64_tr_b16 a[152:153], v14 offset:7168
ds_read_b64_tr_b16 a[154:155], v14 offset:25600
s_and_b32 s44, s67, 1
s_lshl_b32 s46, s44, 8
v_and_b32 v46, 0xf0, v1
v_mfma_f32_32x32x16_bf16 v[136:151], a[164:167], a[12:15], v[136:151]
ds_read_b64_tr_b16 a[156:157], v14 offset:8192
ds_read_b64_tr_b16 a[158:159], v14 offset:26624
buffer_load_dwordx4 v3, s[24:27], s50 offen offset:1024 lds
v_add_u32 v46, s46, v46
v_lshrrev_b32 v47, 8, v1
s_waitcnt lgkmcnt(6)
v_mfma_f32_32x32x16_bf16 v[136:151], a[168:171], a[16:19], v[136:151]
v_xor_b32 v14, 64, v14
ds_read_b64_tr_b16 a[160:161], v14 offset:0
ds_read_b64_tr_b16 a[162:163], v14 offset:18432
v_lshl_add_u32 v33, v47, 9, v46
v_lshrrev_b32 v46, 1, v1
v_mfma_f32_32x32x16_bf16 v[136:151], a[144:147], a[20:23], v[136:151]
ds_read_b64_tr_b16 a[164:165], v14 offset:1024
ds_read_b64_tr_b16 a[166:167], v14 offset:19456
v_and_b32 v46, 0x78, v46
s_lshl_b32 s47, s43, 7
s_add_u32 s47, s47, 40960
s_waitcnt lgkmcnt(6)
v_mfma_f32_32x32x16_bf16 v[136:151], a[148:151], a[24:27], v[136:151]
ds_read_b64_tr_b16 a[168:169], v14 offset:2048
ds_read_b64_tr_b16 a[170:171], v14 offset:20480
buffer_load_dwordx4 v4, s[24:27], s50 offen offset:2048 lds
v_mfma_f32_32x32x16_bf16 v[136:151], a[152:155], a[28:31], v[136:151]
ds_read_b64_tr_b16 a[144:145], v14 offset:3072
ds_read_b64_tr_b16 a[146:147], v14 offset:21504
s_waitcnt lgkmcnt(6)
v_mfma_f32_32x32x16_bf16 v[136:151], a[156:159], a[32:35], v[136:151]
ds_read_b64_tr_b16 a[148:149], v14 offset:4096
ds_read_b64_tr_b16 a[150:151], v14 offset:22528
v_mfma_f32_32x32x16_bf16 v[152:167], a[160:163], a[0:3], v[152:167]
ds_read_b64_tr_b16 a[152:153], v14 offset:5120
ds_read_b64_tr_b16 a[154:155], v14 offset:23552
buffer_load_dwordx4 v5, s[24:27], s50 offen offset:3072 lds
s_waitcnt lgkmcnt(6)
v_mfma_f32_32x32x16_bf16 v[152:167], a[164:167], a[4:7], v[152:167]
ds_read_b64_tr_b16 a[156:157], v14 offset:6144
ds_read_b64_tr_b16 a[158:159], v14 offset:24576
v_mfma_f32_32x32x16_bf16 v[152:167], a[168:171], a[8:11], v[152:167]
ds_read_b64_tr_b16 a[160:161], v14 offset:7168
ds_read_b64_tr_b16 a[162:163], v14 offset:25600
s_add_u32 m0, s72, 40960
s_waitcnt lgkmcnt(6)
v_mfma_f32_32x32x16_bf16 v[152:167], a[144:147], a[12:15], v[152:167]
ds_read_b64_tr_b16 a[164:165], v14 offset:8192
ds_read_b64_tr_b16 a[166:167], v14 offset:26624
buffer_load_dwordx4 v6, s[24:27], s50 offen offset:0 lds
v_mfma_f32_32x32x16_bf16 v[152:167], a[148:151], a[16:19], v[152:167]
v_xor_b32 v14, 192, v14
ds_read_b64_tr_b16 a[168:169], v14 offset:0
ds_read_b64_tr_b16 a[170:171], v14 offset:18432
s_waitcnt lgkmcnt(6)
v_mfma_f32_32x32x16_bf16 v[152:167], a[152:155], a[20:23], v[152:167]
ds_read_b64_tr_b16 a[144:145], v14 offset:1024
ds_read_b64_tr_b16 a[146:147], v14 offset:19456
v_mfma_f32_32x32x16_bf16 v[152:167], a[156:159], a[24:27], v[152:167]
ds_read_b64_tr_b16 a[148:149], v14 offset:2048
ds_read_b64_tr_b16 a[150:151], v14 offset:20480
s_waitcnt lgkmcnt(6)
v_mfma_f32_32x32x16_bf16 v[152:167], a[160:163], a[28:31], v[152:167]
ds_read_b64_tr_b16 a[152:153], v14 offset:3072
ds_read_b64_tr_b16 a[154:155], v14 offset:21504
buffer_load_dwordx4 v7, s[24:27], s50 offen offset:1024 lds
v_mfma_f32_32x32x16_bf16 v[152:167], a[164:167], a[32:35], v[152:167]
ds_read_b64_tr_b16 a[156:157], v14 offset:4096
ds_read_b64_tr_b16 a[158:159], v14 offset:22528
s_waitcnt lgkmcnt(6)
v_mfma_f32_32x32x16_bf16 v[168:183], a[168:171], a[0:3], v[168:183]
ds_read_b64_tr_b16 a[160:161], v14 offset:5120
ds_read_b64_tr_b16 a[162:163], v14 offset:23552
s_waitcnt vmcnt(5)
v_cmp_ne_u64 vcc, s[94:95], v[22:23]
s_nop 0
s_cbranch_vccnz SLOW_hB
BACK_hB:
s_add_u32 s80, s71, 1
v_mfma_f32_32x32x16_bf16 v[168:183], a[144:147], a[4:7], v[168:183]
ds_read_b64_tr_b16 a[164:165], v14 offset:6144
ds_read_b64_tr_b16 a[166:167], v14 offset:24576
buffer_load_dwordx4 v8, s[24:27], s50 offen offset:2048 lds
s_and_b32 s80, s80, 3
s_mul_i32 s80, s80, 8192
s_add_u32 s80, s80, s81
s_add_u32 s80, s80, 8388608
s_waitcnt lgkmcnt(6)
v_mfma_f32_32x32x16_bf16 v[168:183], a[148:151], a[8:11], v[168:183]
ds_read_b64_tr_b16 a[168:169], v14 offset:7168
ds_read_b64_tr_b16 a[170:171], v14 offset:25600
buffer_load_dwordx4 a[108:111], v1, s[36:39], s80 offen offset:1024 sc1
s_add_u32 s80, s80, 2097152
buffer_load_dwordx4 a[112:115], v1, s[36:39], s80 offen offset:0 sc1
buffer_load_dwordx4 a[116:119], v1, s[36:39], s80 offen offset:1024 sc1
v_mfma_f32_32x32x16_bf16 v[168:183], a[152:155], a[12:15], v[168:183]
ds_read_b64_tr_b16 a[144:145], v14 offset:8192
ds_read_b64_tr_b16 a[146:147], v14 offset:26624
s_add_u32 s80, s80, 2097152
buffer_load_dwordx4 a[120:123], v1, s[36:39], s80 offen offset:0 sc1
buffer_load_dwordx4 a[124:127], v1, s[36:39], s80 offen offset:1024 sc1
s_add_u32 s80, s80, 2097152
s_waitcnt lgkmcnt(6)
v_mfma_f32_32x32x16_bf16 v[168:183], a[156:159], a[16:19], v[168:183]
v_xor_b32 v14, 64, v14
ds_read_b64_tr_b16 a[148:149], v14 offset:0
ds_read_b64_tr_b16 a[150:151], v14 offset:18432
buffer_load_dwordx4 v9, s[24:27], s50 offen offset:3072 lds
buffer_load_dwordx4 a[128:131], v1, s[36:39], s80 offen offset:0 sc1
v_mfma_f32_32x32x16_bf16 v[168:183], a[160:163], a[20:23], v[168:183]
ds_read_b64_tr_b16 a[152:153], v14 offset:1024
ds_read_b64_tr_b16 a[154:155], v14 offset:19456
s_waitcnt lgkmcnt(6)
v_mfma_f32_32x32x16_bf16 v[168:183], a[164:167], a[24:27], v[168:183]
ds_read_b64_tr_b16 a[156:157], v14 offset:2048
ds_read_b64_tr_b16 a[158:159], v14 offset:20480
s_add_u32 m0, s72, 45056
buffer_load_dwordx4 a[132:135], v1, s[36:39], s80 offen offset:1024 sc1
v_mfma_f32_32x32x16_bf16 v[168:183], a[168:171], a[28:31], v[168:183]
ds_read_b64_tr_b16 a[160:161], v14 offset:3072
ds_read_b64_tr_b16 a[162:163], v14 offset:21504
buffer_load_dwordx4 v10, s[24:27], s51 offen offset:0 lds
s_waitcnt lgkmcnt(6)
v_mfma_f32_32x32x16_bf16 v[168:183], a[144:147], a[32:35], v[168:183]
ds_read_b64_tr_b16 a[164:165], v14 offset:4096
ds_read_b64_tr_b16 a[166:167], v14 offset:22528
v_mfma_f32_32x32x16_bf16 v[184:199], a[148:151], a[0:3], v[184:199]
ds_read_b64_tr_b16 a[168:169], v14 offset:5120
ds_read_b64_tr_b16 a[170:171], v14 offset:23552
s_add_u32 s80, s80, 2097152
s_waitcnt lgkmcnt(6)
v_mfma_f32_32x32x16_bf16 v[184:199], a[152:155], a[4:7], v[184:199]
ds_read_b64_tr_b16 a[144:145], v14 offset:6144
ds_read_b64_tr_b16 a[146:147], v14 offset:24576
buffer_load_dwordx4 a[136:139], v1, s[36:39], s80 offen offset:0 sc1
v_mfma_f32_32x32x16_bf16 v[184:199], a[156:159], a[8:11], v[184:199]
ds_read_b64_tr_b16 a[148:149], v14 offset:7168
ds_read_b64_tr_b16 a[150:151], v14 offset:25600
s_waitcnt lgkmcnt(6)
v_mfma_f32_32x32x16_bf16 v[184:199], a[160:163], a[12:15], v[184:199]
ds_read_b64_tr_b16 a[152:153], v14 offset:8192
ds_read_b64_tr_b16 a[154:155], v14 offset:26624
s_barrier
v_mfma_f32_32x32x16_bf16 v[184:199], a[164:167], a[16:19], v[184:199]
v_add_u32 v14, 0, v25
ds_read_b64_tr_b16 a[156:157], v14 offset:0
ds_read_b64_tr_b16 a[158:159], v14 offset:18432
s_waitcnt lgkmcnt(6)
v_mfma_f32_32x32x16_bf16 v[184:199], a[168:171], a[20:23], v[184:199]
ds_read_b64_tr_b16 a[160:161], v14 offset:1024
ds_read_b64_tr_b16 a[162:163], v14 offset:19456
s_add_u32 s49, s71, 1
s_and_b32 s49, s49, 3
s_and_b32 s52, s49, 1
v_mfma_f32_32x32x16_bf16 v[184:199], a[144:147], a[24:27], v[184:199]
ds_read_b64_tr_b16 a[164:165], v14 offset:2048
ds_read_b64_tr_b16 a[166:167], v14 offset:20480
s_lshl2_add_u32 s49, s70, s49
s_mul_i32 s49, s49, 72
s_add_u32 s49, s49, s67
s_mul_i32 s49, s49, 4608
s_waitcnt lgkmcnt(6)
v_mfma_f32_32x32x16_bf16 v[184:199], a[148:151], a[28:31], v[184:199]
ds_read_b64_tr_b16 a[168:169], v14 offset:3072
ds_read_b64_tr_b16 a[170:171], v14 offset:21504
s_lshl_b32 s50, s71, 8
s_add_u32 s49, s49, s50
s_mul_i32 s50, s52, 4294672384
s_add_u32 s50, s50, s49
v_mfma_f32_32x32x16_bf16 v[184:199], a[152:155], a[32:35], v[184:199]
ds_read_b64_tr_b16 a[144:145], v14 offset:4096
ds_read_b64_tr_b16 a[146:147], v14 offset:22528
s_add_u32 s50, s50, 313344
s_mul_i32 s51, s52, 36864
s_add_u32 s51, s51, s49
s_add_u32 s51, s51, 129024
s_add_u32 m0, s72, 110592
s_waitcnt lgkmcnt(6)
v_mfma_f32_32x32x16_bf16 v[136:151], a[156:159], a[36:39], v[136:151]
ds_read_b64_tr_b16 a[148:149], v14 offset:5120
ds_read_b64_tr_b16 a[150:151], v14 offset:23552
buffer_load_dwordx4 v2, s[24:27], s50 offen offset:0 lds
buffer_load_dwordx4 a[140:143], v1, s[36:39], s80 offen offset:1024 sc1
s_add_u32 s80, s71, 2
v_mfma_f32_32x32x16_bf16 v[136:151], a[160:163], a[40:43], v[136:151]
ds_read_b64_tr_b16 a[152:153], v14 offset:6144
ds_read_b64_tr_b16 a[154:155], v14 offset:24576
s_and_b32 s80, s80, 3
s_mul_i32 s80, s80, 8192
s_add_u32 s80, s80, s81
s_add_u32 s80, s80, 8388608
s_waitcnt lgkmcnt(6)
v_mfma_f32_32x32x16_bf16 v[136:151], a[164:167], a[44:47], v[136:151]
ds_read_b64_tr_b16 a[156:157], v14 offset:7168
ds_read_b64_tr_b16 a[158:159], v14 offset:25600
buffer_load_dwordx4 a[0:3], v1, s[36:39], s80 offen offset:1024 sc1
v_mfma_f32_32x32x16_bf16 v[136:151], a[168:171], a[48:51], v[136:151]
ds_read_b64_tr_b16 a[160:161], v14 offset:8192
ds_read_b64_tr_b16 a[162:163], v14 offset:26624
buffer_load_dwordx4 v3, s[24:27], s51 offen offset:1024 lds
s_waitcnt lgkmcnt(6)
v_mfma_f32_32x32x16_bf16 v[136:151], a[144:147], a[52:55], v[136:151]
v_xor_b32 v14, 64, v14
ds_read_b64_tr_b16 a[164:165], v14 offset:0
ds_read_b64_tr_b16 a[166:167], v14 offset:18432
s_add_u32 s80, s80, 2097152
v_mfma_f32_32x32x16_bf16 v[136:151], a[148:151], a[56:59], v[136:151]
ds_read_b64_tr_b16 a[168:169], v14 offset:1024
ds_read_b64_tr_b16 a[170:171], v14 offset:19456
buffer_load_dwordx4 a[4:7], v1, s[36:39], s80 offen offset:0 sc1
s_waitcnt lgkmcnt(6)
v_mfma_f32_32x32x16_bf16 v[136:151], a[152:155], a[60:63], v[136:151]
ds_read_b64_tr_b16 a[144:145], v14 offset:2048
ds_read_b64_tr_b16 a[146:147], v14 offset:20480
buffer_load_dwordx4 v4, s[24:27], s51 offen offset:2048 lds
v_mfma_f32_32x32x16_bf16 v[136:151], a[156:159], a[64:67], v[136:151]
ds_read_b64_tr_b16 a[148:149], v14 offset:3072
ds_read_b64_tr_b16 a[150:151], v14 offset:21504
s_waitcnt lgkmcnt(6)
v_mfma_f32_32x32x16_bf16 v[136:151], a[160:163], a[68:71], v[136:151]
ds_read_b64_tr_b16 a[152:153], v14 offset:4096
ds_read_b64_tr_b16 a[154:155], v14 offset:22528
v_mfma_f32_32x32x16_bf16 v[152:167], a[164:167], a[36:39], v[152:167]
ds_read_b64_tr_b16 a[156:157], v14 offset:5120
ds_read_b64_tr_b16 a[158:159], v14 offset:23552
buffer_load_dwordx4 v5, s[24:27], s51 offen offset:3072 lds
buffer_load_dwordx4 a[8:11], v1, s[36:39], s80 offen offset:1024 sc1
s_waitcnt lgkmcnt(6)
v_mfma_f32_32x32x16_bf16 v[152:167], a[168:171], a[40:43], v[152:167]
ds_read_b64_tr_b16 a[160:161], v14 offset:6144
ds_read_b64_tr_b16 a[162:163], v14 offset:24576
v_mfma_f32_32x32x16_bf16 v[152:167], a[144:147], a[44:47], v[152:167]
ds_read_b64_tr_b16 a[164:165], v14 offset:7168
ds_read_b64_tr_b16 a[166:167], v14 offset:25600
s_add_u32 m0, s72, 114688
s_waitcnt lgkmcnt(6)
v_mfma_f32_32x32x16_bf16 v[152:167], a[148:151], a[48:51], v[152:167]
ds_read_b64_tr_b16 a[168:169], v14 offset:8192
ds_read_b64_tr_b16 a[170:171], v14 offset:26624
buffer_load_dwordx4 v6, s[24:27], s51 offen offset:0 lds
s_add_u32 s80, s80, 2097152
v_mfma_f32_32x32x16_bf16 v[152:167], a[152:155], a[52:55], v[152:167]
v_xor_b32 v14, 192, v14
ds_read_b64_tr_b16 a[144:145], v14 offset:0
ds_read_b64_tr_b16 a[146:147], v14 offset:18432
buffer_load_dwordx4 a[12:15], v1, s[36:39], s80 offen offset:0 sc1
s_waitcnt lgkmcnt(6)
v_mfma_f32_32x32x16_bf16 v[152:167], a[156:159], a[56:59], v[152:167]
ds_read_b64_tr_b16 a[148:149], v14 offset:1024
ds_read_b64_tr_b16 a[150:151], v14 offset:19456
v_mfma_f32_32x32x16_bf16 v[152:167], a[160:163], a[60:63], v[152:167]
ds_read_b64_tr_b16 a[152:153], v14 offset:2048
ds_read_b64_tr_b16 a[154:155], v14 offset:20480
s_waitcnt lgkmcnt(6)
v_mfma_f32_32x32x16_bf16 v[152:167], a[164:167], a[64:67], v[152:167]
ds_read_b64_tr_b16 a[156:157], v14 offset:3072
ds_read_b64_tr_b16 a[158:159], v14 offset:21504
buffer_load_dwordx4 v7, s[24:27], s51 offen offset:1024 lds
v_mfma_f32_32x32x16_bf16 v[152:167], a[168:171], a[68:71], v[152:167]
ds_read_b64_tr_b16 a[160:161], v14 offset:4096
ds_read_b64_tr_b16 a[162:163], v14 offset:22528
buffer_load_dwordx4 a[16:19], v1, s[36:39], s80 offen offset:1024 sc1
s_waitcnt lgkmcnt(6)
v_mfma_f32_32x32x16_bf16 v[168:183], a[144:147], a[36:39], v[168:183]
ds_read_b64_tr_b16 a[164:165], v14 offset:5120
ds_read_b64_tr_b16 a[166:167], v14 offset:23552
v_mfma_f32_32x32x16_bf16 v[168:183], a[148:151], a[40:43], v[168:183]
ds_read_b64_tr_b16 a[168:169], v14 offset:6144
ds_read_b64_tr_b16 a[170:171], v14 offset:24576
buffer_load_dwordx4 v8, s[24:27], s51 offen offset:2048 lds
s_add_u32 s80, s80, 2097152
s_waitcnt lgkmcnt(6)
v_mfma_f32_32x32x16_bf16 v[168:183], a[152:155], a[44:47], v[168:183]
ds_read_b64_tr_b16 a[144:145], v14 offset:7168
ds_read_b64_tr_b16 a[146:147], v14 offset:25600
buffer_load_dwordx4 a[20:23], v1, s[36:39], s80 offen offset:0 sc1
v_mfma_f32_32x32x16_bf16 v[168:183], a[156:159], a[48:51], v[168:183]
ds_read_b64_tr_b16 a[148:149], v14 offset:8192
ds_read_b64_tr_b16 a[150:151], v14 offset:26624
s_waitcnt lgkmcnt(6)
v_mfma_f32_32x32x16_bf16 v[168:183], a[160:163], a[52:55], v[168:183]
v_xor_b32 v14, 64, v14
ds_read_b64_tr_b16 a[152:153], v14 offset:0
ds_read_b64_tr_b16 a[154:155], v14 offset:18432
buffer_load_dwordx4 v9, s[24:27], s51 offen offset:3072 lds
v_mfma_f32_32x32x16_bf16 v[168:183], a[164:167], a[56:59], v[168:183]
ds_read_b64_tr_b16 a[156:157], v14 offset:1024
ds_read_b64_tr_b16 a[158:159], v14 offset:19456
s_waitcnt lgkmcnt(6)
v_mfma_f32_32x32x16_bf16 v[168:183], a[168:171], a[60:63], v[168:183]
ds_read_b64_tr_b16 a[160:161], v14 offset:2048
ds_read_b64_tr_b16 a[162:163], v14 offset:20480
s_add_u32 m0, s72, 118784
buffer_load_dwordx4 a[24:27], v1, s[36:39], s80 offen offset:1024 sc1
v_mfma_f32_32x32x16_bf16 v[168:183], a[144:147], a[64:67], v[168:183]
ds_read_b64_tr_b16 a[164:165], v14 offset:3072
ds_read_b64_tr_b16 a[166:167], v14 offset:21504
buffer_load_dwordx4 v10, s[24:27], s51 offen offset:0 lds
s_waitcnt lgkmcnt(6)
v_mfma_f32_32x32x16_bf16 v[168:183], a[148:151], a[68:71], v[168:183]
ds_read_b64_tr_b16 a[168:169], v14 offset:4096
ds_read_b64_tr_b16 a[170:171], v14 offset:22528
v_mfma_f32_32x32x16_bf16 v[184:199], a[152:155], a[36:39], v[184:199]
ds_read_b64_tr_b16 a[144:145], v14 offset:5120
ds_read_b64_tr_b16 a[146:147], v14 offset:23552
s_add_u32 s80, s80, 2097152
s_waitcnt lgkmcnt(6)
v_mfma_f32_32x32x16_bf16 v[184:199], a[156:159], a[40:43], v[184:199]
ds_read_b64_tr_b16 a[148:149], v14 offset:6144
ds_read_b64_tr_b16 a[150:151], v14 offset:24576
buffer_load_dwordx4 a[28:31], v1, s[36:39], s80 offen offset:0 sc1
v_mfma_f32_32x32x16_bf16 v[184:199], a[160:163], a[44:47], v[184:199]
ds_read_b64_tr_b16 a[152:153], v14 offset:7168
ds_read_b64_tr_b16 a[154:155], v14 offset:25600
s_waitcnt lgkmcnt(6)
v_mfma_f32_32x32x16_bf16 v[184:199], a[164:167], a[48:51], v[184:199]
ds_read_b64_tr_b16 a[156:157], v14 offset:8192
ds_read_b64_tr_b16 a[158:159], v14 offset:26624
s_waitcnt vmcnt(19)
s_barrier
v_mfma_f32_32x32x16_bf16 v[184:199], a[168:171], a[52:55], v[184:199]
v_add_u32 v14, 36864, v25
ds_read_b64_tr_b16 a[160:161], v14 offset:0
ds_read_b64_tr_b16 a[162:163], v14 offset:18432
s_waitcnt lgkmcnt(6)
v_mfma_f32_32x32x16_bf16 v[184:199], a[144:147], a[56:59], v[184:199]
ds_read_b64_tr_b16 a[164:165], v14 offset:1024
ds_read_b64_tr_b16 a[166:167], v14 offset:19456
s_add_u32 s49, s71, 2
s_and_b32 s49, s49, 3
s_and_b32 s52, s49, 1
v_mfma_f32_32x32x16_bf16 v[184:199], a[148:151], a[60:63], v[184:199]
ds_read_b64_tr_b16 a[168:169], v14 offset:2048
ds_read_b64_tr_b16 a[170:171], v14 offset:20480
s_lshl2_add_u32 s49, s70, s49
s_mul_i32 s49, s49, 72
s_add_u32 s49, s49, s67
s_mul_i32 s49, s49, 4608
s_waitcnt lgkmcnt(6)
v_mfma_f32_32x32x16_bf16 v[184:199], a[152:155], a[64:67], v[184:199]
ds_read_b64_tr_b16 a[144:145], v14 offset:3072
ds_read_b64_tr_b16 a[146:147], v14 offset:21504
s_lshl_b32 s50, s71, 8
s_add_u32 s49, s49, s50
s_mul_i32 s50, s52, 4294672384
s_add_u32 s50, s50, s49
v_mfma_f32_32x32x16_bf16 v[184:199], a[156:159], a[68:71], v[184:199]
ds_read_b64_tr_b16 a[148:149], v14 offset:4096
ds_read_b64_tr_b16 a[150:151], v14 offset:22528
s_add_u32 s50, s50, 313344
s_mul_i32 s51, s52, 36864
s_add_u32 s51, s51, s49
s_add_u32 s51, s51, 129024
s_add_u32 m0, s72, 0
s_waitcnt lgkmcnt(6)
v_mfma_f32_32x32x16_bf16 v[136:151], a[160:163], a[72:75], v[136:151]
ds_read_b64_tr_b16 a[152:153], v14 offset:5120
ds_read_b64_tr_b16 a[154:155], v14 offset:23552
buffer_load_dwordx4 v2, s[24:27], s50 offen offset:0 lds
buffer_load_dwordx4 a[32:35], v1, s[36:39], s80 offen offset:1024 sc1
s_add_u32 s80, s71, 3
v_mfma_f32_32x32x16_bf16 v[136:151], a[164:167], a[76:79], v[136:151]
ds_read_b64_tr_b16 a[156:157], v14 offset:6144
ds_read_b64_tr_b16 a[158:159], v14 offset:24576
s_and_b32 s80, s80, 3
s_mul_i32 s80, s80, 8192
s_add_u32 s80, s80, s81
s_add_u32 s80, s80, 8388608
s_waitcnt lgkmcnt(6)
v_mfma_f32_32x32x16_bf16 v[136:151], a[168:171], a[80:83], v[136:151]
ds_read_b64_tr_b16 a[160:161], v14 offset:7168
ds_read_b64_tr_b16 a[162:163], v14 offset:25600
buffer_load_dwordx4 a[36:39], v1, s[36:39], s80 offen offset:1024 sc1
v_mfma_f32_32x32x16_bf16 v[136:151], a[144:147], a[84:87], v[136:151]
ds_read_b64_tr_b16 a[164:165], v14 offset:8192
ds_read_b64_tr_b16 a[166:167], v14 offset:26624
buffer_load_dwordx4 v3, s[24:27], s51 offen offset:1024 lds
s_waitcnt lgkmcnt(6)
v_mfma_f32_32x32x16_bf16 v[136:151], a[148:151], a[88:91], v[136:151]
v_xor_b32 v14, 64, v14
ds_read_b64_tr_b16 a[168:169], v14 offset:0
ds_read_b64_tr_b16 a[170:171], v14 offset:18432
s_add_u32 s80, s80, 2097152
v_mfma_f32_32x32x16_bf16 v[136:151], a[152:155], a[92:95], v[136:151]
ds_read_b64_tr_b16 a[144:145], v14 offset:1024
ds_read_b64_tr_b16 a[146:147], v14 offset:19456
buffer_load_dwordx4 a[40:43], v1, s[36:39], s80 offen offset:0 sc1
s_waitcnt lgkmcnt(6)
v_mfma_f32_32x32x16_bf16 v[136:151], a[156:159], a[96:99], v[136:151]
ds_read_b64_tr_b16 a[148:149], v14 offset:2048
ds_read_b64_tr_b16 a[150:151], v14 offset:20480
buffer_load_dwordx4 v4, s[24:27], s51 offen offset:2048 lds
v_mfma_f32_32x32x16_bf16 v[136:151], a[160:163], a[100:103], v[136:151]
ds_read_b64_tr_b16 a[152:153], v14 offset:3072
ds_read_b64_tr_b16 a[154:155], v14 offset:21504
s_waitcnt lgkmcnt(6)
v_mfma_f32_32x32x16_bf16 v[136:151], a[164:167], a[104:107], v[136:151]
ds_read_b64_tr_b16 a[156:157], v14 offset:4096
ds_read_b64_tr_b16 a[158:159], v14 offset:22528
v_mfma_f32_32x32x16_bf16 v[152:167], a[168:171], a[72:75], v[152:167]
ds_read_b64_tr_b16 a[160:161], v14 offset:5120
ds_read_b64_tr_b16 a[162:163], v14 offset:23552
buffer_load_dwordx4 v5, s[24:27], s51 offen offset:3072 lds
buffer_load_dwordx4 a[44:47], v1, s[36:39], s80 offen offset:1024 sc1
s_waitcnt lgkmcnt(6)
v_mfma_f32_32x32x16_bf16 v[152:167], a[144:147], a[76:79], v[152:167]
ds_read_b64_tr_b16 a[164:165], v14 offset:6144
ds_read_b64_tr_b16 a[166:167], v14 offset:24576
v_mfma_f32_32x32x16_bf16 v[152:167], a[148:151], a[80:83], v[152:167]
ds_read_b64_tr_b16 a[168:169], v14 offset:7168
ds_read_b64_tr_b16 a[170:171], v14 offset:25600
s_add_u32 m0, s72, 4096
s_waitcnt lgkmcnt(6)
v_mfma_f32_32x32x16_bf16 v[152:167], a[152:155], a[84:87], v[152:167]
ds_read_b64_tr_b16 a[144:145], v14 offset:8192
ds_read_b64_tr_b16 a[146:147], v14 offset:26624
buffer_load_dwordx4 v6, s[24:27], s51 offen offset:0 lds
s_add_u32 s80, s80, 2097152
v_mfma_f32_32x32x16_bf16 v[152:167], a[156:159], a[88:91], v[152:167]
v_xor_b32 v14, 192, v14
ds_read_b64_tr_b16 a[148:149], v14 offset:0
ds_read_b64_tr_b16 a[150:151], v14 offset:18432
buffer_load_dwordx4 a[48:51], v1, s[36:39], s80 offen offset:0 sc1
s_waitcnt lgkmcnt(6)
v_mfma_f32_32x32x16_bf16 v[152:167], a[160:163], a[92:95], v[152:167]
ds_read_b64_tr_b16 a[152:153], v14 offset:1024
ds_read_b64_tr_b16 a[154:155], v14 offset:19456
buffer_load_dwordx2 v[56:57], v46, s[36:39], s47 offen sc1
s_lshl_b32 s87, s43, 15
s_add_u32 s87, s87, 5242880
v_mfma_f32_32x32x16_bf16 v[152:167], a[164:167], a[96:99], v[152:167]
ds_read_b64_tr_b16 a[156:157], v14 offset:2048
ds_read_b64_tr_b16 a[158:159], v14 offset:20480
s_lshl_b32 s48, s43, 12
s_add_u32 s48, s48, 7340032
s_and_b32 s46, s70, 1
s_lshl1_add_u32 s46, s43, s46
s_waitcnt lgkmcnt(6)
v_mfma_f32_32x32x16_bf16 v[152:167], a[168:171], a[100:103], v[152:167]
ds_read_b64_tr_b16 a[160:161], v14 offset:3072
ds_read_b64_tr_b16 a[162:163], v14 offset:21504
buffer_load_dwordx4 v7, s[24:27], s51 offen offset:1024 lds
s_lshl_b32 s46, s46, 11
s_lshl_b32 s41, s71, 20
v_mfma_f32_32x32x16_bf16 v[152:167], a[144:147], a[104:107], v[152:167]
ds_read_b64_tr_b16 a[164:165], v14 offset:4096
ds_read_b64_tr_b16 a[166:167], v14 offset:22528
buffer_load_dwordx4 a[52:55], v1, s[36:39], s80 offen offset:1024 sc1
s_add_u32 s46, s46, s41
s_add_u32 s46, s46, 8388608
s_waitcnt lgkmcnt(6)
v_mfma_f32_32x32x16_bf16 v[168:183], a[148:151], a[72:75], v[168:183]
ds_read_b64_tr_b16 a[168:169], v14 offset:5120
ds_read_b64_tr_b16 a[170:171], v14 offset:23552
v_mfma_f32_32x32x16_bf16 v[168:183], a[152:155], a[76:79], v[168:183]
ds_read_b64_tr_b16 a[144:145], v14 offset:6144
ds_read_b64_tr_b16 a[146:147], v14 offset:24576
buffer_load_dwordx4 v8, s[24:27], s51 offen offset:2048 lds
s_add_u32 s80, s80, 2097152
s_waitcnt lgkmcnt(6)
v_mfma_f32_32x32x16_bf16 v[168:183], a[156:159], a[80:83], v[168:183]
ds_read_b64_tr_b16 a[148:149], v14 offset:7168
ds_read_b64_tr_b16 a[150:151], v14 offset:25600
buffer_load_dwordx4 a[56:59], v1, s[36:39], s80 offen offset:0 sc1
v_mfma_f32_32x32x16_bf16 v[168:183], a[160:163], a[84:87], v[168:183]
ds_read_b64_tr_b16 a[152:153], v14 offset:8192
ds_read_b64_tr_b16 a[154:155], v14 offset:26624
s_waitcnt lgkmcnt(6)
v_mfma_f32_32x32x16_bf16 v[168:183], a[164:167], a[88:91], v[168:183]
v_xor_b32 v14, 64, v14
ds_read_b64_tr_b16 a[156:157], v14 offset:0
ds_read_b64_tr_b16 a[158:159], v14 offset:18432
buffer_load_dwordx4 v9, s[24:27], s51 offen offset:3072 lds
v_mfma_f32_32x32x16_bf16 v[168:183], a[168:171], a[92:95], v[168:183]
ds_read_b64_tr_b16 a[160:161], v14 offset:1024
ds_read_b64_tr_b16 a[162:163], v14 offset:19456
s_waitcnt lgkmcnt(6)
v_mfma_f32_32x32x16_bf16 v[168:183], a[144:147], a[96:99], v[168:183]
ds_read_b64_tr_b16 a[164:165], v14 offset:2048
ds_read_b64_tr_b16 a[166:167], v14 offset:20480
s_add_u32 m0, s72, 8192
buffer_load_dwordx4 a[60:63], v1, s[36:39], s80 offen offset:1024 sc1
v_mfma_f32_32x32x16_bf16 v[168:183], a[148:151], a[100:103], v[168:183]
ds_read_b64_tr_b16 a[168:169], v14 offset:3072
ds_read_b64_tr_b16 a[170:171], v14 offset:21504
buffer_load_dwordx4 v10, s[24:27], s51 offen offset:0 lds
s_waitcnt lgkmcnt(6)
v_mfma_f32_32x32x16_bf16 v[168:183], a[152:155], a[104:107], v[168:183]
ds_read_b64_tr_b16 a[144:145], v14 offset:4096
ds_read_b64_tr_b16 a[146:147], v14 offset:22528
v_mfma_f32_32x32x16_bf16 v[184:199], a[156:159], a[72:75], v[184:199]
ds_read_b64_tr_b16 a[148:149], v14 offset:5120
ds_read_b64_tr_b16 a[150:151], v14 offset:23552
s_add_u32 s80, s80, 2097152
s_waitcnt lgkmcnt(6)
v_mfma_f32_32x32x16_bf16 v[184:199], a[160:163], a[76:79], v[184:199]
ds_read_b64_tr_b16 a[152:153], v14 offset:6144
ds_read_b64_tr_b16 a[154:155], v14 offset:24576
buffer_load_dwordx4 a[64:67], v1, s[36:39], s80 offen offset:0 sc1
v_mfma_f32_32x32x16_bf16 v[184:199], a[164:167], a[80:83], v[184:199]
ds_read_b64_tr_b16 a[156:157], v14 offset:7168
ds_read_b64_tr_b16 a[158:159], v14 offset:25600
s_waitcnt lgkmcnt(6)
v_mfma_f32_32x32x16_bf16 v[184:199], a[168:171], a[84:87], v[184:199]
ds_read_b64_tr_b16 a[160:161], v14 offset:8192
ds_read_b64_tr_b16 a[162:163], v14 offset:26624
s_waitcnt vmcnt(20)
s_barrier
v_mfma_f32_32x32x16_bf16 v[184:199], a[144:147], a[88:91], v[184:199]
v_add_u32 v14, 110592, v25
ds_read_b64_tr_b16 a[164:165], v14 offset:0
ds_read_b64_tr_b16 a[166:167], v14 offset:18432
s_waitcnt lgkmcnt(6)
v_mfma_f32_32x32x16_bf16 v[184:199], a[148:151], a[92:95], v[184:199]
ds_read_b64_tr_b16 a[168:169], v14 offset:1024
ds_read_b64_tr_b16 a[170:171], v14 offset:19456
s_add_u32 s49, s71, 3
s_and_b32 s49, s49, 3
s_and_b32 s52, s49, 1
v_mfma_f32_32x32x16_bf16 v[184:199], a[152:155], a[96:99], v[184:199]
ds_read_b64_tr_b16 a[144:145], v14 offset:2048
ds_read_b64_tr_b16 a[146:147], v14 offset:20480
s_lshl2_add_u32 s49, s70, s49
s_mul_i32 s49, s49, 72
s_add_u32 s49, s49, s67
s_mul_i32 s49, s49, 4608
s_waitcnt lgkmcnt(6)
v_mfma_f32_32x32x16_bf16 v[184:199], a[156:159], a[100:103], v[184:199]
ds_read_b64_tr_b16 a[148:149], v14 offset:3072
ds_read_b64_tr_b16 a[150:151], v14 offset:21504
s_lshl_b32 s50, s71, 8
s_add_u32 s49, s49, s50
s_mul_i32 s50, s52, 4294672384
s_add_u32 s50, s50, s49
v_mfma_f32_32x32x16_bf16 v[184:199], a[160:163], a[104:107], v[184:199]
ds_read_b64_tr_b16 a[152:153], v14 offset:4096
ds_read_b64_tr_b16 a[154:155], v14 offset:22528
s_add_u32 s50, s50, 313344
s_mul_i32 s51, s52, 36864
s_add_u32 s51, s51, s49
s_add_u32 s51, s51, 129024
s_add_u32 m0, s72, 36864
s_waitcnt lgkmcnt(6)
v_mfma_f32_32x32x16_bf16 v[136:151], a[164:167], a[108:111], v[136:151]
ds_read_b64_tr_b16 a[156:157], v14 offset:5120
ds_read_b64_tr_b16 a[158:159], v14 offset:23552
buffer_load_dwordx4 v2, s[24:27], s50 offen offset:0 lds
buffer_load_dwordx4 a[68:71], v1, s[36:39], s80 offen offset:1024 sc1
v_mfma_f32_32x32x16_bf16 v[136:151], a[168:171], a[112:115], v[136:151]
ds_read_b64_tr_b16 a[160:161], v14 offset:6144
ds_read_b64_tr_b16 a[162:163], v14 offset:24576
s_waitcnt vmcnt(10)
v_cmp_ne_u64 vcc, s[94:95], v[56:57]
s_nop 0
s_cbranch_vccnz SLOW_of
BACK_of:
s_waitcnt lgkmcnt(6)
v_mfma_f32_32x32x16_bf16 v[136:151], a[144:147], a[116:119], v[136:151]
ds_read_b64_tr_b16 a[164:165], v14 offset:7168
ds_read_b64_tr_b16 a[166:167], v14 offset:25600
buffer_load_dwordx4 v[200:203], v33, s[36:39], s46 offen offset:0 sc1
s_add_u32 s46, s46, 262144
v_mfma_f32_32x32x16_bf16 v[136:151], a[148:151], a[120:123], v[136:151]
ds_read_b64_tr_b16 a[168:169], v14 offset:8192
ds_read_b64_tr_b16 a[170:171], v14 offset:26624
buffer_load_dwordx4 v3, s[24:27], s51 offen offset:1024 lds
buffer_load_dwordx4 v[204:207], v33, s[36:39], s46 offen offset:0 sc1
s_add_u32 s46, s46, 262144
s_waitcnt lgkmcnt(6)
v_mfma_f32_32x32x16_bf16 v[136:151], a[152:155], a[124:127], v[136:151]
v_xor_b32 v14, 64, v14
ds_read_b64_tr_b16 a[144:145], v14 offset:0
ds_read_b64_tr_b16 a[146:147], v14 offset:18432
v_mfma_f32_32x32x16_bf16 v[136:151], a[156:159], a[128:131], v[136:151]
ds_read_b64_tr_b16 a[148:149], v14 offset:1024
ds_read_b64_tr_b16 a[150:151], v14 offset:19456
s_waitcnt lgkmcnt(6)
v_mfma_f32_32x32x16_bf16 v[136:151], a[160:163], a[132:135], v[136:151]
ds_read_b64_tr_b16 a[152:153], v14 offset:2048
ds_read_b64_tr_b16 a[154:155], v14 offset:20480
buffer_load_dwordx4 v4, s[24:27], s51 offen offset:2048 lds
buffer_load_dwordx4 v[208:211], v33, s[36:39], s46 offen offset:0 sc1
s_add_u32 s46, s46, 262144
v_mfma_f32_32x32x16_bf16 v[136:151], a[164:167], a[136:139], v[136:151]
ds_read_b64_tr_b16 a[156:157], v14 offset:3072
ds_read_b64_tr_b16 a[158:159], v14 offset:21504
s_waitcnt lgkmcnt(6)
v_mfma_f32_32x32x16_bf16 v[136:151], a[168:171], a[140:143], v[136:151]
ds_read_b64_tr_b16 a[160:161], v14 offset:4096
ds_read_b64_tr_b16 a[162:163], v14 offset:22528
v_mfma_f32_32x32x16_bf16 v[152:167], a[144:147], a[108:111], v[152:167]
ds_read_b64_tr_b16 a[164:165], v14 offset:5120
ds_read_b64_tr_b16 a[166:167], v14 offset:23552
buffer_load_dwordx4 v5, s[24:27], s51 offen offset:3072 lds
buffer_load_dwordx4 v[212:215], v33, s[36:39], s46 offen offset:0 sc1
s_waitcnt lgkmcnt(6)
v_mfma_f32_32x32x16_bf16 v[152:167], a[148:151], a[112:115], v[152:167]
ds_read_b64_tr_b16 a[168:169], v14 offset:6144
ds_read_b64_tr_b16 a[170:171], v14 offset:24576
v_mfma_f32_32x32x16_bf16 v[152:167], a[152:155], a[116:119], v[152:167]
ds_read_b64_tr_b16 a[144:145], v14 offset:7168
ds_read_b64_tr_b16 a[146:147], v14 offset:25600
s_add_u32 m0, s72, 40960
s_waitcnt lgkmcnt(6)
v_mfma_f32_32x32x16_bf16 v[152:167], a[156:159], a[120:123], v[152:167]
ds_read_b64_tr_b16 a[148:149], v14 offset:8192
ds_read_b64_tr_b16 a[150:151], v14 offset:26624
buffer_load_dwordx4 v6, s[24:27], s51 offen offset:0 lds
buffer_load_dwordx4 a[184:187], v33, s[36:39], s87 offen offset:0 sc1
v_bfe_u32 v46, v1, 4, 4
v_mfma_f32_32x32x16_bf16 v[152:167], a[160:163], a[124:127], v[152:167]
v_xor_b32 v14, 192, v14
ds_read_b64_tr_b16 a[152:153], v14 offset:0
ds_read_b64_tr_b16 a[154:155], v14 offset:18432
v_mul_u32_u24 v46, 1152, v46
v_lshl_add_u32 v34, v47, 4, v46
v_lshl_add_u32 v35, v47, 3, v46
s_waitcnt lgkmcnt(6)
v_mfma_f32_32x32x16_bf16 v[152:167], a[164:167], a[128:131], v[152:167]
ds_read_b64_tr_b16 a[156:157], v14 offset:1024
ds_read_b64_tr_b16 a[158:159], v14 offset:19456
v_mov_b32 v46, 2147483648
v_cndmask_b32 v35, v35, v46, s[98:99]
s_lshr_b32 s41, s70, 1
v_mfma_f32_32x32x16_bf16 v[152:167], a[168:171], a[132:135], v[152:167]
ds_read_b64_tr_b16 a[160:161], v14 offset:2048
ds_read_b64_tr_b16 a[162:163], v14 offset:20480
s_lshl1_add_u32 s41, s68, s41
s_lshl2_add_u32 s41, s41, s67
s_waitcnt lgkmcnt(6)
v_mfma_f32_32x32x16_bf16 v[152:167], a[144:147], a[136:139], v[152:167]
ds_read_b64_tr_b16 a[164:165], v14 offset:3072
ds_read_b64_tr_b16 a[166:167], v14 offset:21504
buffer_load_dwordx4 v7, s[24:27], s51 offen offset:1024 lds
buffer_load_dwordx4 a[188:191], v33, s[36:39], s87 offen offset:2048 sc1
s_mul_i32 s41, s41, 18432
v_mfma_f32_32x32x16_bf16 v[152:167], a[148:151], a[140:143], v[152:167]
ds_read_b64_tr_b16 a[168:169], v14 offset:4096
ds_read_b64_tr_b16 a[170:171], v14 offset:22528
s_lshl_b32 s42, s40, 7
s_add_u32 s85, s41, s42
s_lshl4_add_u32 s42, s40, s41
s_add_u32 s42, s42, 1024
s_waitcnt lgkmcnt(6)
v_mfma_f32_32x32x16_bf16 v[168:183], a[152:155], a[108:111], v[168:183]
ds_read_b64_tr_b16 a[144:145], v14 offset:5120
ds_read_b64_tr_b16 a[146:147], v14 offset:23552
s_lshr_b32 s41, s70, 1
s_lshl2_add_u32 s41, s41, s67
s_lshl_b32 s41, s41, 6
v_mfma_f32_32x32x16_bf16 v[168:183], a[156:159], a[112:115], v[168:183]
ds_read_b64_tr_b16 a[148:149], v14 offset:6144
ds_read_b64_tr_b16 a[150:151], v14 offset:24576
buffer_load_dwordx4 v8, s[24:27], s51 offen offset:2048 lds
s_add_u32 s41, s41, 159744
s_waitcnt lgkmcnt(6)
v_mfma_f32_32x32x16_bf16 v[168:183], a[160:163], a[116:119], v[168:183]
ds_read_b64_tr_b16 a[152:153], v14 offset:7168
ds_read_b64_tr_b16 a[154:155], v14 offset:25600
s_add_u32 s87, s87, 4096
buffer_load_dwordx4 a[192:195], v33, s[36:39], s87 offen offset:0 sc1
v_and_b32 v46, 0xf0, v1
v_mfma_f32_32x32x16_bf16 v[168:183], a[164:167], a[120:123], v[168:183]
ds_read_b64_tr_b16 a[156:157], v14 offset:8192
ds_read_b64_tr_b16 a[158:159], v14 offset:26624
v_lshrrev_b32 v46, 2, v46
v_add_u32 v46, s41, v46
ds_read_b32 v40, v46
v_and_b32 v36, 0x3c0, v1
s_waitcnt lgkmcnt(7)
v_mfma_f32_32x32x16_bf16 v[168:183], a[168:171], a[124:127], v[168:183]
v_xor_b32 v14, 64, v14
ds_read_b64_tr_b16 a[160:161], v14 offset:0
ds_read_b64_tr_b16 a[162:163], v14 offset:18432
buffer_load_dwordx4 v9, s[24:27], s51 offen offset:3072 lds
v_lshrrev_b32 v38, 2, v36
v_mfma_f32_32x32x16_bf16 v[168:183], a[144:147], a[128:131], v[168:183]
ds_read_b64_tr_b16 a[164:165], v14 offset:1024
ds_read_b64_tr_b16 a[166:167], v14 offset:19456
v_bfe_u32 v46, v1, 4, 1
v_lshl_add_u32 v36, v46, 3, v36
v_lshl_add_u32 v38, v46, 3, v38
s_waitcnt lgkmcnt(7)
v_mfma_f32_32x32x16_bf16 v[168:183], a[148:151], a[132:135], v[168:183]
ds_read_b64_tr_b16 a[168:169], v14 offset:2048
ds_read_b64_tr_b16 a[170:171], v14 offset:20480
s_add_u32 m0, s72, 45056
v_mfma_f32_32x32x16_bf16 v[168:183], a[152:155], a[136:139], v[168:183]
ds_read_b64_tr_b16 a[144:145], v14 offset:3072
ds_read_b64_tr_b16 a[146:147], v14 offset:21504
buffer_load_dwordx4 v10, s[24:27], s51 offen offset:0 lds
buffer_load_dwordx4 a[196:199], v33, s[36:39], s87 offen offset:2048 sc1
v_and_b32 v46, 32, v1
v_add_u32 v36, v36, v46
s_waitcnt lgkmcnt(6)
v_mfma_f32_32x32x16_bf16 v[168:183], a[156:159], a[140:143], v[168:183]
ds_read_b64_tr_b16 a[148:149], v14 offset:4096
ds_read_b64_tr_b16 a[150:151], v14 offset:22528
v_bfe_u32 v46, v1, 8, 1
v_lshl_add_u32 v36, v46, 4, v36
v_add_u32 v36, 73728, v36
v_mfma_f32_32x32x16_bf16 v[184:199], a[160:163], a[108:111], v[184:199]
ds_read_b64_tr_b16 a[152:153], v14 offset:5120
ds_read_b64_tr_b16 a[154:155], v14 offset:23552
v_xor_b32 v37, 16, v36
v_add_u32 v38, 77824, v38
v_and_b32 v46, 16, v1
v_mov_b32 v44, 0x3f80
s_waitcnt lgkmcnt(6)
v_mfma_f32_32x32x16_bf16 v[184:199], a[164:167], a[112:115], v[184:199]
ds_read_b64_tr_b16 a[156:157], v14 offset:6144
ds_read_b64_tr_b16 a[158:159], v14 offset:24576
v_mfma_f32_32x32x16_bf16 v[184:199], a[168:171], a[116:119], v[184:199]
ds_read_b64_tr_b16 a[160:161], v14 offset:7168
ds_read_b64_tr_b16 a[162:163], v14 offset:25600
s_add_u32 s87, s87, 4096
buffer_load_dwordx4 a[200:203], v33, s[36:39], s87 offen offset:0 sc1
v_lshlrev_b32 v44, v46, v44
v_bfe_i32 v46, v1, 5, 1
s_waitcnt lgkmcnt(6)
v_mfma_f32_32x32x16_bf16 v[184:199], a[144:147], a[120:123], v[184:199]
ds_read_b64_tr_b16 a[164:165], v14 offset:8192
ds_read_b64_tr_b16 a[166:167], v14 offset:26624
s_waitcnt vmcnt(20)
s_barrier
v_and_b32 v45, v44, v46
v_mfma_f32_32x32x16_bf16 v[184:199], a[148:151], a[124:127], v[184:199]
v_add_u32 v14, 0, v25
ds_read_b64_tr_b16 a[168:169], v14 offset:0
ds_read_b64_tr_b16 a[170:171], v14 offset:18432
v_xor_b32 v44, v44, v45
v_mov_b32 v41, v40
v_mul_f32 v42, 0xbfb8aa3b, v40
s_waitcnt lgkmcnt(6)
v_mfma_f32_32x32x16_bf16 v[184:199], a[152:155], a[128:131], v[184:199]
ds_read_b64_tr_b16 a[144:145], v14 offset:1024
ds_read_b64_tr_b16 a[146:147], v14 offset:19456
s_lshl_b32 s50, s71, 1
s_and_b32 s49, s70, 1
s_add_u32 s50, s50, s49
v_mfma_f32_32x32x16_bf16 v[184:199], a[156:159], a[132:135], v[184:199]
ds_read_b64_tr_b16 a[148:149], v14 offset:2048
ds_read_b64_tr_b16 a[150:151], v14 offset:20480
s_mul_i32 s50, s50, 82944
s_add_u32 s50, s50, s72
s_add_u32 s49, s50, 4231168
s_add_u32 m0, s72, 110592
s_waitcnt lgkmcnt(6)
v_mfma_f32_32x32x16_bf16 v[184:199], a[160:163], a[136:139], v[184:199]
ds_read_b64_tr_b16 a[152:153], v14 offset:3072
ds_read_b64_tr_b16 a[154:155], v14 offset:21504
v_mul_f32 v43, 0xbfb8aa3b, v40
s_waitcnt vmcnt(16)
v_mfma_f32_16x16x32_bf16 v[216:219], a[176:179], v[200:203], 0
s_waitcnt vmcnt(14)
v_mfma_f32_16x16x32_bf16 v[216:219], a[176:179], v[204:207], v[216:219]
v_mfma_f32_32x32x16_bf16 v[184:199], a[164:167], a[140:143], v[184:199]
ds_read_b64_tr_b16 a[156:157], v14 offset:4096
ds_read_b64_tr_b16 a[158:159], v14 offset:22528
s_waitcnt vmcnt(12)
v_mfma_f32_16x16x32_bf16 v[216:219], a[176:179], v[208:211], v[216:219]
buffer_load_dwordx4 a[204:207], v33, s[36:39], s87 offen offset:2048 sc1
s_waitcnt vmcnt(11)
v_mfma_f32_16x16x32_bf16 v[216:219], a[176:179], v[212:215], v[216:219]
s_lshl2_add_u32 s41, s68, s71
s_waitcnt lgkmcnt(6)
v_mfma_f32_32x32x16_bf16 v[136:151], a[168:171], a[0:3], v[136:151]
ds_read_b64_tr_b16 a[160:161], v14 offset:5120
ds_read_b64_tr_b16 a[162:163], v14 offset:23552
buffer_load_dwordx4 v1, s[36:39], s49 offen offset:0 sc1 lds
s_lshl2_add_u32 s82, s41, s67
s_lshl_b32 s82, s82, 11
v_mfma_f32_32x32x16_bf16 v[136:151], a[144:147], a[4:7], v[136:151]
ds_read_b64_tr_b16 a[164:165], v14 offset:6144
ds_read_b64_tr_b16 a[166:167], v14 offset:24576
s_lshl_b32 s46, s70, 19
s_add_u32 s82, s82, s46
s_add_u32 s82, s82, 12582912
s_waitcnt lgkmcnt(6)
v_mfma_f32_32x32x16_bf16 v[136:151], a[148:151], a[8:11], v[136:151]
ds_read_b64_tr_b16 a[168:169], v14 offset:7168
ds_read_b64_tr_b16 a[170:171], v14 offset:25600
s_lshl2_add_u32 s41, s41, s45
s_lshl_b32 s86, s41, 11
s_add_u32 s87, s87, 4096
v_mfma_f32_32x32x16_bf16 v[136:151], a[152:155], a[12:15], v[136:151]
ds_read_b64_tr_b16 a[144:145], v14 offset:8192
ds_read_b64_tr_b16 a[146:147], v14 offset:26624
buffer_load_dwordx4 v1, s[36:39], s49 offen offset:1024 sc1 lds
buffer_load_dwordx4 a[208:211], v33, s[36:39], s87 offen offset:0 sc1
s_add_u32 s86, s86, 12582912
s_waitcnt lgkmcnt(6)
v_mfma_f32_32x32x16_bf16 v[136:151], a[156:159], a[16:19], v[136:151]
v_xor_b32 v14, 64, v14
ds_read_b64_tr_b16 a[148:149], v14 offset:0
ds_read_b64_tr_b16 a[150:151], v14 offset:18432
s_lshl_b32 s47, s41, 7
s_add_u32 s47, s47, 65536
v_mfma_f32_32x32x16_bf16 v[136:151], a[160:163], a[20:23], v[136:151]
ds_read_b64_tr_b16 a[152:153], v14 offset:1024
ds_read_b64_tr_b16 a[154:155], v14 offset:19456
v_add_u32 v63, 2097152, v33
v_add_u32 v62, 4194304, v33
s_mov_b32 s74, s94
s_waitcnt lgkmcnt(6)
v_mfma_f32_32x32x16_bf16 v[136:151], a[164:167], a[24:27], v[136:151]
ds_read_b64_tr_b16 a[156:157], v14 offset:2048
ds_read_b64_tr_b16 a[158:159], v14 offset:20480
buffer_load_dwordx4 v1, s[36:39], s49 offen offset:2048 sc1 lds
s_mov_b32 s75, s94
s_lshr_b32 s41, s70, 1
s_lshr_b32 s46, s67, 1
s_cmp_eq_u32 s41, s46
s_cselect_b32 s46, 2147483648, 0
v_mfma_f32_32x32x16_bf16 v[136:151], a[168:171], a[28:31], v[136:151]
ds_read_b64_tr_b16 a[160:161], v14 offset:3072
ds_read_b64_tr_b16 a[162:163], v14 offset:21504
v_or_b32 v58, s46, v1
buffer_load_dwordx4 a[212:215], v33, s[36:39], s87 offen offset:2048 sc1
s_mul_i32 s41, s67, 6144
s_waitcnt lgkmcnt(6)
v_mfma_f32_32x32x16_bf16 v[136:151], a[144:147], a[32:35], v[136:151]
ds_read_b64_tr_b16 a[164:165], v14 offset:4096
ds_read_b64_tr_b16 a[166:167], v14 offset:22528
s_add_u32 s41, s41, 0
v_add_u32 v59, s41, v1
s_mul_i32 s41, s45, 6144
v_mfma_f32_32x32x16_bf16 v[152:167], a[148:151], a[0:3], v[152:167]
ds_read_b64_tr_b16 a[168:169], v14 offset:5120
ds_read_b64_tr_b16 a[170:171], v14 offset:23552
buffer_load_dwordx4 v1, s[36:39], s49 offen offset:3072 sc1 lds
s_add_u32 s41, s41, 0
v_add_u32 v60, s41, v33
v_bfe_u32 v61, v1, 4, 1
s_waitcnt lgkmcnt(6)
v_mfma_f32_32x32x16_bf16 v[152:167], a[152:155], a[4:7], v[152:167]
ds_read_b64_tr_b16 a[144:145], v14 offset:6144
ds_read_b64_tr_b16 a[146:147], v14 offset:24576
v_lshl_or_b32 v61, v61, 1, 1
v_xor_b32 v61, s70, v61
s_add_u32 s87, s87, 4096
v_mfma_f32_32x32x16_bf16 v[152:167], a[156:159], a[8:11], v[152:167]
ds_read_b64_tr_b16 a[148:149], v14 offset:7168
ds_read_b64_tr_b16 a[150:151], v14 offset:25600
s_add_u32 s49, s50, 4235264
s_add_u32 m0, s72, 114688
buffer_load_dwordx4 a[216:219], v33, s[36:39], s87 offen offset:0 sc1
v_lshlrev_b32 v61, 3, v61
s_waitcnt lgkmcnt(6)
v_mfma_f32_32x32x16_bf16 v[152:167], a[160:163], a[12:15], v[152:167]
ds_read_b64_tr_b16 a[152:153], v14 offset:8192
ds_read_b64_tr_b16 a[154:155], v14 offset:26624
s_waitcnt vmcnt(10)
s_barrier
buffer_load_dwordx4 v1, s[36:39], s49 offen offset:0 sc1 lds
v_mfma_f32_32x32x16_bf16 v[152:167], a[164:167], a[16:19], v[152:167]
v_xor_b32 v14, 64, v14
ds_read_b64_tr_b16 a[156:157], v14 offset:36864
ds_read_b64_tr_b16 a[158:159], v14 offset:55296
s_xor_b32 s41, s70, 1
s_lshl_b32 s41, s41, 19
s_add_u32 s90, s86, s41
s_waitcnt lgkmcnt(6)
v_mfma_f32_32x32x16_bf16 v[152:167], a[168:171], a[20:23], v[152:167]
ds_read_b64_tr_b16 a[160:161], v14 offset:37888
ds_read_b64_tr_b16 a[162:163], v14 offset:56320
s_xor_b32 s41, s70, 3
s_lshl_b32 s41, s41, 19
s_add_u32 s91, s86, s41
v_mfma_f32_32x32x16_bf16 v[152:167], a[144:147], a[24:27], v[152:167]
ds_read_b64_tr_b16 a[164:165], v14 offset:38912
ds_read_b64_tr_b16 a[166:167], v14 offset:57344
s_xor_b32 s41, s70, 10
s_lshl_b32 s41, s41, 19
s_add_u32 s92, s86, s41
buffer_load_dwordx4 a[220:223], v33, s[36:39], s87 offen offset:2048 sc1
s_waitcnt lgkmcnt(6)
v_mfma_f32_32x32x16_bf16 v[152:167], a[148:151], a[28:31], v[152:167]
ds_read_b64_tr_b16 a[168:169], v14 offset:39936
ds_read_b64_tr_b16 a[170:171], v14 offset:58368
buffer_load_dwordx4 v1, s[36:39], s49 offen offset:1024 sc1 lds
v_mfma_f32_32x32x16_bf16 v[152:167], a[152:155], a[32:35], v[152:167]
ds_read_b64_tr_b16 a[144:145], v14 offset:40960
ds_read_b64_tr_b16 a[146:147], v14 offset:59392
s_waitcnt lgkmcnt(6)
v_mfma_f32_32x32x16_bf16 v[136:151], a[156:159], a[36:39], v[136:151]
ds_read_b64_tr_b16 a[148:149], v14 offset:41984
ds_read_b64_tr_b16 a[150:151], v14 offset:60416
v_mfma_f32_32x32x16_bf16 v[136:151], a[160:163], a[40:43], v[136:151]
ds_read_b64_tr_b16 a[152:153], v14 offset:43008
ds_read_b64_tr_b16 a[154:155], v14 offset:61440
buffer_load_dwordx4 v1, s[36:39], s49 offen offset:2048 sc1 lds
s_add_u32 s87, s87, 4096
buffer_load_dwordx4 a[224:227], v33, s[36:39], s87 offen offset:0 sc1
s_waitcnt lgkmcnt(6)
v_mfma_f32_32x32x16_bf16 v[136:151], a[164:167], a[44:47], v[136:151]
ds_read_b64_tr_b16 a[156:157], v14 offset:44032
ds_read_b64_tr_b16 a[158:159], v14 offset:62464
v_mfma_f32_32x32x16_bf16 v[136:151], a[168:171], a[48:51], v[136:151]
ds_read_b64_tr_b16 a[160:161], v14 offset:45056
ds_read_b64_tr_b16 a[162:163], v14 offset:63488
s_waitcnt lgkmcnt(6)
v_mfma_f32_32x32x16_bf16 v[136:151], a[144:147], a[52:55], v[136:151]
v_xor_b32 v14, 64, v14
ds_read_b64_tr_b16 a[164:165], v14 offset:36864
ds_read_b64_tr_b16 a[166:167], v14 offset:55296
buffer_load_dwordx4 v1, s[36:39], s49 offen offset:3072 sc1 lds
v_mfma_f32_32x32x16_bf16 v[136:151], a[148:151], a[56:59], v[136:151]
ds_read_b64_tr_b16 a[168:169], v14 offset:37888
ds_read_b64_tr_b16 a[170:171], v14 offset:56320
buffer_load_dwordx4 a[228:231], v33, s[36:39], s87 offen offset:2048 sc1
s_waitcnt lgkmcnt(6)
v_mfma_f32_32x32x16_bf16 v[136:151], a[152:155], a[60:63], v[136:151]
ds_read_b64_tr_b16 a[144:145], v14 offset:38912
ds_read_b64_tr_b16 a[146:147], v14 offset:57344
s_add_u32 s49, s50, 4239360
s_add_u32 m0, s72, 118784
v_mfma_f32_32x32x16_bf16 v[136:151], a[156:159], a[64:67], v[136:151]
ds_read_b64_tr_b16 a[148:149], v14 offset:39936
ds_read_b64_tr_b16 a[150:151], v14 offset:58368
buffer_load_dwordx4 v1, s[36:39], s49 offen offset:0 sc1 lds
s_waitcnt lgkmcnt(6)
v_mfma_f32_32x32x16_bf16 v[136:151], a[160:163], a[68:71], v[136:151]
ds_read_b64_tr_b16 a[152:153], v14 offset:40960
ds_read_b64_tr_b16 a[154:155], v14 offset:59392
v_mfma_f32_32x32x16_bf16 v[152:167], a[164:167], a[36:39], v[152:167]
ds_read_b64_tr_b16 a[156:157], v14 offset:41984
ds_read_b64_tr_b16 a[158:159], v14 offset:60416
s_waitcnt lgkmcnt(6)
v_mfma_f32_32x32x16_bf16 v[152:167], a[168:171], a[40:43], v[152:167]
ds_read_b64_tr_b16 a[160:161], v14 offset:43008
ds_read_b64_tr_b16 a[162:163], v14 offset:61440
s_add_u32 s87, s87, 4096
buffer_load_dwordx4 a[232:235], v33, s[36:39], s87 offen offset:0 sc1
v_mfma_f32_32x32x16_bf16 v[152:167], a[144:147], a[44:47], v[152:167]
ds_read_b64_tr_b16 a[164:165], v14 offset:44032
ds_read_b64_tr_b16 a[166:167], v14 offset:62464
v_cvt_pk_bf16_f32 v136, v136, v137
v_cvt_pk_bf16_f32 v137, v138, v139
v_cvt_pk_bf16_f32 v138, v140, v141
v_cvt_pk_bf16_f32 v139, v142, v143
s_waitcnt lgkmcnt(6)
v_mfma_f32_32x32x16_bf16 v[152:167], a[148:151], a[48:51], v[152:167]
ds_read_b64_tr_b16 a[168:169], v14 offset:45056
ds_read_b64_tr_b16 a[170:171], v14 offset:63488
v_cvt_pk_bf16_f32 v140, v144, v145
v_cvt_pk_bf16_f32 v141, v146, v147
v_cvt_pk_bf16_f32 v142, v148, v149
v_mfma_f32_32x32x16_bf16 v[152:167], a[152:155], a[52:55], v[152:167]
v_xor_b32 v14, 192, v14
ds_read_b64_tr_b16 a[144:145], v14 offset:0
ds_read_b64_tr_b16 a[146:147], v14 offset:18432
v_cvt_pk_bf16_f32 v143, v150, v151
buffer_store_dwordx4 v[136:139], v1, s[36:39], s82 offen offset:0 sc1
buffer_store_dwordx4 v[140:143], v1, s[36:39], s82 offen offset:1024 sc1
s_waitcnt lgkmcnt(6)
v_mfma_f32_32x32x16_bf16 v[152:167], a[156:159], a[56:59], v[152:167]
ds_read_b64_tr_b16 a[148:149], v14 offset:1024
ds_read_b64_tr_b16 a[150:151], v14 offset:19456
buffer_load_dwordx4 a[236:239], v33, s[36:39], s87 offen offset:2048 sc1
v_mfma_f32_32x32x16_bf16 v[152:167], a[160:163], a[60:63], v[152:167]
ds_read_b64_tr_b16 a[152:153], v14 offset:2048
ds_read_b64_tr_b16 a[154:155], v14 offset:20480
s_waitcnt lgkmcnt(6)
v_mfma_f32_32x32x16_bf16 v[152:167], a[164:167], a[64:67], v[152:167]
ds_read_b64_tr_b16 a[156:157], v14 offset:3072
ds_read_b64_tr_b16 a[158:159], v14 offset:21504
v_mfma_f32_32x32x16_bf16 v[152:167], a[168:171], a[68:71], v[152:167]
ds_read_b64_tr_b16 a[160:161], v14 offset:4096
ds_read_b64_tr_b16 a[162:163], v14 offset:22528
s_waitcnt lgkmcnt(6)
v_mfma_f32_32x32x16_bf16 v[168:183], a[144:147], a[0:3], v[168:183]
ds_read_b64_tr_b16 a[164:165], v14 offset:5120
ds_read_b64_tr_b16 a[166:167], v14 offset:23552
s_add_u32 s87, s87, 4096
buffer_load_dwordx4 a[240:243], v33, s[36:39], s87 offen offset:0 sc1
v_mfma_f32_32x32x16_bf16 v[168:183], a[148:151], a[4:7], v[168:183]
ds_read_b64_tr_b16 a[168:169], v14 offset:6144
ds_read_b64_tr_b16 a[170:171], v14 offset:24576
s_waitcnt lgkmcnt(6)
v_mfma_f32_32x32x16_bf16 v[168:183], a[152:155], a[8:11], v[168:183]
ds_read_b64_tr_b16 a[144:145], v14 offset:7168
ds_read_b64_tr_b16 a[146:147], v14 offset:25600
v_cvt_pk_bf16_f32 v152, v152, v153
v_cvt_pk_bf16_f32 v153, v154, v155
v_cvt_pk_bf16_f32 v154, v156, v157
v_mfma_f32_32x32x16_bf16 v[168:183], a[156:159], a[12:15], v[168:183]
ds_read_b64_tr_b16 a[148:149], v14 offset:8192
ds_read_b64_tr_b16 a[150:151], v14 offset:26624
v_cvt_pk_bf16_f32 v155, v158, v159
v_cvt_pk_bf16_f32 v156, v160, v161
v_cvt_pk_bf16_f32 v157, v162, v163
v_cvt_pk_bf16_f32 v158, v164, v165
s_waitcnt lgkmcnt(6)
v_mfma_f32_32x32x16_bf16 v[168:183], a[160:163], a[16:19], v[168:183]
v_xor_b32 v14, 64, v14
ds_read_b64_tr_b16 a[152:153], v14 offset:0
ds_read_b64_tr_b16 a[154:155], v14 offset:18432
v_cvt_pk_bf16_f32 v159, v166, v167
s_add_u32 s82, s82, 2097152
buffer_store_dwordx4 v[152:155], v1, s[36:39], s82 offen offset:0 sc1
v_mfma_f32_32x32x16_bf16 v[168:183], a[164:167], a[20:23], v[168:183]
ds_read_b64_tr_b16 a[156:157], v14 offset:1024
ds_read_b64_tr_b16 a[158:159], v14 offset:19456
buffer_store_dwordx4 v[156:159], v1, s[36:39], s82 offen offset:1024 sc1
buffer_load_dwordx4 a[244:247], v33, s[36:39], s87 offen offset:2048 sc1
s_waitcnt lgkmcnt(6)
v_mfma_f32_32x32x16_bf16 v[168:183], a[168:171], a[24:27], v[168:183]
ds_read_b64_tr_b16 a[160:161], v14 offset:2048
ds_read_b64_tr_b16 a[162:163], v14 offset:20480
v_mfma_f32_32x32x16_bf16 v[168:183], a[144:147], a[28:31], v[168:183]
ds_read_b64_tr_b16 a[164:165], v14 offset:3072
ds_read_b64_tr_b16 a[166:167], v14 offset:21504
buffer_load_dwordx4 v[48:51], v34, s[4:7], s85 offen offset:0
s_waitcnt lgkmcnt(6)
v_mfma_f32_32x32x16_bf16 v[168:183], a[148:151], a[32:35], v[168:183]
ds_read_b64_tr_b16 a[168:169], v14 offset:4096
ds_read_b64_tr_b16 a[170:171], v14 offset:22528
v_mfma_f32_32x32x16_bf16 v[184:199], a[152:155], a[0:3], v[184:199]
ds_read_b64_tr_b16 a[144:145], v14 offset:5120
ds_read_b64_tr_b16 a[146:147], v14 offset:23552
buffer_load_dwordx4 a[248:251], v33, s[36:39], s48 offen offset:0 sc1
s_waitcnt lgkmcnt(6)
v_mfma_f32_32x32x16_bf16 v[184:199], a[156:159], a[4:7], v[184:199]
ds_read_b64_tr_b16 a[148:149], v14 offset:6144
ds_read_b64_tr_b16 a[150:151], v14 offset:24576
v_mfma_f32_32x32x16_bf16 v[184:199], a[160:163], a[8:11], v[184:199]
ds_read_b64_tr_b16 a[152:153], v14 offset:7168
ds_read_b64_tr_b16 a[154:155], v14 offset:25600
buffer_load_dwordx4 v[52:55], v34, s[4:7], s85 offen offset:64
s_waitcnt lgkmcnt(6)
v_mfma_f32_32x32x16_bf16 v[184:199], a[164:167], a[12:15], v[184:199]
ds_read_b64_tr_b16 a[156:157], v14 offset:8192
ds_read_b64_tr_b16 a[158:159], v14 offset:26624
v_mfma_f32_32x32x16_bf16 v[184:199], a[168:171], a[16:19], v[184:199]
v_xor_b32 v14, 64, v14
ds_read_b64_tr_b16 a[160:161], v14 offset:36864
ds_read_b64_tr_b16 a[162:163], v14 offset:55296
buffer_load_dwordx4 a[252:255], v33, s[36:39], s48 offen offset:2048 sc1
s_waitcnt lgkmcnt(6)
v_mfma_f32_32x32x16_bf16 v[184:199], a[144:147], a[20:23], v[184:199]
ds_read_b64_tr_b16 a[164:165], v14 offset:37888
ds_read_b64_tr_b16 a[166:167], v14 offset:56320
v_mfma_f32_32x32x16_bf16 v[184:199], a[148:151], a[24:27], v[184:199]
ds_read_b64_tr_b16 a[168:169], v14 offset:38912
ds_read_b64_tr_b16 a[170:171], v14 offset:57344
buffer_load_dwordx2 v[56:57], v35, s[4:7], s42 offen
s_waitcnt lgkmcnt(6)
v_mfma_f32_32x32x16_bf16 v[184:199], a[152:155], a[28:31], v[184:199]
ds_read_b64_tr_b16 a[144:145], v14 offset:39936
ds_read_b64_tr_b16 a[146:147], v14 offset:58368
v_mfma_f32_32x32x16_bf16 v[184:199], a[156:159], a[32:35], v[184:199]
ds_read_b64_tr_b16 a[148:149], v14 offset:40960
ds_read_b64_tr_b16 a[150:151], v14 offset:59392
s_waitcnt lgkmcnt(6)
v_mfma_f32_32x32x16_bf16 v[168:183], a[160:163], a[36:39], v[168:183]
ds_read_b64_tr_b16 a[152:153], v14 offset:41984
ds_read_b64_tr_b16 a[154:155], v14 offset:60416
v_mfma_f32_32x32x16_bf16 v[168:183], a[164:167], a[40:43], v[168:183]
ds_read_b64_tr_b16 a[156:157], v14 offset:43008
ds_read_b64_tr_b16 a[158:159], v14 offset:61440
s_waitcnt lgkmcnt(6)
v_mfma_f32_32x32x16_bf16 v[168:183], a[168:171], a[44:47], v[168:183]
ds_read_b64_tr_b16 a[160:161], v14 offset:44032
ds_read_b64_tr_b16 a[162:163], v14 offset:62464
v_mfma_f32_32x32x16_bf16 v[168:183], a[144:147], a[48:51], v[168:183]
ds_read_b64_tr_b16 a[164:165], v14 offset:45056
ds_read_b64_tr_b16 a[166:167], v14 offset:63488
s_waitcnt lgkmcnt(6)
v_mfma_f32_32x32x16_bf16 v[168:183], a[148:151], a[52:55], v[168:183]
v_xor_b32 v14, 64, v14
ds_read_b64_tr_b16 a[168:169], v14 offset:36864
ds_read_b64_tr_b16 a[170:171], v14 offset:55296
v_mfma_f32_32x32x16_bf16 v[168:183], a[152:155], a[56:59], v[168:183]
ds_read_b64_tr_b16 a[144:145], v14 offset:37888
ds_read_b64_tr_b16 a[146:147], v14 offset:56320
s_waitcnt lgkmcnt(6)
v_mfma_f32_32x32x16_bf16 v[168:183], a[156:159], a[60:63], v[168:183]
ds_read_b64_tr_b16 a[148:149], v14 offset:38912
ds_read_b64_tr_b16 a[150:151], v14 offset:57344
v_mfma_f32_32x32x16_bf16 v[168:183], a[160:163], a[64:67], v[168:183]
ds_read_b64_tr_b16 a[152:153], v14 offset:39936
ds_read_b64_tr_b16 a[154:155], v14 offset:58368
s_waitcnt lgkmcnt(6)
v_mfma_f32_32x32x16_bf16 v[168:183], a[164:167], a[68:71], v[168:183]
ds_read_b64_tr_b16 a[156:157], v14 offset:40960
ds_read_b64_tr_b16 a[158:159], v14 offset:59392
v_mfma_f32_32x32x16_bf16 v[184:199], a[168:171], a[36:39], v[184:199]
ds_read_b64_tr_b16 a[160:161], v14 offset:41984
ds_read_b64_tr_b16 a[162:163], v14 offset:60416
s_waitcnt lgkmcnt(6)
v_mfma_f32_32x32x16_bf16 v[184:199], a[144:147], a[40:43], v[184:199]
ds_read_b64_tr_b16 a[164:165], v14 offset:43008
ds_read_b64_tr_b16 a[166:167], v14 offset:61440
v_mfma_f32_32x32x16_bf16 v[184:199], a[148:151], a[44:47], v[184:199]
ds_read_b64_tr_b16 a[168:169], v14 offset:44032
ds_read_b64_tr_b16 a[170:171], v14 offset:62464
s_add_u32 s82, s82, 2097152
v_cvt_pk_bf16_f32 v168, v168, v169
v_cvt_pk_bf16_f32 v169, v170, v171
v_cvt_pk_bf16_f32 v170, v172, v173
s_waitcnt lgkmcnt(6)
v_mfma_f32_32x32x16_bf16 v[184:199], a[152:155], a[48:51], v[184:199]
ds_read_b64_tr_b16 a[144:145], v14 offset:45056
ds_read_b64_tr_b16 a[146:147], v14 offset:63488
s_waitcnt vmcnt(13)
s_barrier
v_mov_b32 v171, s94
v_mfma_f32_32x32x16_bf16 v[184:199], a[156:159], a[52:55], v[184:199]
ds_read_b64_tr_b16 a[72:73], v36 offset:0
ds_read_b64_tr_b16 a[74:75], v36 offset:1024
buffer_store_dwordx4 v[168:171], v58, s[36:39], s82 offen offset:0 sc1
v_cvt_pk_bf16_f32 v172, v176, v177
v_cvt_pk_bf16_f32 v173, v178, v179
v_cvt_pk_bf16_f32 v178, v174, v175
v_cvt_pk_bf16_f32 v174, v180, v181
s_waitcnt lgkmcnt(6)
v_mfma_f32_32x32x16_bf16 v[184:199], a[160:163], a[56:59], v[184:199]
ds_read_b64_tr_b16 a[76:77], v37 offset:0
ds_read_b64_tr_b16 a[78:79], v37 offset:1024
ds_read_b64_tr_b16 a[80:81], v36 offset:2048
ds_read_b64_tr_b16 a[82:83], v36 offset:3072
v_mov_b32 v175, s94
buffer_store_dwordx4 v[172:175], v58, s[36:39], s82 offen offset:1024 sc1
v_mfma_f32_32x32x16_bf16 v[184:199], a[164:167], a[60:63], v[184:199]
ds_read_b64_tr_b16 a[84:85], v37 offset:2048
ds_read_b64_tr_b16 a[86:87], v37 offset:3072
v_cvt_pk_bf16_f32 v182, v182, v183
v_mov_b32 v179, s94
v_mov_b32 v183, s94
ds_write_b128 v59, v[168:171] offset:0
ds_write_b128 v59, v[172:175] offset:1024
s_waitcnt lgkmcnt(10)
v_mfma_f32_32x32x16_bf16 v[184:199], a[168:171], a[64:67], v[184:199]
ds_read_b64_tr_b16 a[88:89], v38 offset:0
ds_read_b64_tr_b16 a[90:91], v38 offset:256
ds_read_b64_tr_b16 a[92:93], v36 offset:4608
ds_read_b64_tr_b16 a[94:95], v36 offset:5632
v_mfma_f32_32x32x16_bf16 v[184:199], a[144:147], a[68:71], v[184:199]
ds_read_b64_tr_b16 a[96:97], v37 offset:4608
ds_read_b64_tr_b16 a[98:99], v37 offset:5632
ds_read_b64_tr_b16 a[100:101], v36 offset:6656
ds_read_b64_tr_b16 a[102:103], v36 offset:7680
s_waitcnt lgkmcnt(12)
v_mfma_f32_16x16x32_bf16 v[84:87], a[72:75], a[184:187], 0
ds_read_b64_tr_b16 a[104:105], v37 offset:6656
ds_read_b64_tr_b16 a[106:107], v37 offset:7680
s_waitcnt vmcnt(8)
buffer_store_dwordx2 a[180:181], v15, s[36:39], s77 offen sc1
v_mfma_f32_16x16x32_bf16 v[88:91], a[76:79], a[184:187], 0
ds_read_b64_tr_b16 a[108:109], v38 offset:4608
ds_read_b64_tr_b16 a[110:111], v38 offset:4864
s_add_u32 s82, s82, 2097152
v_cvt_pk_bf16_f32 v176, v184, v185
v_cvt_pk_bf16_f32 v177, v186, v187
v_cvt_pk_bf16_f32 v180, v192, v193
v_mfma_f32_16x16x32_bf16 v[92:95], a[80:83], a[184:187], 0
ds_read_b64_tr_b16 a[112:113], v36 offset:9216
ds_read_b64_tr_b16 a[114:115], v36 offset:10240
v_cvt_pk_bf16_f32 v181, v194, v195
buffer_store_dwordx4 v[176:179], v58, s[36:39], s82 offen offset:0 sc1
buffer_store_dwordx4 v[180:183], v58, s[36:39], s82 offen offset:1024 sc1
v_cvt_pk_bf16_f32 v184, v188, v189
s_waitcnt lgkmcnt(10)
v_mfma_f32_16x16x32_bf16 v[96:99], a[84:87], a[184:187], 0
ds_read_b64_tr_b16 a[116:117], v37 offset:9216
ds_read_b64_tr_b16 a[118:119], v37 offset:10240
v_cvt_pk_bf16_f32 v185, v190, v191
v_mov_b32 v187, s94
v_cvt_pk_bf16_f32 v188, v196, v197
v_cvt_pk_bf16_f32 v189, v198, v199
v_mfma_f32_16x16x32_bf16 v[100:103], a[88:91], a[184:187], 0
ds_read_b64_tr_b16 a[120:121], v36 offset:11264
ds_read_b64_tr_b16 a[122:123], v36 offset:12288
v_mov_b32 v191, s94
s_add_u32 s82, s82, 2097152
buffer_store_dwordx4 v[184:187], v58, s[36:39], s82 offen offset:0 sc1
buffer_store_dwordx4 v[188:191], v58, s[36:39], s82 offen offset:1024 sc1
v_mfma_f32_16x16x32_bf16 v[84:87], a[92:95], a[188:191], v[84:87]
ds_read_b64_tr_b16 a[124:125], v37 offset:11264
ds_read_b64_tr_b16 a[126:127], v37 offset:12288
ds_write_b128 v59, v[176:179] offset:2048
ds_write_b128 v59, v[180:183] offset:3072
ds_write_b128 v59, v[184:187] offset:4096
ds_write_b128 v59, v[188:191] offset:5120
s_waitcnt lgkmcnt(14)
v_mfma_f32_16x16x32_bf16 v[88:91], a[96:99], a[188:191], v[88:91]
ds_read_b64_tr_b16 a[128:129], v38 offset:9216
ds_read_b64_tr_b16 a[130:131], v38 offset:9472
buffer_load_dwordx2 v[222:223], v61, s[36:39], s47 offen sc1
v_mfma_f32_16x16x32_bf16 v[92:95], a[100:103], a[188:191], v[92:95]
ds_read_b64_tr_b16 a[132:133], v36 offset:13824
ds_read_b64_tr_b16 a[134:135], v36 offset:14848
v_mfma_f32_16x16x32_bf16 v[96:99], a[104:107], a[188:191], v[96:99]
ds_read_b64_tr_b16 a[136:137], v37 offset:13824
ds_read_b64_tr_b16 a[138:139], v37 offset:14848
s_waitcnt lgkmcnt(14)
v_mfma_f32_16x16x32_bf16 v[100:103], a[108:111], a[188:191], v[100:103]
ds_read_b64_tr_b16 a[140:141], v36 offset:15872
ds_read_b64_tr_b16 a[142:143], v36 offset:16896
s_waitcnt lgkmcnt(8)
s_barrier
ds_read_b128 v[244:247], v60 offset:0
ds_read_b128 v[248:251], v60 offset:2048
ds_read_b128 v[252:255], v60 offset:4096
v_mfma_f32_16x16x32_bf16 v[84:87], a[112:115], a[192:195], v[84:87]
ds_read_b64_tr_b16 a[72:73], v37 offset:15872
ds_read_b64_tr_b16 a[74:75], v37 offset:16896
v_mfma_f32_16x16x32_bf16 v[88:91], a[116:119], a[192:195], v[88:91]
ds_read_b64_tr_b16 a[76:77], v38 offset:13824
ds_read_b64_tr_b16 a[78:79], v38 offset:14080
s_waitcnt lgkmcnt(13)
v_mfma_f32_16x16x32_bf16 v[92:95], a[120:123], a[192:195], v[92:95]
ds_read_b64_tr_b16 a[80:81], v36 offset:18432
ds_read_b64_tr_b16 a[82:83], v36 offset:19456
v_mfma_f32_16x16x32_bf16 v[96:99], a[124:127], a[192:195], v[96:99]
ds_read_b64_tr_b16 a[84:85], v37 offset:18432
ds_read_b64_tr_b16 a[86:87], v37 offset:19456
v_mfma_f32_16x16x32_bf16 v[100:103], a[128:131], a[192:195], v[100:103]
ds_read_b64_tr_b16 a[88:89], v36 offset:20480
ds_read_b64_tr_b16 a[90:91], v36 offset:21504
s_waitcnt vmcnt(12)
v_permlane16_swap_b32 v48, v50
v_permlane16_swap_b32 v49, v51
s_waitcnt lgkmcnt(13)
v_mfma_f32_16x16x32_bf16 v[84:87], a[132:135], a[196:199], v[84:87]
ds_read_b64_tr_b16 a[92:93], v37 offset:20480
ds_read_b64_tr_b16 a[94:95], v37 offset:21504
s_waitcnt vmcnt(10)
v_permlane16_swap_b32 v52, v54
v_permlane16_swap_b32 v53, v55
v_mfma_f32_16x16x32_bf16 v[88:91], a[136:139], a[196:199], v[88:91]
ds_read_b64_tr_b16 a[96:97], v38 offset:18432
ds_read_b64_tr_b16 a[98:99], v38 offset:18688
v_lshlrev_b32 v64, 16, v48
v_and_b32 v65, 0xffff0000, v48
v_mfma_f32_16x16x32_bf16 v[92:95], a[140:143], a[196:199], v[92:95]
ds_read_b64_tr_b16 a[100:101], v36 offset:23040
ds_read_b64_tr_b16 a[102:103], v36 offset:24064
v_lshlrev_b32 v66, 16, v49
v_and_b32 v67, 0xffff0000, v49
s_waitcnt lgkmcnt(10)
v_mfma_f32_16x16x32_bf16 v[96:99], a[72:75], a[196:199], v[96:99]
ds_read_b64_tr_b16 a[104:105], v37 offset:23040
ds_read_b64_tr_b16 a[106:107], v37 offset:24064
v_lshlrev_b32 v68, 16, v50
v_and_b32 v69, 0xffff0000, v50
v_mfma_f32_16x16x32_bf16 v[100:103], a[76:79], a[196:199], v[100:103]
ds_read_b64_tr_b16 a[108:109], v36 offset:25088
ds_read_b64_tr_b16 a[110:111], v36 offset:26112
v_lshlrev_b32 v70, 16, v51
v_and_b32 v71, 0xffff0000, v51
v_mfma_f32_16x16x32_bf16 v[84:87], a[80:83], a[200:203], v[84:87]
ds_read_b64_tr_b16 a[112:113], v37 offset:25088
ds_read_b64_tr_b16 a[114:115], v37 offset:26112
v_lshlrev_b32 v72, 16, v52
v_and_b32 v73, 0xffff0000, v52
s_waitcnt lgkmcnt(10)
v_mfma_f32_16x16x32_bf16 v[88:91], a[84:87], a[200:203], v[88:91]
ds_read_b64_tr_b16 a[116:117], v38 offset:23040
ds_read_b64_tr_b16 a[118:119], v38 offset:23296
v_lshlrev_b32 v74, 16, v53
v_and_b32 v75, 0xffff0000, v53
v_mov_b32 v247, v250
v_mfma_f32_16x16x32_bf16 v[92:95], a[88:91], a[200:203], v[92:95]
ds_read_b64_tr_b16 a[120:121], v36 offset:27648
ds_read_b64_tr_b16 a[122:123], v36 offset:28672
v_lshlrev_b32 v76, 16, v54
v_and_b32 v77, 0xffff0000, v54
v_mfma_f32_16x16x32_bf16 v[96:99], a[92:95], a[200:203], v[96:99]
ds_read_b64_tr_b16 a[124:125], v37 offset:27648
ds_read_b64_tr_b16 a[126:127], v37 offset:28672
v_lshlrev_b32 v78, 16, v55
v_and_b32 v79, 0xffff0000, v55
s_waitcnt lgkmcnt(10)
v_mfma_f32_16x16x32_bf16 v[100:103], a[96:99], a[200:203], v[100:103]
ds_read_b64_tr_b16 a[128:129], v36 offset:29696
ds_read_b64_tr_b16 a[130:131], v36 offset:30720
s_waitcnt vmcnt(8)
v_lshlrev_b32 v80, 16, v56
v_and_b32 v81, 0xffff0000, v56
v_mfma_f32_16x16x32_bf16 v[84:87], a[100:103], a[204:207], v[84:87]
ds_read_b64_tr_b16 a[132:133], v37 offset:29696
ds_read_b64_tr_b16 a[134:135], v37 offset:30720
v_lshlrev_b32 v82, 16, v57
v_and_b32 v83, 0xffff0000, v57
v_mfma_f32_16x16x32_bf16 v[88:91], a[104:107], a[204:207], v[88:91]
ds_read_b64_tr_b16 a[136:137], v38 offset:27648
ds_read_b64_tr_b16 a[138:139], v38 offset:27904
s_waitcnt lgkmcnt(10)
v_mfma_f32_16x16x32_bf16 v[92:95], a[108:111], a[204:207], v[92:95]
ds_read_b64_tr_b16 a[140:141], v36 offset:32256
ds_read_b64_tr_b16 a[142:143], v36 offset:33280
v_mfma_f32_16x16x32_bf16 v[96:99], a[112:115], a[204:207], v[96:99]
ds_read_b64_tr_b16 a[72:73], v37 offset:32256
ds_read_b64_tr_b16 a[74:75], v37 offset:33280
v_mfma_f32_16x16x32_bf16 v[100:103], a[116:119], a[204:207], v[100:103]
ds_read_b64_tr_b16 a[76:77], v36 offset:34304
ds_read_b64_tr_b16 a[78:79], v36 offset:35328
s_waitcnt lgkmcnt(10)
v_mfma_f32_16x16x32_bf16 v[84:87], a[120:123], a[208:211], v[84:87]
ds_read_b64_tr_b16 a[80:81], v37 offset:34304
ds_read_b64_tr_b16 a[82:83], v37 offset:35328
v_mfma_f32_16x16x32_bf16 v[88:91], a[124:127], a[208:211], v[88:91]
ds_read_b64_tr_b16 a[84:85], v38 offset:32256
ds_read_b64_tr_b16 a[86:87], v38 offset:32512
v_mfma_f32_16x16x32_bf16 v[92:95], a[128:131], a[208:211], v[92:95]
v_add_u32 v36, 36864, v36
v_add_u32 v37, 36864, v37
v_add_u32 v38, 36864, v38
ds_read_b64_tr_b16 a[88:89], v36 offset:0
ds_read_b64_tr_b16 a[90:91], v36 offset:1024
s_waitcnt lgkmcnt(10)
v_mfma_f32_16x16x32_bf16 v[96:99], a[132:135], a[208:211], v[96:99]
ds_read_b64_tr_b16 a[92:93], v37 offset:0
ds_read_b64_tr_b16 a[94:95], v37 offset:1024
v_mfma_f32_16x16x32_bf16 v[100:103], a[136:139], a[208:211], v[100:103]
ds_read_b64_tr_b16 a[96:97], v36 offset:2048
ds_read_b64_tr_b16 a[98:99], v36 offset:3072
v_mfma_f32_16x16x32_bf16 v[84:87], a[140:143], a[212:215], v[84:87]
ds_read_b64_tr_b16 a[100:101], v37 offset:2048
ds_read_b64_tr_b16 a[102:103], v37 offset:3072
s_waitcnt lgkmcnt(10)
v_mfma_f32_16x16x32_bf16 v[88:91], a[72:75], a[212:215], v[88:91]
ds_read_b64_tr_b16 a[104:105], v38 offset:0
ds_read_b64_tr_b16 a[106:107], v38 offset:256
v_mfma_f32_16x16x32_bf16 v[92:95], a[76:79], a[212:215], v[92:95]
ds_read_b64_tr_b16 a[108:109], v36 offset:4608
ds_read_b64_tr_b16 a[110:111], v36 offset:5632
v_mfma_f32_16x16x32_bf16 v[96:99], a[80:83], a[212:215], v[96:99]
ds_read_b64_tr_b16 a[112:113], v37 offset:4608
ds_read_b64_tr_b16 a[114:115], v37 offset:5632
s_waitcnt lgkmcnt(10)
v_mfma_f32_16x16x32_bf16 v[100:103], a[84:87], a[212:215], v[100:103]
ds_read_b64_tr_b16 a[116:117], v36 offset:6656
ds_read_b64_tr_b16 a[118:119], v36 offset:7680
v_mfma_f32_16x16x32_bf16 v[84:87], a[88:91], a[216:219], v[84:87]
ds_read_b64_tr_b16 a[120:121], v37 offset:6656
ds_read_b64_tr_b16 a[122:123], v37 offset:7680
s_waitcnt vmcnt(0)
v_cmp_ne_u64 vcc, s[94:95], v[222:223]
s_nop 0
s_cbranch_vccnz SLOW_yfE
BACK_yfE:
buffer_load_dwordx4 v[104:107], v33, s[36:39], s90 offen offset:0 sc1
v_mfma_f32_16x16x32_bf16 v[88:91], a[92:95], a[216:219], v[88:91]
ds_read_b64_tr_b16 a[124:125], v38 offset:4608
ds_read_b64_tr_b16 a[126:127], v38 offset:4864
buffer_load_dwordx4 v[108:111], v63, s[36:39], s90 offen offset:0 sc1
s_waitcnt lgkmcnt(10)
v_mfma_f32_16x16x32_bf16 v[92:95], a[96:99], a[216:219], v[92:95]
ds_read_b64_tr_b16 a[128:129], v36 offset:9216
ds_read_b64_tr_b16 a[130:131], v36 offset:10240
buffer_load_dwordx4 v[112:115], v33, s[36:39], s91 offen offset:0 sc1
v_mfma_f32_16x16x32_bf16 v[96:99], a[100:103], a[216:219], v[96:99]
ds_read_b64_tr_b16 a[132:133], v37 offset:9216
ds_read_b64_tr_b16 a[134:135], v37 offset:10240
buffer_load_dwordx4 v[116:119], v63, s[36:39], s91 offen offset:0 sc1
v_mfma_f32_16x16x32_bf16 v[100:103], a[104:107], a[216:219], v[100:103]
ds_read_b64_tr_b16 a[136:137], v36 offset:11264
ds_read_b64_tr_b16 a[138:139], v36 offset:12288
s_waitcnt lgkmcnt(10)
v_mfma_f32_16x16x32_bf16 v[84:87], a[108:111], a[220:223], v[84:87]
ds_read_b64_tr_b16 a[140:141], v37 offset:11264
ds_read_b64_tr_b16 a[142:143], v37 offset:12288
v_mfma_f32_16x16x32_bf16 v[88:91], a[112:115], a[220:223], v[88:91]
ds_read_b64_tr_b16 a[72:73], v38 offset:9216
ds_read_b64_tr_b16 a[74:75], v38 offset:9472
v_mfma_f32_16x16x32_bf16 v[92:95], a[116:119], a[220:223], v[92:95]
ds_read_b64_tr_b16 a[76:77], v36 offset:13824
ds_read_b64_tr_b16 a[78:79], v36 offset:14848
s_waitcnt lgkmcnt(10)
v_mfma_f32_16x16x32_bf16 v[96:99], a[120:123], a[220:223], v[96:99]
ds_read_b64_tr_b16 a[80:81], v37 offset:13824
ds_read_b64_tr_b16 a[82:83], v37 offset:14848
v_mfma_f32_16x16x32_bf16 v[100:103], a[124:127], a[220:223], v[100:103]
ds_read_b64_tr_b16 a[84:85], v36 offset:15872
ds_read_b64_tr_b16 a[86:87], v36 offset:16896
v_mfma_f32_16x16x32_bf16 v[84:87], a[128:131], a[224:227], v[84:87]
ds_read_b64_tr_b16 a[88:89], v37 offset:15872
ds_read_b64_tr_b16 a[90:91], v37 offset:16896
buffer_load_dwordx4 v[232:235], v33, s[36:39], s92 offen sc1
s_waitcnt lgkmcnt(10)
v_mfma_f32_16x16x32_bf16 v[88:91], a[132:135], a[224:227], v[88:91]
ds_read_b64_tr_b16 a[92:93], v38 offset:13824
ds_read_b64_tr_b16 a[94:95], v38 offset:14080
buffer_load_dwordx4 v[236:239], v63, s[36:39], s92 offen sc1
v_mfma_f32_16x16x32_bf16 v[92:95], a[136:139], a[224:227], v[92:95]
ds_read_b64_tr_b16 a[96:97], v36 offset:18432
ds_read_b64_tr_b16 a[98:99], v36 offset:19456
buffer_load_dwordx4 v[240:243], v62, s[36:39], s92 offen sc1
v_mfma_f32_16x16x32_bf16 v[96:99], a[140:143], a[224:227], v[96:99]
ds_read_b64_tr_b16 a[100:101], v37 offset:18432
ds_read_b64_tr_b16 a[102:103], v37 offset:19456
s_waitcnt lgkmcnt(10)
v_mfma_f32_16x16x32_bf16 v[100:103], a[72:75], a[224:227], v[100:103]
ds_read_b64_tr_b16 a[104:105], v36 offset:20480
ds_read_b64_tr_b16 a[106:107], v36 offset:21504
v_mfma_f32_16x16x32_bf16 v[84:87], a[76:79], a[228:231], v[84:87]
ds_read_b64_tr_b16 a[108:109], v37 offset:20480
ds_read_b64_tr_b16 a[110:111], v37 offset:21504
v_mfma_f32_16x16x32_bf16 v[88:91], a[80:83], a[228:231], v[88:91]
ds_read_b64_tr_b16 a[112:113], v38 offset:18432
ds_read_b64_tr_b16 a[114:115], v38 offset:18688
s_waitcnt lgkmcnt(10)
v_mfma_f32_16x16x32_bf16 v[92:95], a[84:87], a[228:231], v[92:95]
ds_read_b64_tr_b16 a[116:117], v36 offset:23040
ds_read_b64_tr_b16 a[118:119], v36 offset:24064
v_mfma_f32_16x16x32_bf16 v[96:99], a[88:91], a[228:231], v[96:99]
ds_read_b64_tr_b16 a[120:121], v37 offset:23040
ds_read_b64_tr_b16 a[122:123], v37 offset:24064
v_mfma_f32_16x16x32_bf16 v[100:103], a[92:95], a[228:231], v[100:103]
ds_read_b64_tr_b16 a[124:125], v36 offset:25088
ds_read_b64_tr_b16 a[126:127], v36 offset:26112
s_waitcnt lgkmcnt(10)
v_mfma_f32_16x16x32_bf16 v[84:87], a[96:99], a[232:235], v[84:87]
ds_read_b64_tr_b16 a[128:129], v37 offset:25088
ds_read_b64_tr_b16 a[130:131], v37 offset:26112
v_mfma_f32_16x16x32_bf16 v[88:91], a[100:103], a[232:235], v[88:91]
ds_read_b64_tr_b16 a[132:133], v38 offset:23040
ds_read_b64_tr_b16 a[134:135], v38 offset:23296
v_mfma_f32_16x16x32_bf16 v[92:95], a[104:107], a[232:235], v[92:95]
ds_read_b64_tr_b16 a[136:137], v36 offset:27648
ds_read_b64_tr_b16 a[138:139], v36 offset:28672
s_waitcnt lgkmcnt(10)
v_mfma_f32_16x16x32_bf16 v[96:99], a[108:111], a[232:235], v[96:99]
ds_read_b64_tr_b16 a[140:141], v37 offset:27648
ds_read_b64_tr_b16 a[142:143], v37 offset:28672
v_mfma_f32_16x16x32_bf16 v[100:103], a[112:115], a[232:235], v[100:103]
ds_read_b64_tr_b16 a[72:73], v36 offset:29696
ds_read_b64_tr_b16 a[74:75], v36 offset:30720
v_mfma_f32_16x16x32_bf16 v[84:87], a[116:119], a[236:239], v[84:87]
ds_read_b64_tr_b16 a[76:77], v37 offset:29696
ds_read_b64_tr_b16 a[78:79], v37 offset:30720
s_waitcnt lgkmcnt(10)
v_mfma_f32_16x16x32_bf16 v[88:91], a[120:123], a[236:239], v[88:91]
ds_read_b64_tr_b16 a[80:81], v38 offset:27648
ds_read_b64_tr_b16 a[82:83], v38 offset:27904
v_mfma_f32_16x16x32_bf16 v[92:95], a[124:127], a[236:239], v[92:95]
ds_read_b64_tr_b16 a[84:85], v36 offset:32256
ds_read_b64_tr_b16 a[86:87], v36 offset:33280
v_mfma_f32_16x16x32_bf16 v[96:99], a[128:131], a[236:239], v[96:99]
ds_read_b64_tr_b16 a[88:89], v37 offset:32256
ds_read_b64_tr_b16 a[90:91], v37 offset:33280
s_waitcnt lgkmcnt(10)
v_mfma_f32_16x16x32_bf16 v[100:103], a[132:135], a[236:239], v[100:103]
ds_read_b64_tr_b16 a[92:93], v36 offset:34304
ds_read_b64_tr_b16 a[94:95], v36 offset:35328
v_mfma_f32_16x16x32_bf16 v[84:87], a[136:139], a[240:243], v[84:87]
ds_read_b64_tr_b16 a[96:97], v37 offset:34304
ds_read_b64_tr_b16 a[98:99], v37 offset:35328
v_mfma_f32_16x16x32_bf16 v[88:91], a[140:143], a[240:243], v[88:91]
ds_read_b64_tr_b16 a[100:101], v38 offset:32256
ds_read_b64_tr_b16 a[102:103], v38 offset:32512
s_waitcnt lgkmcnt(10)
v_mfma_f32_16x16x32_bf16 v[92:95], a[72:75], a[240:243], v[92:95]
v_add_u32 v36, 36864, v36
v_add_u32 v37, 36864, v37
v_add_u32 v38, 36864, v38
ds_read_b64_tr_b16 a[104:105], v36 offset:0
ds_read_b64_tr_b16 a[106:107], v36 offset:1024
v_mfma_f32_16x16x32_bf16 v[96:99], a[76:79], a[240:243], v[96:99]
ds_read_b64_tr_b16 a[108:109], v37 offset:0
ds_read_b64_tr_b16 a[110:111], v37 offset:1024
v_mfma_f32_16x16x32_bf16 v[100:103], a[80:83], a[240:243], v[100:103]
ds_read_b64_tr_b16 a[112:113], v36 offset:2048
ds_read_b64_tr_b16 a[114:115], v36 offset:3072
s_waitcnt lgkmcnt(10)
v_mfma_f32_16x16x32_bf16 v[84:87], a[84:87], a[244:247], v[84:87]
ds_read_b64_tr_b16 a[116:117], v37 offset:2048
ds_read_b64_tr_b16 a[118:119], v37 offset:3072
v_mfma_f32_16x16x32_bf16 v[88:91], a[88:91], a[244:247], v[88:91]
ds_read_b64_tr_b16 a[120:121], v38 offset:0
ds_read_b64_tr_b16 a[122:123], v38 offset:256
v_mfma_f32_16x16x32_bf16 v[92:95], a[92:95], a[244:247], v[92:95]
ds_read_b64_tr_b16 a[124:125], v36 offset:4608
ds_read_b64_tr_b16 a[126:127], v36 offset:5632
s_waitcnt lgkmcnt(10)
v_mfma_f32_16x16x32_bf16 v[96:99], a[96:99], a[244:247], v[96:99]
ds_read_b64_tr_b16 a[128:129], v37 offset:4608
ds_read_b64_tr_b16 a[130:131], v37 offset:5632
v_mfma_f32_16x16x32_bf16 v[100:103], a[100:103], a[244:247], v[100:103]
ds_read_b64_tr_b16 a[132:133], v36 offset:6656
ds_read_b64_tr_b16 a[134:135], v36 offset:7680
v_mfma_f32_16x16x32_bf16 v[84:87], a[104:107], a[248:251], v[84:87]
ds_read_b64_tr_b16 a[136:137], v37 offset:6656
ds_read_b64_tr_b16 a[138:139], v37 offset:7680
s_waitcnt lgkmcnt(10)
v_mfma_f32_16x16x32_bf16 v[88:91], a[108:111], a[248:251], v[88:91]
ds_read_b64_tr_b16 a[140:141], v38 offset:4608
ds_read_b64_tr_b16 a[142:143], v38 offset:4864
v_mfma_f32_16x16x32_bf16 v[92:95], a[112:115], a[248:251], v[92:95]
v_mfma_f32_16x16x32_bf16 v[96:99], a[116:119], a[248:251], v[96:99]
s_waitcnt lgkmcnt(6)
v_mfma_f32_16x16x32_bf16 v[100:103], a[120:123], a[248:251], v[100:103]
v_mfma_f32_16x16x32_bf16 v[84:87], a[124:127], a[252:255], v[84:87]
v_mfma_f32_16x16x32_bf16 v[88:91], a[128:131], a[252:255], v[88:91]
s_waitcnt lgkmcnt(0)
v_mfma_f32_16x16x32_bf16 v[92:95], a[132:135], a[252:255], v[92:95]
v_mfma_f32_16x16x32_bf16 v[96:99], a[136:139], a[252:255], v[96:99]
v_mfma_f32_16x16x32_bf16 v[100:103], a[140:143], a[252:255], v[100:103]
v_mfma_f32_4x4x4_16b_bf16 v[200:203], v[44:45], v[244:245], 0
v_mfma_f32_4x4x4_16b_bf16 v[204:207], v[44:45], v[246:247], 0
v_mfma_f32_4x4x4_16b_bf16 v[208:211], v[44:45], v[248:249], 0
v_mfma_f32_4x4x4_16b_bf16 v[212:215], v[44:45], v[252:253], 0
v_pk_mul_f32 v[84:85], v[84:85], v[40:41]
v_pk_mul_f32 v[86:87], v[86:87], v[40:41]
v_pk_mul_f32 v[88:89], v[88:89], v[40:41]
v_pk_mul_f32 v[90:91], v[90:91], v[40:41]
v_pk_mul_f32 v[92:93], v[92:93], v[40:41]
v_pk_mul_f32 v[94:95], v[94:95], v[40:41]
v_pk_mul_f32 v[96:97], v[96:97], v[40:41]
v_pk_mul_f32 v[98:99], v[98:99], v[40:41]
v_pk_mul_f32 v[100:101], v[100:101], v[40:41]
v_pk_mul_f32 v[102:103], v[102:103], v[40:41]
v_pk_mul_f32 v[176:177], v[216:217], v[42:43]
v_pk_mul_f32 v[178:179], v[218:219], v[42:43]
v_exp_f32 v176, v176
v_exp_f32 v177, v177
v_exp_f32 v178, v178
v_exp_f32 v179, v179
v_pk_mul_f32 v[216:217], v[216:217], v[100:101]
v_pk_mul_f32 v[218:219], v[218:219], v[102:103]
v_pk_add_f32 v[176:177], v[176:177], 1.0 op_sel_hi:[1,0]
v_pk_add_f32 v[178:179], v[178:179], 1.0 op_sel_hi:[1,0]
v_rcp_f32 v176, v176
v_rcp_f32 v177, v177
v_rcp_f32 v178, v178
v_rcp_f32 v179, v179
v_pk_fma_f32 v[216:217], v[216:217], v[176:177], v[80:81]
v_pk_fma_f32 v[218:219], v[218:219], v[178:179], v[82:83]
v_cvt_pk_bf16_f32 v188, v216, v217
v_cvt_pk_bf16_f32 v189, v218, v219
buffer_store_dwordx2 v[188:189], v35, s[28:31], s42 offen sc1
s_waitcnt vmcnt(7)
v_mfma_f32_4x4x4_16b_bf16 v[200:203], v[44:45], v[104:105], v[200:203]
v_mfma_f32_4x4x4_16b_bf16 v[204:207], v[44:45], v[106:107], v[204:207]
s_waitcnt vmcnt(6)
v_mfma_f32_4x4x4_16b_bf16 v[208:211], v[44:45], v[108:109], v[208:211]
v_mfma_f32_4x4x4_16b_bf16 v[212:215], v[44:45], v[110:111], v[212:215]
s_waitcnt vmcnt(5)
v_mfma_f32_4x4x4_16b_bf16 v[200:203], v[44:45], v[112:113], v[200:203]
v_mfma_f32_4x4x4_16b_bf16 v[204:207], v[44:45], v[114:115], v[204:207]
s_waitcnt vmcnt(4)
v_mfma_f32_4x4x4_16b_bf16 v[208:211], v[44:45], v[116:117], v[208:211]
v_mfma_f32_4x4x4_16b_bf16 v[212:215], v[44:45], v[118:119], v[212:215]
s_waitcnt vmcnt(1)
v_min3_u32 v222, v235, v239, v243
v_max3_u32 v223, v235, v239, v243
v_cmp_ne_u64 vcc, s[74:75], v[222:223]
s_nop 0
s_cbranch_vccnz SLOW_ysL
BACK_ysL:
v_mov_b32 v235, v238
v_mfma_f32_4x4x4_16b_bf16 v[200:203], v[44:45], v[232:233], v[200:203]
s_nop 0
v_mfma_f32_4x4x4_16b_bf16 v[204:207], v[44:45], v[234:235], v[204:207]
v_mfma_f32_4x4x4_16b_bf16 v[208:211], v[44:45], v[236:237], v[208:211]
v_mfma_f32_4x4x4_16b_bf16 v[212:215], v[44:45], v[240:241], v[212:215]
s_nop 0
v_pk_mul_f32 v[160:161], v[200:201], v[42:43]
v_pk_mul_f32 v[162:163], v[202:203], v[42:43]
v_exp_f32 v160, v160
v_exp_f32 v161, v161
v_exp_f32 v162, v162
v_exp_f32 v163, v163
v_pk_mul_f32 v[200:201], v[200:201], v[84:85]
v_pk_mul_f32 v[202:203], v[202:203], v[86:87]
v_pk_mul_f32 v[164:165], v[204:205], v[42:43]
v_pk_mul_f32 v[166:167], v[206:207], v[42:43]
v_exp_f32 v164, v164
v_exp_f32 v165, v165
v_exp_f32 v166, v166
v_exp_f32 v167, v167
v_pk_mul_f32 v[204:205], v[204:205], v[88:89]
v_pk_mul_f32 v[206:207], v[206:207], v[90:91]
v_pk_add_f32 v[160:161], v[160:161], 1.0 op_sel_hi:[1,0]
v_pk_add_f32 v[162:163], v[162:163], 1.0 op_sel_hi:[1,0]
v_rcp_f32 v160, v160
v_rcp_f32 v161, v161
v_rcp_f32 v162, v162
v_rcp_f32 v163, v163
v_pk_fma_f32 v[200:201], v[200:201], v[160:161], v[64:65]
v_pk_fma_f32 v[202:203], v[202:203], v[162:163], v[66:67]
v_cvt_pk_bf16_f32 v180, v200, v201
v_cvt_pk_bf16_f32 v181, v202, v203
v_pk_add_f32 v[164:165], v[164:165], 1.0 op_sel_hi:[1,0]
v_pk_add_f32 v[166:167], v[166:167], 1.0 op_sel_hi:[1,0]
v_rcp_f32 v164, v164
v_rcp_f32 v165, v165
v_rcp_f32 v166, v166
v_rcp_f32 v167, v167
v_pk_fma_f32 v[204:205], v[204:205], v[164:165], v[68:69]
v_pk_fma_f32 v[206:207], v[206:207], v[166:167], v[70:71]
v_cvt_pk_bf16_f32 v182, v204, v205
v_cvt_pk_bf16_f32 v183, v206, v207
s_nop 0
v_permlane16_swap_b32 v180, v182
v_permlane16_swap_b32 v181, v183
buffer_store_dwordx4 v[180:183], v34, s[28:31], s85 offen offset:0 sc1
v_pk_mul_f32 v[168:169], v[208:209], v[42:43]
v_pk_mul_f32 v[170:171], v[210:211], v[42:43]
v_exp_f32 v168, v168
v_exp_f32 v169, v169
v_exp_f32 v170, v170
v_exp_f32 v171, v171
v_pk_mul_f32 v[208:209], v[208:209], v[92:93]
v_pk_mul_f32 v[210:211], v[210:211], v[94:95]
v_pk_mul_f32 v[172:173], v[212:213], v[42:43]
v_pk_mul_f32 v[174:175], v[214:215], v[42:43]
v_exp_f32 v172, v172
v_exp_f32 v173, v173
v_exp_f32 v174, v174
v_exp_f32 v175, v175
v_pk_mul_f32 v[212:213], v[212:213], v[96:97]
v_pk_mul_f32 v[214:215], v[214:215], v[98:99]
v_pk_add_f32 v[168:169], v[168:169], 1.0 op_sel_hi:[1,0]
v_pk_add_f32 v[170:171], v[170:171], 1.0 op_sel_hi:[1,0]
v_rcp_f32 v168, v168
v_rcp_f32 v169, v169
v_rcp_f32 v170, v170
v_rcp_f32 v171, v171
v_pk_fma_f32 v[208:209], v[208:209], v[168:169], v[72:73]
v_pk_fma_f32 v[210:211], v[210:211], v[170:171], v[74:75]
v_cvt_pk_bf16_f32 v184, v208, v209
v_cvt_pk_bf16_f32 v185, v210, v211
v_pk_add_f32 v[172:173], v[172:173], 1.0 op_sel_hi:[1,0]
v_pk_add_f32 v[174:175], v[174:175], 1.0 op_sel_hi:[1,0]
v_rcp_f32 v172, v172
v_rcp_f32 v173, v173
v_rcp_f32 v174, v174
v_rcp_f32 v175, v175
v_pk_fma_f32 v[212:213], v[212:213], v[172:173], v[76:77]
v_pk_fma_f32 v[214:215], v[214:215], v[174:175], v[78:79]
v_cvt_pk_bf16_f32 v186, v212, v213
v_cvt_pk_bf16_f32 v187, v214, v215
s_nop 0
v_permlane16_swap_b32 v184, v186
v_permlane16_swap_b32 v185, v187
buffer_store_dwordx4 v[184:187], v34, s[28:31], s85 offen offset:64 sc1
L_end:
s_endpgm
SLOW_tag:
s_mov_b32 s100, 0
LOOP_tag:
v_mov_b32 v24, 0
buffer_load_dwordx2 v[22:23], v24, s[32:35], s56 offen sc1
s_add_u32 s100, s100, 1
s_waitcnt vmcnt(0)
v_min_u32 v24, v22, v23
v_cmp_eq_u32 vcc, 0, v24
s_nop 1
s_cbranch_vccz BACK_tag
s_cmp_lt_u32 s100, 20000
s_cbranch_scc1 LOOP_tag
s_branch BACK_tag
SLOW_rp:
s_mov_b32 s100, 0
LOOP_rp:
buffer_load_dwordx2 v[22:23], v24, s[36:39], s53 offen sc1
s_add_u32 s100, s100, 1
s_waitcnt vmcnt(0)
v_cmp_ne_u64 vcc, s[94:95], v[22:23]
s_nop 1
s_cbranch_vccz BACK_rp
s_cmp_lt_u32 s100, 20000
s_cbranch_scc1 LOOP_rp
s_branch BACK_rp
SLOW_kvf:
s_mov_b32 s100, 0
LOOP_kvf:
buffer_load_dwordx2 v[30:31], v26, s[36:39], s60 offen sc1
s_add_u32 s100, s100, 1
s_waitcnt vmcnt(0)
v_cmp_ne_u64 vcc, s[94:95], v[30:31]
s_nop 1
s_cbranch_vccz BACK_kvf
s_cmp_lt_u32 s100, 20000
s_cbranch_scc1 LOOP_kvf
s_branch BACK_kvf
SLOW_wo:
s_mov_b32 s100, 0
LOOP_wo:
buffer_load_dwordx2 v[22:23], v24, s[36:39], s66 offen sc1
s_add_u32 s100, s100, 1
s_waitcnt vmcnt(0)
v_cmp_ne_u64 vcc, s[94:95], v[22:23]
s_nop 1
s_cbranch_vccz BACK_wo
s_cmp_lt_u32 s100, 20000
s_cbranch_scc1 LOOP_wo
s_branch BACK_wo
SLOW_hA:
s_mov_b32 s100, 0
LOOP_hA:
buffer_load_dwordx2 v[22:23], v24, s[36:39], s66 offen sc1
s_add_u32 s100, s100, 1
s_waitcnt vmcnt(0)
v_cmp_ne_u64 vcc, s[94:95], v[22:23]
s_nop 1
s_cbranch_vccz BACK_hA
s_cmp_lt_u32 s100, 20000
s_cbranch_scc1 LOOP_hA
s_branch BACK_hA
SLOW_hB:
s_mov_b32 s100, 0
LOOP_hB:
buffer_load_dwordx2 v[22:23], v24, s[36:39], s66 offen offset:32 sc1
s_add_u32 s100, s100, 1
s_waitcnt vmcnt(0)
v_cmp_ne_u64 vcc, s[94:95], v[22:23]
s_nop 1
s_cbranch_vccz BACK_hB
s_cmp_lt_u32 s100, 20000
s_cbranch_scc1 LOOP_hB
s_branch BACK_hB
SLOW_of:
s_mov_b32 s100, 0
LOOP_of:
buffer_load_dwordx2 v[56:57], v46, s[36:39], s47 offen sc1
s_add_u32 s100, s100, 1
s_waitcnt vmcnt(0)
v_cmp_ne_u64 vcc, s[94:95], v[56:57]
s_nop 1
s_cbranch_vccz BACK_of
s_cmp_lt_u32 s100, 20000
s_cbranch_scc1 LOOP_of
s_branch BACK_of
SLOW_yfE:
s_mov_b32 s100, 0
LOOP_yfE:
buffer_load_dwordx2 v[222:223], v61, s[36:39], s47 offen sc1
s_add_u32 s100, s100, 1
s_waitcnt vmcnt(0)
v_cmp_ne_u64 vcc, s[94:95], v[222:223]
s_nop 1
s_cbranch_vccz BACK_yfE
s_cmp_lt_u32 s100, 20000
s_cbranch_scc1 LOOP_yfE
s_branch BACK_yfE
SLOW_ysL:
s_mov_b32 s100, 0
LOOP_ysL:
v_mov_b32 v224, 4196348
PRE_ysL:
buffer_load_dword v222, v224, s[36:39], s92 offen sc1
s_add_u32 s100, s100, 1
s_waitcnt vmcnt(0)
v_cmp_ne_u32 vcc, s74, v222
s_nop 1
s_cbranch_vccz GO_ysL
s_cmp_lt_u32 s100, 20000
s_cbranch_scc1 PRE_ysL
GO_ysL:
buffer_load_dwordx4 v[232:235], v33, s[36:39], s92 offen sc1
buffer_load_dwordx4 v[236:239], v63, s[36:39], s92 offen sc1
buffer_load_dwordx4 v[240:243], v62, s[36:39], s92 offen sc1
s_add_u32 s100, s100, 1
s_waitcnt vmcnt(0)
v_min3_u32 v222, v235, v239, v243
v_max3_u32 v223, v235, v239, v243
v_cmp_ne_u64 vcc, s[74:75], v[222:223]
s_nop 1
s_cbranch_vccz BACK_ysL
s_cmp_lt_u32 s100, 20000
s_cbranch_scc1 LOOP_ysL
s_branch BACK_ysL
CODE_END:
s_endpgm
.section .rodata,"a"
.p2align 6
.amdhsa_kernel recurrent_scan__linear_kernel_hedgehog__dense_activation_relu__prompt_kernel
  .amdhsa_next_free_vgpr 512
  .amdhsa_next_free_sgpr 102
  .amdhsa_accum_offset 256
  .amdhsa_group_segment_fixed_size 0
  .amdhsa_kernarg_size 80
  .amdhsa_user_sgpr_count 2
  .amdhsa_user_sgpr_kernarg_segment_ptr 1
  .amdhsa_system_sgpr_workgroup_id_x 1
.end_amdhsa_kernel
```
